```python
import torch

def _softmax(x, axis=-1):
    return torch.softmax(x, dim=axis)
def _gelu(x):
    return torch.nn.functional.gelu(x, approximate="tanh")
def _silu(x):
    return torch.nn.functional.silu(x)
def _sigmoid(x):
    return torch.sigmoid(x)
def _layernorm(x, axis=-1, eps=1e-5):
    m = x.mean(dim=axis, keepdim=True)
    v = x.var(dim=axis, keepdim=True, unbiased=False)
    return (x - m) / torch.sqrt(v + eps)
def _scatter_add(tgt, idx, src, axis=0):
    return tgt.clone().index_add_(axis, idx, src)
def _segment_sum(src, seg, n):
    out = torch.zeros((n,) + src.shape[1:], dtype=src.dtype)
    return out.index_add_(0, seg, src)
def _pad(x, pw):
    flat = tuple(v for pair in reversed(pw) for v in pair)
    return torch.nn.functional.pad(x, flat)

kernel_name = 'standalone__mha_softmax__near_ridge'

def setup_inputs():

    _w = (lambda a: (lambda t: t.to(torch.bfloat16) if t.is_floating_point() else t)(torch.as_tensor(a)))
    B, H, Sq, Sk, D = 16, 32, 384, 512, 128
    return {
        "q": _w((lambda *s: torch.randn(*s, dtype=torch.bfloat16) * 0.8)(B, H, Sq, D)),
        "k": _w((lambda *s: torch.randn(*s, dtype=torch.bfloat16) * 0.8)(B, H, Sk, D)),
        "v": _w((lambda *s: torch.randn(*s, dtype=torch.bfloat16) * 0.05)(B, H, Sk, D)),
    }

def reference(q, k, v):
    scale = q.shape[-1] ** -0.5
    scores = torch.einsum("bhqd,bhkd->bhqk", q, k) * scale
    p = _softmax(scores, axis=-1)
    return torch.einsum("bhqk,bhkd->bhqd", p, v)
```

```asm
; @launch grid=(256,1,1) block=(256,1,1) lds=163840
.amdgcn_target "amdgcn-amd-amdhsa--gfx950"
.text
.globl standalone__mha_softmax__near_ridge_kernel
.p2align 8
.type standalone__mha_softmax__near_ridge_kernel,@function
standalone__mha_softmax__near_ridge_kernel:
    s_load_dwordx4 s[4:7], s[0:1], 0
    s_load_dwordx4 s[8:11], s[0:1], 16
    s_cmp_ge_u32 s2, 256
    s_cbranch_scc1 L_end
    s_getpc_b64 s[40:41]
L_pc:
    s_bfe_u32 s33, s2, 0x40003
    s_lshl_b32 s33, s33, 12
    v_lshlrev_b32 v4, 4, v0
    v_add_u32 v4, s33, v4
    v_min_u32 v5, L_fast_end-L_pc, v4
    global_load_dword v7, v5, s[40:41]
    v_lshrrev_b32 v5, 6, v0
    v_and_b32 v1, 63, v0
    v_readfirstlane_b32 s28, v5
    v_and_b32 v2, 15, v1
    v_lshrrev_b32 v3, 4, v1
    v_lshlrev_b32 v4, 1, v3
    v_xor_b32 v4, v4, v2
    v_lshlrev_b32 v4, 4, v4
    v_lshl_add_u32 v133, v3, 8, v4
    v_xor_b32 v134, 128, v133
    s_and_b32 s33, s28, 1
    s_lshr_b32 s34, s28, 1
    s_lshl_b32 s35, s33, 7
    s_lshl_b32 s33, s33, 10
    s_lshl_b32 s34, s34, 12
    s_add_u32 s33, s33, s34
    v_xor_b32 v132, s35, v133
    v_add_u32 v132, s33, v132
    s_lshl_b32 s30, s28, 12
    s_mul_i32 s31, s28, 24576
    s_mul_i32 s33, s2, 196608
    s_add_u32 s33, s33, s31
    s_add_u32 s31, s31, 65536
    s_lshl_b32 s34, s2, 18
    s_mov_b32 s14, 122880
    s_mov_b32 s15, 0x20000
    s_waitcnt lgkmcnt(0)
    s_add_u32 s16, s6, s34
    s_addc_u32 s17, s7, 0
    s_add_u32 s12, s4, s33
    s_addc_u32 s13, s5, 0
    s_and_b32 s13, s13, 0xffff
    s_mov_b32 s32, -4096
    s_add_u32 m0, s30, 32768
    s_nop 0
    global_load_lds_dwordx4 v132, s[16:17] nt
    global_load_lds_dwordx4 v132, s[16:17] offset:2048 nt
    v_add_u32 v132, 8192, v132
    s_add_u32 s32, s32, 4096
    s_add_u32 m0, s31, s32
    s_nop 0
    buffer_load_dwordx4 v133, s[12:15], s32 offen nt lds
    buffer_load_dwordx4 v134, s[12:15], s32 offen offset:1024 nt lds
    buffer_load_dwordx4 v133, s[12:15], s32 offen offset:2048 nt lds
    buffer_load_dwordx4 v134, s[12:15], s32 offen offset:3072 nt lds
    s_getreg_b32 s29, hwreg(HW_REG_XCC_ID, 0, 1)
    s_cmp_eq_u32 s29, 0
    s_cbranch_scc1 L_e1
    s_add_u32 s32, s32, 4096
    s_add_u32 m0, s31, s32
    s_nop 0
    buffer_load_dwordx4 v133, s[12:15], s32 offen nt lds
    buffer_load_dwordx4 v134, s[12:15], s32 offen offset:1024 nt lds
    buffer_load_dwordx4 v133, s[12:15], s32 offen offset:2048 nt lds
    buffer_load_dwordx4 v134, s[12:15], s32 offen offset:3072 nt lds
L_e1:
    s_branch L_main
.p2align 12
L_main:
    s_add_u32 s22, s8, s34
    s_addc_u32 s23, s9, 0
    s_sub_u32 s22, s22, 17408
    s_subb_u32 s23, s23, 0
    s_add_u32 s24, s10, s33
    s_addc_u32 s25, s11, 0
    s_and_b32 s25, s25, 0xffff
    s_mov_b32 s26, 122880
    s_mov_b32 s27, 0x20000
    s_add_u32 s18, s22, 9216
    s_addc_u32 s19, s23, 0
    s_mov_b32 s38, 0x3e0293ee
    s_mov_b32 s39, 0x3e0293ee
    s_mov_b32 s37, 0x5f800000
    s_mov_b32 s36, 0
    s_add_u32 s20, s12, 98304
    s_addc_u32 s21, s13, 0
    v_and_b32 v4, 7, v2
    v_lshlrev_b32 v4, 1, v4
    v_xor_b32 v4, v4, v3
    v_lshlrev_b32 v4, 4, v4
    v_lshl_add_u32 v6, v2, 8, v4
    v_add_u32 v136, s31, v6
    v_and_b32 v5, 3, v2
    v_lshl_add_u32 v4, v5, 8, v4
    v_lshrrev_b32 v5, 3, v2
    v_lshl_add_u32 v4, v5, 11, v4
    v_bfe_u32 v5, v2, 2, 1
    v_lshl_add_u32 v120, v5, 12, v4
    v_xor_b32 v121, 64, v120
    v_xor_b32 v137, 64, v136
    v_xor_b32 v122, 128, v120
    v_xor_b32 v138, 128, v136
    v_xor_b32 v123, 192, v120
    v_xor_b32 v139, 192, v136
    v_lshrrev_b32 v5, 2, v2
    v_and_b32 v6, 1, v3
    v_lshl_add_u32 v4, v6, 2, v5
    v_lshlrev_b32 v4, 5, v4
    v_lshl_add_u32 v4, v5, 8, v4
    v_lshl_add_u32 v4, v6, 12, v4
    v_lshrrev_b32 v6, 1, v3
    v_lshl_add_u32 v4, v6, 11, v4
    v_and_b32 v5, 3, v2
    v_lshl_add_u32 v4, v5, 3, v4
    v_add_u32 v124, 1024, v4
    v_xor_b32 v125, 32, v124
    v_xor_b32 v126, 64, v124
    v_xor_b32 v127, 96, v124
    v_xor_b32 v128, 128, v124
    v_xor_b32 v129, 160, v124
    v_xor_b32 v130, 192, v124
    v_xor_b32 v131, 224, v124
    v_mov_b32 v6, 0x3f803f80
    v_cmp_eq_u32 vcc, 0, v2
    s_nop 1
    v_cndmask_b32 v4, 0, v6, vcc
    v_accvgpr_write_b32 a136, v4
    v_accvgpr_write_b32 a137, v4
    v_accvgpr_write_b32 a138, v4
    v_accvgpr_write_b32 a139, v4
    v_cmp_eq_u32 vcc, 1, v2
    s_nop 1
    v_cndmask_b32 v4, 0, v6, vcc
    v_accvgpr_write_b32 a140, v4
    v_accvgpr_write_b32 a141, v4
    v_accvgpr_write_b32 a142, v4
    v_accvgpr_write_b32 a143, v4
    v_cmp_eq_u32 vcc, 2, v2
    s_nop 1
    v_cndmask_b32 v4, 0, v6, vcc
    v_accvgpr_write_b32 a144, v4
    v_accvgpr_write_b32 a145, v4
    v_accvgpr_write_b32 a146, v4
    v_accvgpr_write_b32 a147, v4
    v_lshrrev_b32 v4, 1, v2
    v_lshlrev_b32 v5, 1, v3
    v_sub_u32 v4, v4, v5
    v_and_b32 v5, 1, v2
    v_lshlrev_b32 v5, 4, v5
    v_cmp_eq_u32 vcc, 0, v4
    v_mov_b32 v6, 0x3e03
    v_lshlrev_b32 v6, v5, v6
    v_cndmask_b32 v6, 0, v6, vcc
    v_accvgpr_write_b32 a166, v6
    v_mov_b32 v6, 0xb9d8
    v_lshlrev_b32 v6, v5, v6
    v_cndmask_b32 v6, 0, v6, vcc
    v_accvgpr_write_b32 a170, v6
    v_cmp_eq_u32 vcc, 1, v4
    v_mov_b32 v6, 0x3e03
    v_lshlrev_b32 v6, v5, v6
    v_cndmask_b32 v6, 0, v6, vcc
    v_accvgpr_write_b32 a167, v6
    v_mov_b32 v6, 0xb9d8
    v_lshlrev_b32 v6, v5, v6
    v_cndmask_b32 v6, 0, v6, vcc
    v_accvgpr_write_b32 a171, v6
    v_accvgpr_write_b32 a164, 0
    v_accvgpr_write_b32 a165, 0
    v_accvgpr_write_b32 a168, 0
    v_accvgpr_write_b32 a169, 0
    v_accvgpr_write_b32 a172, 0
    v_accvgpr_write_b32 a173, 0
    v_lshlrev_b32 v4, 3, v1
    v_add_u32 v140, s31, v4
    v_bfe_u32 v5, v2, 1, 1
    v_lshl_add_u32 v4, v5, 2, v3
    v_lshlrev_b32 v4, 9, v4
    v_and_b32 v5, 1, v2
    v_lshl_add_u32 v4, v5, 6, v4
    v_lshrrev_b32 v5, 2, v2
    v_lshl_add_u32 v4, v5, 3, v4
    v_add_u32 v141, s31, v4
    v_and_b32 v6, 3, v2
    v_lshlrev_b32 v4, 5, v6
    v_lshl_add_u32 v4, v3, 8, v4
    v_and_b32 v6, 1, v5
    v_lshl_add_u32 v4, v6, 4, v4
    v_lshrrev_b32 v6, 1, v5
    v_lshl_add_u32 v135, v6, 7, v4
    s_cmp_eq_u32 s29, 0
    s_cbranch_scc1 L_e2
    s_add_u32 s32, s32, 4096
    s_add_u32 m0, s31, s32
    s_nop 0
    buffer_load_dwordx4 v133, s[12:15], s32 offen nt lds
    buffer_load_dwordx4 v134, s[12:15], s32 offen offset:1024 nt lds
    buffer_load_dwordx4 v133, s[12:15], s32 offen offset:2048 nt lds
    buffer_load_dwordx4 v134, s[12:15], s32 offen offset:3072 nt lds
L_e2:
    s_mov_b64 vcc, 0
    s_cmp_eq_u32 s28, 0
    s_cbranch_scc1 L_pad1
    s_cmp_eq_u32 s28, 1
    s_cbranch_scc1 L_pad2
    s_cmp_eq_u32 s28, 2
    s_cbranch_scc1 L_pad3
    s_branch L_pad4
L_padret0:
    s_mov_b64 vcc, -1
    s_mov_b64 vcc, 0
    s_cmp_eq_u32 s28, 0
    s_cbranch_scc1 L_pad5
    s_cmp_eq_u32 s28, 1
    s_cbranch_scc1 L_pad6
    s_cmp_eq_u32 s28, 2
    s_cbranch_scc1 L_pad7
    s_branch L_pad8
L_padret1:
    s_mov_b64 vcc, -1
    s_mov_b64 vcc, 0
    s_cmp_eq_u32 s28, 0
    s_cbranch_scc1 L_pad9
    s_cmp_eq_u32 s28, 1
    s_cbranch_scc1 L_pad10
    s_cmp_eq_u32 s28, 2
    s_cbranch_scc1 L_pad11
    s_branch L_pad12
L_padret2:
    s_mov_b64 vcc, -1
    s_cmp_eq_u32 s29, 0
    s_cbranch_scc0 L_lk
    s_waitcnt vmcnt(4)
L_lk:
    s_waitcnt vmcnt(12)
    s_barrier
    ds_read_b128 a[96:99], v120 offset:32768
    ds_read_b128 a[100:103], v121 offset:32768
    ds_read_b128 a[104:107], v122 offset:32768
    ds_read_b128 a[108:111], v123 offset:32768
    ds_read_b128 a[112:115], v120 offset:40960
    ds_read_b128 a[116:119], v121 offset:40960
    ds_read_b128 a[120:123], v122 offset:40960
    ds_read_b128 a[124:127], v123 offset:40960
    s_cmp_eq_u32 s29, 0
    s_cbranch_scc0 L_l0
    s_waitcnt vmcnt(0)
L_l0:
    s_waitcnt vmcnt(8)
    ds_read_b128 v[72:75], v136
    ds_read_b128 v[76:79], v137
    ds_read_b128 v[80:83], v138
    ds_read_b128 v[84:87], v139
    s_waitcnt lgkmcnt(3)
    s_add_u32 s32, s32, 4096
    s_add_u32 m0, s31, s32
    s_nop 0
    buffer_load_dwordx4 v133, s[12:15], s32 offen nt lds
    v_lshlrev_b32 v88, 16, v72
    v_and_b32 v89, 0xffff0000, v72
    v_lshlrev_b32 v90, 16, v73
    v_and_b32 v91, 0xffff0000, v73
    v_lshlrev_b32 v92, 16, v74
    v_and_b32 v93, 0xffff0000, v74
    v_lshlrev_b32 v94, 16, v75
    v_and_b32 v95, 0xffff0000, v75
    v_pk_mul_f32 v[88:89], v[88:89], s[38:39]
    v_pk_mul_f32 v[90:91], v[90:91], s[38:39]
    v_pk_mul_f32 v[92:93], v[92:93], s[38:39]
    v_pk_mul_f32 v[94:95], v[94:95], s[38:39]
    v_cvt_pk_bf16_f32 v0, v88, v89
    v_cvt_pk_bf16_f32 v1, v90, v91
    v_cvt_pk_bf16_f32 v2, v92, v93
    v_cvt_pk_bf16_f32 v3, v94, v95
    v_accvgpr_write_b32 a0, v0
    v_accvgpr_write_b32 a1, v1
    v_accvgpr_write_b32 a2, v2
    v_accvgpr_write_b32 a3, v3
    s_waitcnt lgkmcnt(2)
    buffer_load_dwordx4 v134, s[12:15], s32 offen offset:1024 nt lds
    v_lshlrev_b32 v88, 16, v76
    v_and_b32 v89, 0xffff0000, v76
    v_lshlrev_b32 v90, 16, v77
    v_and_b32 v91, 0xffff0000, v77
    v_lshlrev_b32 v92, 16, v78
    v_and_b32 v93, 0xffff0000, v78
    v_lshlrev_b32 v94, 16, v79
    v_and_b32 v95, 0xffff0000, v79
    v_pk_mul_f32 v[88:89], v[88:89], s[38:39]
    v_pk_mul_f32 v[90:91], v[90:91], s[38:39]
    v_pk_mul_f32 v[92:93], v[92:93], s[38:39]
    v_pk_mul_f32 v[94:95], v[94:95], s[38:39]
    v_cvt_pk_bf16_f32 v4, v88, v89
    v_cvt_pk_bf16_f32 v5, v90, v91
    v_cvt_pk_bf16_f32 v6, v92, v93
    v_cvt_pk_bf16_f32 v7, v94, v95
    v_accvgpr_write_b32 a4, v4
    v_accvgpr_write_b32 a5, v5
    v_accvgpr_write_b32 a6, v6
    v_accvgpr_write_b32 a7, v7
    s_waitcnt lgkmcnt(1)
    buffer_load_dwordx4 v133, s[12:15], s32 offen offset:2048 nt lds
    v_lshlrev_b32 v88, 16, v80
    v_and_b32 v89, 0xffff0000, v80
    v_lshlrev_b32 v90, 16, v81
    v_and_b32 v91, 0xffff0000, v81
    v_lshlrev_b32 v92, 16, v82
    v_and_b32 v93, 0xffff0000, v82
    v_lshlrev_b32 v94, 16, v83
    v_and_b32 v95, 0xffff0000, v83
    v_pk_mul_f32 v[88:89], v[88:89], s[38:39]
    v_pk_mul_f32 v[90:91], v[90:91], s[38:39]
    v_pk_mul_f32 v[92:93], v[92:93], s[38:39]
    v_pk_mul_f32 v[94:95], v[94:95], s[38:39]
    v_cvt_pk_bf16_f32 v0, v88, v89
    v_cvt_pk_bf16_f32 v1, v90, v91
    v_cvt_pk_bf16_f32 v2, v92, v93
    v_cvt_pk_bf16_f32 v3, v94, v95
    v_accvgpr_write_b32 a8, v0
    v_accvgpr_write_b32 a9, v1
    v_accvgpr_write_b32 a10, v2
    v_accvgpr_write_b32 a11, v3
    s_waitcnt lgkmcnt(0)
    buffer_load_dwordx4 v134, s[12:15], s32 offen offset:3072 nt lds
    v_lshlrev_b32 v88, 16, v84
    v_and_b32 v89, 0xffff0000, v84
    v_lshlrev_b32 v90, 16, v85
    v_and_b32 v91, 0xffff0000, v85
    v_lshlrev_b32 v92, 16, v86
    v_and_b32 v93, 0xffff0000, v86
    v_lshlrev_b32 v94, 16, v87
    v_and_b32 v95, 0xffff0000, v87
    v_pk_mul_f32 v[88:89], v[88:89], s[38:39]
    v_pk_mul_f32 v[90:91], v[90:91], s[38:39]
    v_pk_mul_f32 v[92:93], v[92:93], s[38:39]
    v_pk_mul_f32 v[94:95], v[94:95], s[38:39]
    v_cvt_pk_bf16_f32 v4, v88, v89
    v_cvt_pk_bf16_f32 v5, v90, v91
    v_cvt_pk_bf16_f32 v6, v92, v93
    v_cvt_pk_bf16_f32 v7, v94, v95
    v_accvgpr_write_b32 a12, v4
    v_accvgpr_write_b32 a13, v5
    v_accvgpr_write_b32 a14, v6
    v_accvgpr_write_b32 a15, v7
    v_mfma_f32_16x16x32_bf16 v[0:3], a[96:99], a[0:3], 0
    v_mfma_f32_16x16x32_bf16 v[0:3], a[100:103], a[4:7], v[0:3]
    v_mfma_f32_16x16x32_bf16 v[0:3], a[104:107], a[8:11], v[0:3]
    v_mfma_f32_16x16x32_bf16 v[0:3], a[108:111], a[12:15], v[0:3]
    v_mfma_f32_16x16x32_bf16 v[4:7], a[124:127], a[12:15], 0
    v_mfma_f32_16x16x32_bf16 v[4:7], a[120:123], a[8:11], v[4:7]
    v_mfma_f32_16x16x32_bf16 v[4:7], a[116:119], a[4:7], v[4:7]
    v_mfma_f32_16x16x32_bf16 v[4:7], a[112:115], a[0:3], v[4:7]
    s_nop 3
    v_max3_f32 v96, v0, v1, v2
    s_nop 6
    v_max3_f32 v97, v3, v4, v5
    s_nop 5
    v_max3_f32 v96, v96, v6, v7
    v_max_f32 v96, v96, v97
    v_mov_b32 v97, v96
    s_nop 1
    v_permlane32_swap_b32 v96, v97
    v_max_f32 v96, v96, v97
    v_mov_b32 v97, v96
    s_nop 1
    v_permlane16_swap_b32 v96, v97
    v_max_f32 v96, v96, v97
    v_sub_f32 v97, 0, v96
    v_sub_f32 v98, 0, v96
    v_sub_f32 v99, 0, v96
    v_sub_f32 v96, 0, v96
    v_pk_add_f32 v[0:1], v[0:1], v[96:97]
    v_pk_add_f32 v[2:3], v[2:3], v[96:97]
    v_pk_add_f32 v[4:5], v[4:5], v[96:97]
    v_pk_add_f32 v[6:7], v[6:7], v[96:97]
    v_exp_f32 v0, v0
    v_exp_f32 v1, v1
    v_exp_f32 v2, v2
    v_cvt_pk_bf16_f32 v48, v0, v1
    v_exp_f32 v3, v3
    v_exp_f32 v4, v4
    v_cvt_pk_bf16_f32 v49, v2, v3
    v_exp_f32 v5, v5
    v_exp_f32 v6, v6
    v_cvt_pk_bf16_f32 v50, v4, v5
    v_exp_f32 v7, v7
    s_nop 0
    v_cvt_pk_bf16_f32 v51, v6, v7
    s_cmp_eq_u32 s29, 0
    s_cbranch_scc0 L_l1
    s_waitcnt vmcnt(0)
L_l1:
    s_waitcnt vmcnt(8)
    ds_read_b128 v[72:75], v136 offset:4096
    ds_read_b128 v[76:79], v137 offset:4096
    ds_read_b128 v[80:83], v138 offset:4096
    ds_read_b128 v[84:87], v139 offset:4096
    s_waitcnt lgkmcnt(3)
    s_add_u32 s32, s32, 4096
    s_add_u32 m0, s31, s32
    s_nop 0
    buffer_load_dwordx4 v133, s[12:15], s32 offen nt lds
    v_lshlrev_b32 v88, 16, v72
    v_and_b32 v89, 0xffff0000, v72
    v_lshlrev_b32 v90, 16, v73
    v_and_b32 v91, 0xffff0000, v73
    v_lshlrev_b32 v92, 16, v74
    v_and_b32 v93, 0xffff0000, v74
    v_lshlrev_b32 v94, 16, v75
    v_and_b32 v95, 0xffff0000, v75
    v_pk_mul_f32 v[88:89], v[88:89], s[38:39]
    v_pk_mul_f32 v[90:91], v[90:91], s[38:39]
    v_pk_mul_f32 v[92:93], v[92:93], s[38:39]
    v_pk_mul_f32 v[94:95], v[94:95], s[38:39]
    v_cvt_pk_bf16_f32 v8, v88, v89
    v_cvt_pk_bf16_f32 v9, v90, v91
    v_cvt_pk_bf16_f32 v10, v92, v93
    v_cvt_pk_bf16_f32 v11, v94, v95
    v_accvgpr_write_b32 a16, v8
    v_accvgpr_write_b32 a17, v9
    v_accvgpr_write_b32 a18, v10
    v_accvgpr_write_b32 a19, v11
    s_waitcnt lgkmcnt(2)
    buffer_load_dwordx4 v134, s[12:15], s32 offen offset:1024 nt lds
    v_lshlrev_b32 v88, 16, v76
    v_and_b32 v89, 0xffff0000, v76
    v_lshlrev_b32 v90, 16, v77
    v_and_b32 v91, 0xffff0000, v77
    v_lshlrev_b32 v92, 16, v78
    v_and_b32 v93, 0xffff0000, v78
    v_lshlrev_b32 v94, 16, v79
    v_and_b32 v95, 0xffff0000, v79
    v_pk_mul_f32 v[88:89], v[88:89], s[38:39]
    v_pk_mul_f32 v[90:91], v[90:91], s[38:39]
    v_pk_mul_f32 v[92:93], v[92:93], s[38:39]
    v_pk_mul_f32 v[94:95], v[94:95], s[38:39]
    v_cvt_pk_bf16_f32 v12, v88, v89
    v_cvt_pk_bf16_f32 v13, v90, v91
    v_cvt_pk_bf16_f32 v14, v92, v93
    v_cvt_pk_bf16_f32 v15, v94, v95
    v_accvgpr_write_b32 a20, v12
    v_accvgpr_write_b32 a21, v13
    v_accvgpr_write_b32 a22, v14
    v_accvgpr_write_b32 a23, v15
    s_waitcnt lgkmcnt(1)
    buffer_load_dwordx4 v133, s[12:15], s32 offen offset:2048 nt lds
    v_lshlrev_b32 v88, 16, v80
    v_and_b32 v89, 0xffff0000, v80
    v_lshlrev_b32 v90, 16, v81
    v_and_b32 v91, 0xffff0000, v81
    v_lshlrev_b32 v92, 16, v82
    v_and_b32 v93, 0xffff0000, v82
    v_lshlrev_b32 v94, 16, v83
    v_and_b32 v95, 0xffff0000, v83
    v_pk_mul_f32 v[88:89], v[88:89], s[38:39]
    v_pk_mul_f32 v[90:91], v[90:91], s[38:39]
    v_pk_mul_f32 v[92:93], v[92:93], s[38:39]
    v_pk_mul_f32 v[94:95], v[94:95], s[38:39]
    v_cvt_pk_bf16_f32 v8, v88, v89
    v_cvt_pk_bf16_f32 v9, v90, v91
    v_cvt_pk_bf16_f32 v10, v92, v93
    v_cvt_pk_bf16_f32 v11, v94, v95
    v_accvgpr_write_b32 a24, v8
    v_accvgpr_write_b32 a25, v9
    v_accvgpr_write_b32 a26, v10
    v_accvgpr_write_b32 a27, v11
    s_waitcnt lgkmcnt(0)
    buffer_load_dwordx4 v134, s[12:15], s32 offen offset:3072 nt lds
    v_lshlrev_b32 v88, 16, v84
    v_and_b32 v89, 0xffff0000, v84
    v_lshlrev_b32 v90, 16, v85
    v_and_b32 v91, 0xffff0000, v85
    v_lshlrev_b32 v92, 16, v86
    v_and_b32 v93, 0xffff0000, v86
    v_lshlrev_b32 v94, 16, v87
    v_and_b32 v95, 0xffff0000, v87
    v_pk_mul_f32 v[88:89], v[88:89], s[38:39]
    v_pk_mul_f32 v[90:91], v[90:91], s[38:39]
    v_pk_mul_f32 v[92:93], v[92:93], s[38:39]
    v_pk_mul_f32 v[94:95], v[94:95], s[38:39]
    v_cvt_pk_bf16_f32 v12, v88, v89
    v_cvt_pk_bf16_f32 v13, v90, v91
    v_cvt_pk_bf16_f32 v14, v92, v93
    v_cvt_pk_bf16_f32 v15, v94, v95
    v_accvgpr_write_b32 a28, v12
    v_accvgpr_write_b32 a29, v13
    v_accvgpr_write_b32 a30, v14
    v_accvgpr_write_b32 a31, v15
    v_mfma_f32_16x16x32_bf16 v[8:11], a[96:99], a[16:19], 0
    v_mfma_f32_16x16x32_bf16 v[8:11], a[100:103], a[20:23], v[8:11]
    v_mfma_f32_16x16x32_bf16 v[8:11], a[104:107], a[24:27], v[8:11]
    v_mfma_f32_16x16x32_bf16 v[8:11], a[108:111], a[28:31], v[8:11]
    v_mfma_f32_16x16x32_bf16 v[12:15], a[124:127], a[28:31], 0
    v_mfma_f32_16x16x32_bf16 v[12:15], a[120:123], a[24:27], v[12:15]
    v_mfma_f32_16x16x32_bf16 v[12:15], a[116:119], a[20:23], v[12:15]
    v_mfma_f32_16x16x32_bf16 v[12:15], a[112:115], a[16:19], v[12:15]
    s_nop 3
    v_max3_f32 v100, v8, v9, v10
    s_nop 6
    v_max3_f32 v101, v11, v12, v13
    s_nop 5
    v_max3_f32 v100, v100, v14, v15
    v_max_f32 v100, v100, v101
    v_mov_b32 v101, v100
    s_nop 1
    v_permlane32_swap_b32 v100, v101
    v_max_f32 v100, v100, v101
    v_mov_b32 v101, v100
    s_nop 1
    v_permlane16_swap_b32 v100, v101
    v_max_f32 v100, v100, v101
    v_sub_f32 v101, 0, v100
    v_sub_f32 v102, 0, v100
    v_sub_f32 v103, 0, v100
    v_sub_f32 v100, 0, v100
    v_pk_add_f32 v[8:9], v[8:9], v[100:101]
    v_pk_add_f32 v[10:11], v[10:11], v[100:101]
    v_pk_add_f32 v[12:13], v[12:13], v[100:101]
    v_pk_add_f32 v[14:15], v[14:15], v[100:101]
    v_exp_f32 v8, v8
    v_exp_f32 v9, v9
    v_exp_f32 v10, v10
    v_cvt_pk_bf16_f32 v52, v8, v9
    v_exp_f32 v11, v11
    v_exp_f32 v12, v12
    v_cvt_pk_bf16_f32 v53, v10, v11
    v_exp_f32 v13, v13
    v_exp_f32 v14, v14
    v_cvt_pk_bf16_f32 v54, v12, v13
    v_exp_f32 v15, v15
    s_nop 0
    v_cvt_pk_bf16_f32 v55, v14, v15
    s_cmp_eq_u32 s29, 0
    s_cbranch_scc0 L_l2
    s_waitcnt vmcnt(0)
L_l2:
    s_waitcnt vmcnt(8)
    ds_read_b128 v[72:75], v136 offset:8192
    ds_read_b128 v[76:79], v137 offset:8192
    ds_read_b128 v[80:83], v138 offset:8192
    ds_read_b128 v[84:87], v139 offset:8192
    s_waitcnt lgkmcnt(3)
    s_add_u32 s32, s32, 4096
    s_add_u32 m0, s31, s32
    s_nop 0
    buffer_load_dwordx4 v133, s[12:15], s32 offen nt lds
    v_lshlrev_b32 v88, 16, v72
    v_and_b32 v89, 0xffff0000, v72
    v_lshlrev_b32 v90, 16, v73
    v_and_b32 v91, 0xffff0000, v73
    v_lshlrev_b32 v92, 16, v74
    v_and_b32 v93, 0xffff0000, v74
    v_lshlrev_b32 v94, 16, v75
    v_and_b32 v95, 0xffff0000, v75
    v_pk_mul_f32 v[88:89], v[88:89], s[38:39]
    v_pk_mul_f32 v[90:91], v[90:91], s[38:39]
    v_pk_mul_f32 v[92:93], v[92:93], s[38:39]
    v_pk_mul_f32 v[94:95], v[94:95], s[38:39]
    v_cvt_pk_bf16_f32 v16, v88, v89
    v_cvt_pk_bf16_f32 v17, v90, v91
    v_cvt_pk_bf16_f32 v18, v92, v93
    v_cvt_pk_bf16_f32 v19, v94, v95
    v_accvgpr_write_b32 a32, v16
    v_accvgpr_write_b32 a33, v17
    v_accvgpr_write_b32 a34, v18
    v_accvgpr_write_b32 a35, v19
    s_waitcnt lgkmcnt(2)
    buffer_load_dwordx4 v134, s[12:15], s32 offen offset:1024 nt lds
    v_lshlrev_b32 v88, 16, v76
    v_and_b32 v89, 0xffff0000, v76
    v_lshlrev_b32 v90, 16, v77
    v_and_b32 v91, 0xffff0000, v77
    v_lshlrev_b32 v92, 16, v78
    v_and_b32 v93, 0xffff0000, v78
    v_lshlrev_b32 v94, 16, v79
    v_and_b32 v95, 0xffff0000, v79
    v_pk_mul_f32 v[88:89], v[88:89], s[38:39]
    v_pk_mul_f32 v[90:91], v[90:91], s[38:39]
    v_pk_mul_f32 v[92:93], v[92:93], s[38:39]
    v_pk_mul_f32 v[94:95], v[94:95], s[38:39]
    v_cvt_pk_bf16_f32 v20, v88, v89
    v_cvt_pk_bf16_f32 v21, v90, v91
    v_cvt_pk_bf16_f32 v22, v92, v93
    v_cvt_pk_bf16_f32 v23, v94, v95
    v_accvgpr_write_b32 a36, v20
    v_accvgpr_write_b32 a37, v21
    v_accvgpr_write_b32 a38, v22
    v_accvgpr_write_b32 a39, v23
    s_waitcnt lgkmcnt(1)
    buffer_load_dwordx4 v133, s[12:15], s32 offen offset:2048 nt lds
    v_lshlrev_b32 v88, 16, v80
    v_and_b32 v89, 0xffff0000, v80
    v_lshlrev_b32 v90, 16, v81
    v_and_b32 v91, 0xffff0000, v81
    v_lshlrev_b32 v92, 16, v82
    v_and_b32 v93, 0xffff0000, v82
    v_lshlrev_b32 v94, 16, v83
    v_and_b32 v95, 0xffff0000, v83
    v_pk_mul_f32 v[88:89], v[88:89], s[38:39]
    v_pk_mul_f32 v[90:91], v[90:91], s[38:39]
    v_pk_mul_f32 v[92:93], v[92:93], s[38:39]
    v_pk_mul_f32 v[94:95], v[94:95], s[38:39]
    v_cvt_pk_bf16_f32 v16, v88, v89
    v_cvt_pk_bf16_f32 v17, v90, v91
    v_cvt_pk_bf16_f32 v18, v92, v93
    v_cvt_pk_bf16_f32 v19, v94, v95
    v_accvgpr_write_b32 a40, v16
    v_accvgpr_write_b32 a41, v17
    v_accvgpr_write_b32 a42, v18
    v_accvgpr_write_b32 a43, v19
    s_waitcnt lgkmcnt(0)
    buffer_load_dwordx4 v134, s[12:15], s32 offen offset:3072 nt lds
    v_lshlrev_b32 v88, 16, v84
    v_and_b32 v89, 0xffff0000, v84
    v_lshlrev_b32 v90, 16, v85
    v_and_b32 v91, 0xffff0000, v85
    v_lshlrev_b32 v92, 16, v86
    v_and_b32 v93, 0xffff0000, v86
    v_lshlrev_b32 v94, 16, v87
    v_and_b32 v95, 0xffff0000, v87
    v_pk_mul_f32 v[88:89], v[88:89], s[38:39]
    v_pk_mul_f32 v[90:91], v[90:91], s[38:39]
    v_pk_mul_f32 v[92:93], v[92:93], s[38:39]
    v_pk_mul_f32 v[94:95], v[94:95], s[38:39]
    v_cvt_pk_bf16_f32 v20, v88, v89
    v_cvt_pk_bf16_f32 v21, v90, v91
    v_cvt_pk_bf16_f32 v22, v92, v93
    v_cvt_pk_bf16_f32 v23, v94, v95
    v_accvgpr_write_b32 a44, v20
    v_accvgpr_write_b32 a45, v21
    v_accvgpr_write_b32 a46, v22
    v_accvgpr_write_b32 a47, v23
    v_mfma_f32_16x16x32_bf16 v[16:19], a[96:99], a[32:35], 0
    v_mfma_f32_16x16x32_bf16 v[16:19], a[100:103], a[36:39], v[16:19]
    v_mfma_f32_16x16x32_bf16 v[16:19], a[104:107], a[40:43], v[16:19]
    v_mfma_f32_16x16x32_bf16 v[16:19], a[108:111], a[44:47], v[16:19]
    v_mfma_f32_16x16x32_bf16 v[20:23], a[124:127], a[44:47], 0
    v_mfma_f32_16x16x32_bf16 v[20:23], a[120:123], a[40:43], v[20:23]
    v_mfma_f32_16x16x32_bf16 v[20:23], a[116:119], a[36:39], v[20:23]
    v_mfma_f32_16x16x32_bf16 v[20:23], a[112:115], a[32:35], v[20:23]
    s_nop 3
    v_max3_f32 v104, v16, v17, v18
    s_nop 6
    v_max3_f32 v105, v19, v20, v21
    s_nop 5
    v_max3_f32 v104, v104, v22, v23
    v_max_f32 v104, v104, v105
    v_mov_b32 v105, v104
    s_nop 1
    v_permlane32_swap_b32 v104, v105
    v_max_f32 v104, v104, v105
    v_mov_b32 v105, v104
    s_nop 1
    v_permlane16_swap_b32 v104, v105
    v_max_f32 v104, v104, v105
    v_sub_f32 v105, 0, v104
    v_sub_f32 v106, 0, v104
    v_sub_f32 v107, 0, v104
    v_sub_f32 v104, 0, v104
    v_pk_add_f32 v[16:17], v[16:17], v[104:105]
    v_pk_add_f32 v[18:19], v[18:19], v[104:105]
    v_pk_add_f32 v[20:21], v[20:21], v[104:105]
    v_pk_add_f32 v[22:23], v[22:23], v[104:105]
    v_exp_f32 v16, v16
    v_exp_f32 v17, v17
    v_exp_f32 v18, v18
    v_cvt_pk_bf16_f32 v56, v16, v17
    v_exp_f32 v19, v19
    v_exp_f32 v20, v20
    v_cvt_pk_bf16_f32 v57, v18, v19
    v_exp_f32 v21, v21
    v_exp_f32 v22, v22
    v_cvt_pk_bf16_f32 v58, v20, v21
    v_exp_f32 v23, v23
    s_nop 0
    v_cvt_pk_bf16_f32 v59, v22, v23
    s_cmp_eq_u32 s29, 0
    s_cbranch_scc0 L_l3
    s_add_u32 s32, s32, 4096
    s_add_u32 m0, s31, s32
    s_nop 0
    buffer_load_dwordx4 v133, s[12:15], s32 offen nt lds
    buffer_load_dwordx4 v134, s[12:15], s32 offen offset:1024 nt lds
    buffer_load_dwordx4 v133, s[12:15], s32 offen offset:2048 nt lds
    buffer_load_dwordx4 v134, s[12:15], s32 offen offset:3072 nt lds
    s_add_u32 s32, s32, 4096
    s_add_u32 m0, s31, s32
    s_nop 0
    buffer_load_dwordx4 v133, s[12:15], s32 offen nt lds
    buffer_load_dwordx4 v134, s[12:15], s32 offen offset:1024 nt lds
    buffer_load_dwordx4 v133, s[12:15], s32 offen offset:2048 nt lds
    buffer_load_dwordx4 v134, s[12:15], s32 offen offset:3072 nt lds
L_l3:
    s_waitcnt vmcnt(8)
    ds_read_b128 v[72:75], v136 offset:12288
    ds_read_b128 v[76:79], v137 offset:12288
    ds_read_b128 v[80:83], v138 offset:12288
    ds_read_b128 v[84:87], v139 offset:12288
    s_waitcnt lgkmcnt(3)
    s_add_u32 m0, s30, 49152
    s_nop 0
    global_load_lds_dwordx4 v132, s[16:17] nt
    v_lshlrev_b32 v88, 16, v72
    v_and_b32 v89, 0xffff0000, v72
    v_lshlrev_b32 v90, 16, v73
    v_and_b32 v91, 0xffff0000, v73
    v_lshlrev_b32 v92, 16, v74
    v_and_b32 v93, 0xffff0000, v74
    v_lshlrev_b32 v94, 16, v75
    v_and_b32 v95, 0xffff0000, v75
    v_pk_mul_f32 v[88:89], v[88:89], s[38:39]
    v_pk_mul_f32 v[90:91], v[90:91], s[38:39]
    v_pk_mul_f32 v[92:93], v[92:93], s[38:39]
    v_pk_mul_f32 v[94:95], v[94:95], s[38:39]
    v_cvt_pk_bf16_f32 v24, v88, v89
    v_cvt_pk_bf16_f32 v25, v90, v91
    v_cvt_pk_bf16_f32 v26, v92, v93
    v_cvt_pk_bf16_f32 v27, v94, v95
    v_accvgpr_write_b32 a48, v24
    v_accvgpr_write_b32 a49, v25
    v_accvgpr_write_b32 a50, v26
    v_accvgpr_write_b32 a51, v27
L_pad1:
    s_cbranch_vccz L_padret0
    s_waitcnt lgkmcnt(2)
    global_load_lds_dwordx4 v132, s[16:17] offset:2048 nt
    v_lshlrev_b32 v88, 16, v76
    v_and_b32 v89, 0xffff0000, v76
    v_lshlrev_b32 v90, 16, v77
    v_and_b32 v91, 0xffff0000, v77
    v_lshlrev_b32 v92, 16, v78
    v_and_b32 v93, 0xffff0000, v78
    v_lshlrev_b32 v94, 16, v79
    v_and_b32 v95, 0xffff0000, v79
    v_pk_mul_f32 v[88:89], v[88:89], s[38:39]
    v_pk_mul_f32 v[90:91], v[90:91], s[38:39]
    v_pk_mul_f32 v[92:93], v[92:93], s[38:39]
    v_pk_mul_f32 v[94:95], v[94:95], s[38:39]
    v_cvt_pk_bf16_f32 v28, v88, v89
    v_cvt_pk_bf16_f32 v29, v90, v91
    v_cvt_pk_bf16_f32 v30, v92, v93
    v_cvt_pk_bf16_f32 v31, v94, v95
    v_accvgpr_write_b32 a52, v28
    v_accvgpr_write_b32 a53, v29
    v_accvgpr_write_b32 a54, v30
    v_accvgpr_write_b32 a55, v31
    s_waitcnt lgkmcnt(1)
    v_add_u32 v132, 8192, v132
    s_add_u32 m0, s30, 0
    s_nop 0
    global_load_lds_dwordx4 v132, s[22:23] offset:1024 nt
    v_lshlrev_b32 v88, 16, v80
    v_and_b32 v89, 0xffff0000, v80
    v_lshlrev_b32 v90, 16, v81
    v_and_b32 v91, 0xffff0000, v81
    v_lshlrev_b32 v92, 16, v82
    v_and_b32 v93, 0xffff0000, v82
    v_lshlrev_b32 v94, 16, v83
    v_and_b32 v95, 0xffff0000, v83
    v_pk_mul_f32 v[88:89], v[88:89], s[38:39]
    v_pk_mul_f32 v[90:91], v[90:91], s[38:39]
    v_pk_mul_f32 v[92:93], v[92:93], s[38:39]
    v_pk_mul_f32 v[94:95], v[94:95], s[38:39]
    v_cvt_pk_bf16_f32 v24, v88, v89
    v_cvt_pk_bf16_f32 v25, v90, v91
    v_cvt_pk_bf16_f32 v26, v92, v93
    v_cvt_pk_bf16_f32 v27, v94, v95
    v_accvgpr_write_b32 a56, v24
    v_accvgpr_write_b32 a57, v25
    v_accvgpr_write_b32 a58, v26
    v_accvgpr_write_b32 a59, v27
    s_waitcnt lgkmcnt(0)
    global_load_lds_dwordx4 v132, s[22:23] offset:3072 nt
    v_lshlrev_b32 v88, 16, v84
    v_and_b32 v89, 0xffff0000, v84
    v_lshlrev_b32 v90, 16, v85
    v_and_b32 v91, 0xffff0000, v85
    v_lshlrev_b32 v92, 16, v86
    v_and_b32 v93, 0xffff0000, v86
    v_lshlrev_b32 v94, 16, v87
    v_and_b32 v95, 0xffff0000, v87
    v_pk_mul_f32 v[88:89], v[88:89], s[38:39]
    v_pk_mul_f32 v[90:91], v[90:91], s[38:39]
    v_pk_mul_f32 v[92:93], v[92:93], s[38:39]
    v_pk_mul_f32 v[94:95], v[94:95], s[38:39]
    v_cvt_pk_bf16_f32 v28, v88, v89
    v_cvt_pk_bf16_f32 v29, v90, v91
    v_cvt_pk_bf16_f32 v30, v92, v93
    v_cvt_pk_bf16_f32 v31, v94, v95
    v_accvgpr_write_b32 a60, v28
    v_accvgpr_write_b32 a61, v29
    v_accvgpr_write_b32 a62, v30
    v_accvgpr_write_b32 a63, v31
    v_mfma_f32_16x16x32_bf16 v[24:27], a[96:99], a[48:51], 0
    v_mfma_f32_16x16x32_bf16 v[24:27], a[100:103], a[52:55], v[24:27]
    v_mfma_f32_16x16x32_bf16 v[24:27], a[104:107], a[56:59], v[24:27]
    v_mfma_f32_16x16x32_bf16 v[24:27], a[108:111], a[60:63], v[24:27]
    v_mfma_f32_16x16x32_bf16 v[28:31], a[124:127], a[60:63], 0
    v_mfma_f32_16x16x32_bf16 v[28:31], a[120:123], a[56:59], v[28:31]
    v_mfma_f32_16x16x32_bf16 v[28:31], a[116:119], a[52:55], v[28:31]
    v_mfma_f32_16x16x32_bf16 v[28:31], a[112:115], a[48:51], v[28:31]
    s_nop 3
    v_max3_f32 v108, v24, v25, v26
    s_nop 6
    v_max3_f32 v109, v27, v28, v29
    s_nop 5
    v_max3_f32 v108, v108, v30, v31
    v_max_f32 v108, v108, v109
    v_mov_b32 v109, v108
    s_nop 1
    v_permlane32_swap_b32 v108, v109
    v_max_f32 v108, v108, v109
    v_mov_b32 v109, v108
    s_nop 1
    v_permlane16_swap_b32 v108, v109
    v_max_f32 v108, v108, v109
    v_sub_f32 v109, 0, v108
    v_sub_f32 v110, 0, v108
    v_sub_f32 v111, 0, v108
    v_sub_f32 v108, 0, v108
    v_pk_add_f32 v[24:25], v[24:25], v[108:109]
    v_pk_add_f32 v[26:27], v[26:27], v[108:109]
    v_pk_add_f32 v[28:29], v[28:29], v[108:109]
    v_pk_add_f32 v[30:31], v[30:31], v[108:109]
    v_exp_f32 v24, v24
    v_exp_f32 v25, v25
    v_exp_f32 v26, v26
    v_cvt_pk_bf16_f32 v60, v24, v25
    v_exp_f32 v27, v27
    v_exp_f32 v28, v28
    v_cvt_pk_bf16_f32 v61, v26, v27
    v_exp_f32 v29, v29
    v_exp_f32 v30, v30
    v_cvt_pk_bf16_f32 v62, v28, v29
    v_exp_f32 v31, v31
    s_nop 0
    v_cvt_pk_bf16_f32 v63, v30, v31
    s_waitcnt vmcnt(8)
    ds_read_b128 v[72:75], v136 offset:16384
    ds_read_b128 v[76:79], v137 offset:16384
    ds_read_b128 v[80:83], v138 offset:16384
    ds_read_b128 v[84:87], v139 offset:16384
    s_waitcnt lgkmcnt(3)
    global_load_lds_dwordx4 v132, s[16:17] nt
    v_lshlrev_b32 v88, 16, v72
    v_and_b32 v89, 0xffff0000, v72
    v_lshlrev_b32 v90, 16, v73
    v_and_b32 v91, 0xffff0000, v73
    v_lshlrev_b32 v92, 16, v74
    v_and_b32 v93, 0xffff0000, v74
    v_lshlrev_b32 v94, 16, v75
    v_and_b32 v95, 0xffff0000, v75
    v_pk_mul_f32 v[88:89], v[88:89], s[38:39]
    v_pk_mul_f32 v[90:91], v[90:91], s[38:39]
    v_pk_mul_f32 v[92:93], v[92:93], s[38:39]
    v_pk_mul_f32 v[94:95], v[94:95], s[38:39]
    v_cvt_pk_bf16_f32 v32, v88, v89
    v_cvt_pk_bf16_f32 v33, v90, v91
    v_cvt_pk_bf16_f32 v34, v92, v93
    v_cvt_pk_bf16_f32 v35, v94, v95
    v_accvgpr_write_b32 a64, v32
    v_accvgpr_write_b32 a65, v33
    v_accvgpr_write_b32 a66, v34
    v_accvgpr_write_b32 a67, v35
    s_waitcnt lgkmcnt(2)
    global_load_lds_dwordx4 v132, s[16:17] offset:2048 nt
    v_add_u32 v132, 8192, v132
    v_lshlrev_b32 v88, 16, v76
    v_and_b32 v89, 0xffff0000, v76
    v_lshlrev_b32 v90, 16, v77
    v_and_b32 v91, 0xffff0000, v77
    v_lshlrev_b32 v92, 16, v78
    v_and_b32 v93, 0xffff0000, v78
    v_lshlrev_b32 v94, 16, v79
    v_and_b32 v95, 0xffff0000, v79
    v_pk_mul_f32 v[88:89], v[88:89], s[38:39]
    v_pk_mul_f32 v[90:91], v[90:91], s[38:39]
    v_pk_mul_f32 v[92:93], v[92:93], s[38:39]
    v_pk_mul_f32 v[94:95], v[94:95], s[38:39]
    v_cvt_pk_bf16_f32 v36, v88, v89
    v_cvt_pk_bf16_f32 v37, v90, v91
    v_cvt_pk_bf16_f32 v38, v92, v93
    v_cvt_pk_bf16_f32 v39, v94, v95
    v_accvgpr_write_b32 a68, v36
    v_accvgpr_write_b32 a69, v37
    v_accvgpr_write_b32 a70, v38
    v_accvgpr_write_b32 a71, v39
    s_waitcnt lgkmcnt(1)
    v_lshlrev_b32 v88, 16, v80
    v_and_b32 v89, 0xffff0000, v80
    v_lshlrev_b32 v90, 16, v81
    v_and_b32 v91, 0xffff0000, v81
    v_lshlrev_b32 v92, 16, v82
    v_and_b32 v93, 0xffff0000, v82
    v_lshlrev_b32 v94, 16, v83
    v_and_b32 v95, 0xffff0000, v83
    v_pk_mul_f32 v[88:89], v[88:89], s[38:39]
    v_pk_mul_f32 v[90:91], v[90:91], s[38:39]
    v_pk_mul_f32 v[92:93], v[92:93], s[38:39]
    v_pk_mul_f32 v[94:95], v[94:95], s[38:39]
    v_cvt_pk_bf16_f32 v32, v88, v89
    v_cvt_pk_bf16_f32 v33, v90, v91
    v_cvt_pk_bf16_f32 v34, v92, v93
    v_cvt_pk_bf16_f32 v35, v94, v95
    v_accvgpr_write_b32 a72, v32
    v_accvgpr_write_b32 a73, v33
    v_accvgpr_write_b32 a74, v34
    v_accvgpr_write_b32 a75, v35
    s_waitcnt lgkmcnt(0)
    v_lshlrev_b32 v88, 16, v84
    v_and_b32 v89, 0xffff0000, v84
    v_lshlrev_b32 v90, 16, v85
    v_and_b32 v91, 0xffff0000, v85
    v_lshlrev_b32 v92, 16, v86
    v_and_b32 v93, 0xffff0000, v86
    v_lshlrev_b32 v94, 16, v87
    v_and_b32 v95, 0xffff0000, v87
    v_pk_mul_f32 v[88:89], v[88:89], s[38:39]
    v_pk_mul_f32 v[90:91], v[90:91], s[38:39]
    v_pk_mul_f32 v[92:93], v[92:93], s[38:39]
    v_pk_mul_f32 v[94:95], v[94:95], s[38:39]
    v_cvt_pk_bf16_f32 v36, v88, v89
    v_cvt_pk_bf16_f32 v37, v90, v91
    v_cvt_pk_bf16_f32 v38, v92, v93
    v_cvt_pk_bf16_f32 v39, v94, v95
    v_accvgpr_write_b32 a76, v36
    v_accvgpr_write_b32 a77, v37
    v_accvgpr_write_b32 a78, v38
    v_accvgpr_write_b32 a79, v39
    v_mfma_f32_16x16x32_bf16 v[32:35], a[96:99], a[64:67], 0
    v_mfma_f32_16x16x32_bf16 v[32:35], a[100:103], a[68:71], v[32:35]
    v_mfma_f32_16x16x32_bf16 v[32:35], a[104:107], a[72:75], v[32:35]
    v_mfma_f32_16x16x32_bf16 v[32:35], a[108:111], a[76:79], v[32:35]
    v_mfma_f32_16x16x32_bf16 v[36:39], a[124:127], a[76:79], 0
    v_mfma_f32_16x16x32_bf16 v[36:39], a[120:123], a[72:75], v[36:39]
    v_mfma_f32_16x16x32_bf16 v[36:39], a[116:119], a[68:71], v[36:39]
    v_mfma_f32_16x16x32_bf16 v[36:39], a[112:115], a[64:67], v[36:39]
    s_nop 3
    v_max3_f32 v112, v32, v33, v34
    s_nop 6
    v_max3_f32 v113, v35, v36, v37
    s_nop 5
    v_max3_f32 v112, v112, v38, v39
    v_max_f32 v112, v112, v113
    v_mov_b32 v113, v112
    s_nop 1
    v_permlane32_swap_b32 v112, v113
    v_max_f32 v112, v112, v113
    v_mov_b32 v113, v112
    s_nop 1
    v_permlane16_swap_b32 v112, v113
    v_max_f32 v112, v112, v113
    v_sub_f32 v113, 0, v112
    v_sub_f32 v114, 0, v112
    v_sub_f32 v115, 0, v112
    v_sub_f32 v112, 0, v112
    v_pk_add_f32 v[32:33], v[32:33], v[112:113]
    v_pk_add_f32 v[34:35], v[34:35], v[112:113]
    v_pk_add_f32 v[36:37], v[36:37], v[112:113]
    v_pk_add_f32 v[38:39], v[38:39], v[112:113]
    v_exp_f32 v32, v32
    v_exp_f32 v33, v33
    v_exp_f32 v34, v34
    v_cvt_pk_bf16_f32 v64, v32, v33
    v_exp_f32 v35, v35
    v_exp_f32 v36, v36
    v_cvt_pk_bf16_f32 v65, v34, v35
    v_exp_f32 v37, v37
    v_exp_f32 v38, v38
    v_cvt_pk_bf16_f32 v66, v36, v37
    v_exp_f32 v39, v39
    s_nop 0
    v_cvt_pk_bf16_f32 v67, v38, v39
    s_waitcnt vmcnt(6)
    ds_read_b128 v[72:75], v136 offset:20480
    ds_read_b128 v[76:79], v137 offset:20480
    ds_read_b128 v[80:83], v138 offset:20480
    ds_read_b128 v[84:87], v139 offset:20480
    s_waitcnt lgkmcnt(3)
    v_lshlrev_b32 v88, 16, v72
    v_and_b32 v89, 0xffff0000, v72
    v_lshlrev_b32 v90, 16, v73
    v_and_b32 v91, 0xffff0000, v73
    v_lshlrev_b32 v92, 16, v74
    v_and_b32 v93, 0xffff0000, v74
    v_lshlrev_b32 v94, 16, v75
    v_and_b32 v95, 0xffff0000, v75
    v_pk_mul_f32 v[88:89], v[88:89], s[38:39]
    v_pk_mul_f32 v[90:91], v[90:91], s[38:39]
    v_pk_mul_f32 v[92:93], v[92:93], s[38:39]
    v_pk_mul_f32 v[94:95], v[94:95], s[38:39]
    v_cvt_pk_bf16_f32 v40, v88, v89
    v_cvt_pk_bf16_f32 v41, v90, v91
    v_cvt_pk_bf16_f32 v42, v92, v93
    v_cvt_pk_bf16_f32 v43, v94, v95
    v_accvgpr_write_b32 a80, v40
    v_accvgpr_write_b32 a81, v41
    v_accvgpr_write_b32 a82, v42
    v_accvgpr_write_b32 a83, v43
    s_waitcnt lgkmcnt(2)
    v_lshlrev_b32 v88, 16, v76
    v_and_b32 v89, 0xffff0000, v76
    v_lshlrev_b32 v90, 16, v77
    v_and_b32 v91, 0xffff0000, v77
    v_lshlrev_b32 v92, 16, v78
    v_and_b32 v93, 0xffff0000, v78
    v_lshlrev_b32 v94, 16, v79
    v_and_b32 v95, 0xffff0000, v79
    v_pk_mul_f32 v[88:89], v[88:89], s[38:39]
    v_pk_mul_f32 v[90:91], v[90:91], s[38:39]
    v_pk_mul_f32 v[92:93], v[92:93], s[38:39]
    v_pk_mul_f32 v[94:95], v[94:95], s[38:39]
    v_cvt_pk_bf16_f32 v44, v88, v89
    v_cvt_pk_bf16_f32 v45, v90, v91
    v_cvt_pk_bf16_f32 v46, v92, v93
    v_cvt_pk_bf16_f32 v47, v94, v95
    v_accvgpr_write_b32 a84, v44
    v_accvgpr_write_b32 a85, v45
    v_accvgpr_write_b32 a86, v46
    v_accvgpr_write_b32 a87, v47
    s_waitcnt lgkmcnt(1)
    v_lshlrev_b32 v88, 16, v80
    v_and_b32 v89, 0xffff0000, v80
    v_lshlrev_b32 v90, 16, v81
    v_and_b32 v91, 0xffff0000, v81
    v_lshlrev_b32 v92, 16, v82
    v_and_b32 v93, 0xffff0000, v82
    v_lshlrev_b32 v94, 16, v83
    v_and_b32 v95, 0xffff0000, v83
    v_pk_mul_f32 v[88:89], v[88:89], s[38:39]
    v_pk_mul_f32 v[90:91], v[90:91], s[38:39]
    v_pk_mul_f32 v[92:93], v[92:93], s[38:39]
    v_pk_mul_f32 v[94:95], v[94:95], s[38:39]
    v_cvt_pk_bf16_f32 v40, v88, v89
    v_cvt_pk_bf16_f32 v41, v90, v91
    v_cvt_pk_bf16_f32 v42, v92, v93
    v_cvt_pk_bf16_f32 v43, v94, v95
    v_accvgpr_write_b32 a88, v40
    v_accvgpr_write_b32 a89, v41
    v_accvgpr_write_b32 a90, v42
    v_accvgpr_write_b32 a91, v43
    s_waitcnt lgkmcnt(0)
    v_lshlrev_b32 v88, 16, v84
    v_and_b32 v89, 0xffff0000, v84
    v_lshlrev_b32 v90, 16, v85
    v_and_b32 v91, 0xffff0000, v85
    v_lshlrev_b32 v92, 16, v86
    v_and_b32 v93, 0xffff0000, v86
    v_lshlrev_b32 v94, 16, v87
    v_and_b32 v95, 0xffff0000, v87
    v_pk_mul_f32 v[88:89], v[88:89], s[38:39]
    v_pk_mul_f32 v[90:91], v[90:91], s[38:39]
    v_pk_mul_f32 v[92:93], v[92:93], s[38:39]
    v_pk_mul_f32 v[94:95], v[94:95], s[38:39]
    v_cvt_pk_bf16_f32 v44, v88, v89
    v_cvt_pk_bf16_f32 v45, v90, v91
    v_cvt_pk_bf16_f32 v46, v92, v93
    v_cvt_pk_bf16_f32 v47, v94, v95
    v_accvgpr_write_b32 a92, v44
    v_accvgpr_write_b32 a93, v45
    v_accvgpr_write_b32 a94, v46
    v_accvgpr_write_b32 a95, v47
    v_mfma_f32_16x16x32_bf16 v[40:43], a[96:99], a[80:83], 0
    v_mfma_f32_16x16x32_bf16 v[40:43], a[100:103], a[84:87], v[40:43]
    v_mfma_f32_16x16x32_bf16 v[40:43], a[104:107], a[88:91], v[40:43]
    v_mfma_f32_16x16x32_bf16 v[40:43], a[108:111], a[92:95], v[40:43]
    s_waitcnt vmcnt(4)
    s_barrier
    v_mfma_f32_16x16x32_bf16 v[44:47], a[124:127], a[92:95], 0
    ds_read_b128 a[96:99], v120 offset:49152
    v_mfma_f32_16x16x32_bf16 v[44:47], a[120:123], a[88:91], v[44:47]
    ds_read_b128 a[100:103], v121 offset:49152
    v_mfma_f32_16x16x32_bf16 v[44:47], a[116:119], a[84:87], v[44:47]
    ds_read_b128 a[104:107], v122 offset:49152
    v_mfma_f32_16x16x32_bf16 v[44:47], a[112:115], a[80:83], v[44:47]
    ds_read_b128 a[108:111], v123 offset:49152
    s_mov_b32 s32, s31
    s_mov_b32 s3, 1
    v_max3_f32 v116, v40, v41, v42
    s_nop 3
    v_max3_f32 v117, v43, v44, v45
    s_nop 2
    v_max3_f32 v116, v116, v46, v47
    v_max_f32 v116, v116, v117
    s_waitcnt lgkmcnt(0)
    v_mfma_f32_16x16x32_bf16 v[0:3], a[96:99], a[0:3], v[96:99]
    v_mov_b32 v117, v116
    v_mfma_f32_16x16x32_bf16 v[0:3], a[100:103], a[4:7], v[0:3]
    ds_read_b128 a[112:115], v120 offset:57344
    v_mfma_f32_16x16x32_bf16 v[0:3], a[104:107], a[8:11], v[0:3]
    v_permlane32_swap_b32 v116, v117
    v_mfma_f32_16x16x32_bf16 v[0:3], a[108:111], a[12:15], v[0:3]
    v_max_f32 v116, v116, v117
    v_mov_b32 v117, v116
    v_mfma_f32_16x16x32_bf16 v[8:11], a[108:111], a[28:31], v[100:103]
    s_nop 0
    v_permlane16_swap_b32 v116, v117
    v_mfma_f32_16x16x32_bf16 v[8:11], a[104:107], a[24:27], v[8:11]
    v_max_f32 v116, v116, v117
    v_sub_f32 v117, 0, v116
    v_mfma_f32_16x16x32_bf16 v[8:11], a[100:103], a[20:23], v[8:11]
    ds_read_b128 a[116:119], v121 offset:57344
    v_sub_f32 v118, 0, v116
    v_mfma_f32_16x16x32_bf16 v[8:11], a[96:99], a[16:19], v[8:11]
    v_sub_f32 v119, 0, v116
    v_sub_f32 v116, 0, v116
    v_mfma_f32_16x16x32_bf16 v[16:19], a[96:99], a[32:35], v[104:107]
    v_add_f32 v40, v40, v117
    v_add_f32 v41, v41, v117
    v_mfma_f32_16x16x32_bf16 v[16:19], a[100:103], a[36:39], v[16:19]
    v_add_f32 v42, v42, v117
    v_add_f32 v43, v43, v117
    v_mfma_f32_16x16x32_bf16 v[16:19], a[104:107], a[40:43], v[16:19]
    v_add_f32 v44, v44, v117
    v_add_f32 v45, v45, v117
    v_mfma_f32_16x16x32_bf16 v[16:19], a[108:111], a[44:47], v[16:19]
    ds_read_b128 a[120:123], v122 offset:57344
    v_add_f32 v46, v46, v117
    v_mfma_f32_16x16x32_bf16 v[24:27], a[108:111], a[60:63], v[108:111]
    v_add_f32 v47, v47, v117
    v_mfma_f32_16x16x32_bf16 v[24:27], a[104:107], a[56:59], v[24:27]
    ds_read_b128 a[124:127], v123 offset:57344
    v_mfma_f32_16x16x32_bf16 v[24:27], a[100:103], a[52:55], v[24:27]
    v_exp_f32 v43, v43
    v_mfma_f32_16x16x32_bf16 v[24:27], a[96:99], a[48:51], v[24:27]
    v_exp_f32 v40, v40
    v_mfma_f32_16x16x32_bf16 v[32:35], a[96:99], a[64:67], v[112:115]
    v_exp_f32 v47, v47
    v_mfma_f32_16x16x32_bf16 v[32:35], a[100:103], a[68:71], v[32:35]
    v_exp_f32 v41, v41
    v_mfma_f32_16x16x32_bf16 v[32:35], a[104:107], a[72:75], v[32:35]
    v_exp_f32 v42, v42
    v_mfma_f32_16x16x32_bf16 v[32:35], a[108:111], a[76:79], v[32:35]
    v_cvt_pk_bf16_f32 v68, v40, v41
    v_cvt_pk_bf16_f32 v69, v42, v43
    v_mfma_f32_16x16x32_bf16 v[40:43], a[108:111], a[92:95], v[116:119]
    v_exp_f32 v3, v3
    v_mfma_f32_16x16x32_bf16 v[40:43], a[104:107], a[88:91], v[40:43]
    v_exp_f32 v0, v0
    v_mfma_f32_16x16x32_bf16 v[40:43], a[100:103], a[84:87], v[40:43]
    v_exp_f32 v8, v8
    v_mfma_f32_16x16x32_bf16 v[40:43], a[96:99], a[80:83], v[40:43]
    s_waitcnt vmcnt(2) lgkmcnt(0)
    s_barrier
    v_mfma_f32_16x16x32_bf16 v[4:7], a[112:115], a[0:3], v[96:99]
    v_exp_f32 v1, v1
    v_mfma_f32_16x16x32_bf16 v[4:7], a[116:119], a[4:7], v[4:7]
    v_exp_f32 v44, v44
    v_mfma_f32_16x16x32_bf16 v[4:7], a[120:123], a[8:11], v[4:7]
    v_exp_f32 v45, v45
    v_mfma_f32_16x16x32_bf16 v[4:7], a[124:127], a[12:15], v[4:7]
    v_exp_f32 v9, v9
    v_mfma_f32_16x16x32_bf16 v[12:15], a[124:127], a[28:31], v[100:103]
    ds_read_b64_tr_b16 a[96:97], v124
    v_mfma_f32_16x16x32_bf16 v[12:15], a[120:123], a[24:27], v[12:15]
    v_exp_f32 v17, v17
    v_mfma_f32_16x16x32_bf16 v[12:15], a[116:119], a[20:23], v[12:15]
    ds_read_b64_tr_b16 a[98:99], v124 offset:8192
    v_mfma_f32_16x16x32_bf16 v[12:15], a[112:115], a[16:19], v[12:15]
    ds_read_b64_tr_b16 a[100:101], v125
    v_cvt_pk_bf16_f32 v72, v0, v1
    v_mfma_f32_16x16x32_bf16 v[20:23], a[112:115], a[32:35], v[104:107]
    v_exp_f32 v46, v46
    v_mfma_f32_16x16x32_bf16 v[20:23], a[116:119], a[36:39], v[20:23]
    s_add_u32 m0, s30, 16384
    v_mfma_f32_16x16x32_bf16 v[20:23], a[120:123], a[40:43], v[20:23]
    ds_read_b64_tr_b16 a[102:103], v125 offset:8192
    v_mfma_f32_16x16x32_bf16 v[20:23], a[124:127], a[44:47], v[20:23]
    global_load_lds_dwordx4 v132, s[22:23] offset:1024 nt
    v_mfma_f32_16x16x32_bf16 v[28:31], a[124:127], a[60:63], v[108:111]
    v_exp_f32 v16, v16
    v_mfma_f32_16x16x32_bf16 v[28:31], a[120:123], a[56:59], v[28:31]
    v_exp_f32 v2, v2
    v_mfma_f32_16x16x32_bf16 v[28:31], a[116:119], a[52:55], v[28:31]
    ds_read_b64_tr_b16 a[104:105], v126
    v_cvt_pk_bf16_f32 v70, v44, v45
    v_mfma_f32_16x16x32_bf16 v[28:31], a[112:115], a[48:51], v[28:31]
    v_cvt_pk_bf16_f32 v71, v46, v47
    v_mfma_f32_16x16x32_bf16 v[36:39], a[112:115], a[64:67], v[112:115]
    global_load_lds_dwordx4 v132, s[16:17] nt
    v_mfma_f32_16x16x32_bf16 v[36:39], a[116:119], a[68:71], v[36:39]
    v_exp_f32 v34, v34
    v_mfma_f32_16x16x32_bf16 v[36:39], a[120:123], a[72:75], v[36:39]
    v_exp_f32 v11, v11
    v_mfma_f32_16x16x32_bf16 v[36:39], a[124:127], a[76:79], v[36:39]
    v_exp_f32 v10, v10
    v_mfma_f32_16x16x32_bf16 v[44:47], a[124:127], a[92:95], v[116:119]
    ds_read_b64_tr_b16 a[106:107], v126 offset:8192
    s_waitcnt lgkmcnt(2)
    v_mfma_f32_16x16x32_bf16 v[44:47], a[120:123], a[88:91], v[44:47]
    global_load_lds_dwordx4 v132, s[22:23] offset:3072 nt
    v_mfma_f32_16x16x32_bf16 v[44:47], a[116:119], a[84:87], v[44:47]
    ds_read_b64_tr_b16 a[108:109], v127
    v_mfma_f32_16x16x32_bf16 v[44:47], a[112:115], a[80:83], v[44:47]
    ds_read_b64_tr_b16 a[110:111], v127 offset:8192
    v_cvt_pk_bf16_f32 v76, v8, v9
    v_mfma_f32_16x16x32_bf16 v[144:147], v[48:51], a[96:99], 0
    v_exp_f32 v18, v18
    v_mfma_f32_16x16x32_bf16 a[128:131], v[48:51], a[136:139], 0
    ds_read_b64_tr_b16 a[112:113], v128
    v_mfma_f32_16x16x32_bf16 v[148:151], v[48:51], a[100:103], 0
    global_load_lds_dwordx4 v132, s[16:17] offset:2048 nt
    v_mfma_f32_16x16x32_bf16 v[180:183], v[52:55], a[100:103], 0
    v_exp_f32 v35, v35
    v_mfma_f32_16x16x32_bf16 a[128:131], v[52:55], a[140:143], a[128:131]
    ds_read_b64_tr_b16 a[114:115], v128 offset:8192
    v_mfma_f32_16x16x32_bf16 v[176:179], v[52:55], a[96:99], 0
    v_exp_f32 v33, v33
    v_mfma_f32_16x16x32_bf16 v[208:211], v[56:59], a[96:99], 0
    v_exp_f32 v40, v40
    v_mfma_f32_16x16x32_bf16 v[212:215], v[56:59], a[100:103], 0
    v_exp_f32 v42, v42
    v_mfma_f32_16x16x32_bf16 v[244:247], v[60:63], a[100:103], 0
    ds_read_b64_tr_b16 a[116:117], v129
    s_waitcnt lgkmcnt(3)
    v_mfma_f32_16x16x32_bf16 v[240:243], v[60:63], a[96:99], 0
    ds_read_b64_tr_b16 a[118:119], v129 offset:8192
    v_mfma_f32_16x16x32_bf16 a[192:195], v[64:67], a[96:99], 0
    v_exp_f32 v24, v24
    v_mfma_f32_16x16x32_bf16 a[196:199], v[64:67], a[100:103], 0
    v_exp_f32 v32, v32
    v_mfma_f32_16x16x32_bf16 a[228:231], v[68:71], a[100:103], 0
    ds_read_b64_tr_b16 a[120:121], v130
    v_mfma_f32_16x16x32_bf16 a[224:227], v[68:71], a[96:99], 0
    v_exp_f32 v26, v26
    v_mfma_f32_16x16x32_bf16 a[232:235], v[68:71], a[104:107], 0
    v_exp_f32 v41, v41
    v_mfma_f32_16x16x32_bf16 a[132:135], v[68:71], a[144:147], 0
    ds_read_b64_tr_b16 a[122:123], v130 offset:8192
    v_add_u32 v132, 8192, v132
    v_mfma_f32_16x16x32_bf16 a[236:239], v[68:71], a[108:111], 0
    v_exp_f32 v4, v4
    v_mfma_f32_16x16x32_bf16 a[204:207], v[64:67], a[108:111], 0
    ds_read_b64_tr_b16 a[124:125], v131
    v_cvt_pk_bf16_f32 v77, v10, v11
    v_mfma_f32_16x16x32_bf16 a[132:135], v[64:67], a[140:143], a[132:135]
    v_cvt_pk_bf16_f32 v89, v34, v35
    v_mfma_f32_16x16x32_bf16 a[200:203], v[64:67], a[104:107], 0
    ds_read_b64_tr_b16 a[126:127], v131 offset:8192
    v_mfma_f32_16x16x32_bf16 v[248:251], v[60:63], a[104:107], 0
    v_exp_f32 v27, v27
    v_mfma_f32_16x16x32_bf16 v[252:255], v[60:63], a[108:111], 0
    v_exp_f32 v25, v25
    v_mfma_f32_16x16x32_bf16 v[220:223], v[56:59], a[108:111], 0
    v_exp_f32 v43, v43
    v_mfma_f32_16x16x32_bf16 v[216:219], v[56:59], a[104:107], 0
    v_exp_f32 v19, v19
    v_mfma_f32_16x16x32_bf16 v[184:187], v[52:55], a[104:107], 0
    s_waitcnt vmcnt(4)
    s_barrier
    v_mfma_f32_16x16x32_bf16 v[188:191], v[52:55], a[108:111], 0
    v_exp_f32 v5, v5
    v_mfma_f32_16x16x32_bf16 v[156:159], v[48:51], a[108:111], 0
    v_exp_f32 v28, v28
    v_mfma_f32_16x16x32_bf16 v[152:155], v[48:51], a[104:107], 0
    s_waitcnt lgkmcnt(0)
    v_cvt_pk_bf16_f32 v85, v26, v27
    v_mfma_f32_16x16x32_bf16 v[160:163], v[48:51], a[112:115], 0
    ds_read_b128 a[96:99], v120
    v_cvt_pk_bf16_f32 v92, v40, v41
    v_mfma_f32_16x16x32_bf16 v[164:167], v[48:51], a[116:119], 0
    v_exp_f32 v23, v23
    v_mfma_f32_16x16x32_bf16 v[196:199], v[52:55], a[116:119], 0
    v_cvt_pk_bf16_f32 v73, v2, v3
    v_mfma_f32_16x16x32_bf16 v[192:195], v[52:55], a[112:115], 0
    ds_read_b128 a[100:103], v121
    v_cvt_pk_bf16_f32 v84, v24, v25
    v_mfma_f32_16x16x32_bf16 v[224:227], v[56:59], a[112:115], 0
    v_exp_f32 v15, v15
    v_mfma_f32_16x16x32_bf16 a[128:131], v[56:59], a[144:147], a[128:131]
    v_exp_f32 v6, v6
    v_mfma_f32_16x16x32_bf16 v[228:231], v[56:59], a[116:119], 0
    v_exp_f32 v29, v29
    v_mfma_f32_16x16x32_bf16 a[180:183], v[60:63], a[116:119], 0
    v_exp_f32 v14, v14
    v_mfma_f32_16x16x32_bf16 a[176:179], v[60:63], a[112:115], 0
    v_exp_f32 v12, v12
    v_mfma_f32_16x16x32_bf16 a[208:211], v[64:67], a[112:115], 0
    ds_read_b128 a[104:107], v122
    v_cvt_pk_bf16_f32 v79, v14, v15
    v_mfma_f32_16x16x32_bf16 a[212:215], v[64:67], a[116:119], 0
    v_cvt_pk_bf16_f32 v81, v18, v19
    v_cvt_pk_bf16_f32 v93, v42, v43
    v_mfma_f32_16x16x32_bf16 a[244:247], v[68:71], a[116:119], 0
    v_exp_f32 v13, v13
    v_mfma_f32_16x16x32_bf16 a[240:243], v[68:71], a[112:115], 0
    v_exp_f32 v21, v21
    v_mfma_f32_16x16x32_bf16 a[248:251], v[68:71], a[120:123], 0
    v_exp_f32 v31, v31
    v_mfma_f32_16x16x32_bf16 a[252:255], v[68:71], a[124:127], 0
    v_cvt_pk_bf16_f32 v86, v28, v29
    v_mfma_f32_16x16x32_bf16 a[220:223], v[64:67], a[124:127], 0
    ds_read_b128 a[108:111], v123
    v_cvt_pk_bf16_f32 v88, v32, v33
    v_mfma_f32_16x16x32_bf16 a[216:219], v[64:67], a[120:123], 0
    v_exp_f32 v7, v7
    v_mfma_f32_16x16x32_bf16 a[184:187], v[60:63], a[120:123], 0
    v_exp_f32 v22, v22
    v_mfma_f32_16x16x32_bf16 a[132:135], v[60:63], a[136:139], a[132:135]
    v_cvt_pk_bf16_f32 v75, v6, v7
    v_cvt_pk_bf16_f32 v78, v12, v13
    v_mfma_f32_16x16x32_bf16 a[188:191], v[60:63], a[124:127], 0
    v_mfma_f32_16x16x32_bf16 v[236:239], v[56:59], a[124:127], 0
    v_exp_f32 v30, v30
    v_mfma_f32_16x16x32_bf16 v[232:235], v[56:59], a[120:123], 0
    v_cvt_pk_bf16_f32 v83, v22, v23
    v_cvt_pk_bf16_f32 v87, v30, v31
    v_mfma_f32_16x16x32_bf16 v[200:203], v[52:55], a[120:123], 0
    v_exp_f32 v20, v20
    v_mfma_f32_16x16x32_bf16 v[204:207], v[52:55], a[124:127], 0
    v_cvt_pk_bf16_f32 v74, v4, v5
    v_cvt_pk_bf16_f32 v82, v20, v21
    v_mfma_f32_16x16x32_bf16 v[172:175], v[48:51], a[124:127], 0
    s_waitcnt lgkmcnt(0)
    v_cvt_pk_bf16_f32 v80, v16, v17
    v_mfma_f32_16x16x32_bf16 v[168:171], v[48:51], a[120:123], 0
    v_mfma_f32_16x16x32_bf16 v[0:3], a[96:99], a[0:3], v[96:99]
    v_mfma_f32_16x16x32_bf16 v[0:3], a[100:103], a[4:7], v[0:3]
    ds_read_b128 a[112:115], v120 offset:8192
    v_mfma_f32_16x16x32_bf16 v[0:3], a[104:107], a[8:11], v[0:3]
    v_mfma_f32_16x16x32_bf16 v[0:3], a[108:111], a[12:15], v[0:3]
    v_mfma_f32_16x16x32_bf16 v[8:11], a[108:111], a[28:31], v[100:103]
    v_exp_f32 v37, v37
    v_mfma_f32_16x16x32_bf16 v[8:11], a[104:107], a[24:27], v[8:11]
    v_exp_f32 v36, v36
    v_mfma_f32_16x16x32_bf16 v[8:11], a[100:103], a[20:23], v[8:11]
    ds_read_b128 a[116:119], v121 offset:8192
    v_cvt_pk_bf16_f32 v90, v36, v37
    v_mfma_f32_16x16x32_bf16 v[8:11], a[96:99], a[16:19], v[8:11]
    v_exp_f32 v46, v46
    v_mfma_f32_16x16x32_bf16 v[16:19], a[96:99], a[32:35], v[104:107]
    v_exp_f32 v39, v39
    v_mfma_f32_16x16x32_bf16 v[16:19], a[100:103], a[36:39], v[16:19]
    v_exp_f32 v3, v3
    v_mfma_f32_16x16x32_bf16 v[16:19], a[104:107], a[40:43], v[16:19]
    v_exp_f32 v44, v44
    v_mfma_f32_16x16x32_bf16 v[16:19], a[108:111], a[44:47], v[16:19]
L_pad2:
    s_cbranch_vccz L_padret0
    ds_read_b128 a[120:123], v122 offset:8192
    v_mfma_f32_16x16x32_bf16 v[24:27], a[108:111], a[60:63], v[108:111]
    v_mfma_f32_16x16x32_bf16 v[24:27], a[104:107], a[56:59], v[24:27]
    ds_read_b128 a[124:127], v123 offset:8192
    v_mfma_f32_16x16x32_bf16 v[24:27], a[100:103], a[52:55], v[24:27]
    v_exp_f32 v38, v38
    v_mfma_f32_16x16x32_bf16 v[24:27], a[96:99], a[48:51], v[24:27]
    v_exp_f32 v11, v11
    v_mfma_f32_16x16x32_bf16 v[32:35], a[96:99], a[64:67], v[112:115]
    v_exp_f32 v8, v8
    v_mfma_f32_16x16x32_bf16 v[32:35], a[100:103], a[68:71], v[32:35]
    v_mfma_f32_16x16x32_bf16 v[32:35], a[104:107], a[72:75], v[32:35]
    v_cvt_pk_bf16_f32 v91, v38, v39
    v_mfma_f32_16x16x32_bf16 v[32:35], a[108:111], a[76:79], v[32:35]
    v_exp_f32 v1, v1
    v_mfma_f32_16x16x32_bf16 v[40:43], a[108:111], a[92:95], v[116:119]
    v_exp_f32 v45, v45
    v_mfma_f32_16x16x32_bf16 v[40:43], a[104:107], a[88:91], v[40:43]
    v_exp_f32 v47, v47
    v_mfma_f32_16x16x32_bf16 v[40:43], a[100:103], a[84:87], v[40:43]
    v_exp_f32 v0, v0
    v_mfma_f32_16x16x32_bf16 v[40:43], a[96:99], a[80:83], v[40:43]
    s_waitcnt vmcnt(0) lgkmcnt(0)
    s_barrier
    v_mfma_f32_16x16x32_bf16 v[4:7], a[112:115], a[0:3], v[96:99]
    v_exp_f32 v9, v9
    v_mfma_f32_16x16x32_bf16 v[4:7], a[116:119], a[4:7], v[4:7]
    v_mfma_f32_16x16x32_bf16 v[4:7], a[120:123], a[8:11], v[4:7]
    ds_read_b64_tr_b16 a[96:97], v124 offset:16384
    v_cvt_pk_bf16_f32 v94, v44, v45
    v_mfma_f32_16x16x32_bf16 v[4:7], a[124:127], a[12:15], v[4:7]
    v_exp_f32 v25, v25
    v_mfma_f32_16x16x32_bf16 v[12:15], a[124:127], a[28:31], v[100:103]
    v_exp_f32 v10, v10
    v_mfma_f32_16x16x32_bf16 v[12:15], a[120:123], a[24:27], v[12:15]
    v_exp_f32 v2, v2
    v_mfma_f32_16x16x32_bf16 v[12:15], a[116:119], a[20:23], v[12:15]
    ds_read_b64_tr_b16 a[98:99], v124 offset:24576
    v_cvt_pk_bf16_f32 v95, v46, v47
    v_mfma_f32_16x16x32_bf16 v[12:15], a[112:115], a[16:19], v[12:15]
    v_cvt_pk_bf16_f32 v52, v8, v9
    v_mfma_f32_16x16x32_bf16 v[20:23], a[112:115], a[32:35], v[104:107]
    ds_read_b64_tr_b16 a[100:101], v125 offset:16384
    v_mfma_f32_16x16x32_bf16 v[20:23], a[116:119], a[36:39], v[20:23]
    s_add_u32 m0, s30, 32768
    v_cvt_pk_bf16_f32 v48, v0, v1
    v_mfma_f32_16x16x32_bf16 v[20:23], a[120:123], a[40:43], v[20:23]
    ds_read_b64_tr_b16 a[102:103], v125 offset:24576
    v_mfma_f32_16x16x32_bf16 v[20:23], a[124:127], a[44:47], v[20:23]
    global_load_lds_dwordx4 v132, s[22:23] offset:1024 nt
    v_mfma_f32_16x16x32_bf16 v[28:31], a[124:127], a[60:63], v[108:111]
    v_mfma_f32_16x16x32_bf16 v[28:31], a[120:123], a[56:59], v[28:31]
    v_exp_f32 v17, v17
    v_mfma_f32_16x16x32_bf16 v[28:31], a[116:119], a[52:55], v[28:31]
    v_exp_f32 v19, v19
    v_mfma_f32_16x16x32_bf16 v[28:31], a[112:115], a[48:51], v[28:31]
    ds_read_b64_tr_b16 a[104:105], v126 offset:16384
    v_mfma_f32_16x16x32_bf16 v[36:39], a[112:115], a[64:67], v[112:115]
    global_load_lds_dwordx4 v132, s[16:17] nt
    v_mfma_f32_16x16x32_bf16 v[36:39], a[116:119], a[68:71], v[36:39]
    v_exp_f32 v32, v32
    v_mfma_f32_16x16x32_bf16 v[36:39], a[120:123], a[72:75], v[36:39]
    v_exp_f32 v16, v16
    v_mfma_f32_16x16x32_bf16 v[36:39], a[124:127], a[76:79], v[36:39]
    ds_read_b64_tr_b16 a[106:107], v126 offset:24576
    s_waitcnt lgkmcnt(2)
    v_mfma_f32_16x16x32_bf16 v[44:47], a[124:127], a[92:95], v[116:119]
    ds_read_b64_tr_b16 a[108:109], v127 offset:16384
    v_mfma_f32_16x16x32_bf16 v[44:47], a[120:123], a[88:91], v[44:47]
    global_load_lds_dwordx4 v132, s[22:23] offset:3072 nt
    v_mfma_f32_16x16x32_bf16 v[44:47], a[116:119], a[84:87], v[44:47]
    ds_read_b64_tr_b16 a[110:111], v127 offset:24576
    v_mfma_f32_16x16x32_bf16 v[44:47], a[112:115], a[80:83], v[44:47]
    v_exp_f32 v27, v27
    v_mfma_f32_16x16x32_bf16 v[144:147], v[72:75], a[96:99], v[144:147]
    v_exp_f32 v18, v18
    v_mfma_f32_16x16x32_bf16 a[128:131], v[72:75], a[136:139], a[128:131]
    ds_read_b64_tr_b16 a[112:113], v128 offset:16384
    v_mfma_f32_16x16x32_bf16 v[148:151], v[72:75], a[100:103], v[148:151]
    global_load_lds_dwordx4 v132, s[16:17] offset:2048 nt
    v_mfma_f32_16x16x32_bf16 v[180:183], v[76:79], a[100:103], v[180:183]
    ds_read_b64_tr_b16 a[114:115], v128 offset:24576
    v_mfma_f32_16x16x32_bf16 a[128:131], v[76:79], a[140:143], a[128:131]
    v_mfma_f32_16x16x32_bf16 v[176:179], v[76:79], a[96:99], v[176:179]
    v_exp_f32 v5, v5
    v_mfma_f32_16x16x32_bf16 v[208:211], v[80:83], a[96:99], v[208:211]
    ds_read_b64_tr_b16 a[116:117], v129 offset:16384
    v_mfma_f32_16x16x32_bf16 v[212:215], v[80:83], a[100:103], v[212:215]
    v_exp_f32 v35, v35
    v_mfma_f32_16x16x32_bf16 v[244:247], v[84:87], a[100:103], v[244:247]
    v_exp_f32 v33, v33
    v_mfma_f32_16x16x32_bf16 v[240:243], v[84:87], a[96:99], v[240:243]
    v_exp_f32 v34, v34
    v_mfma_f32_16x16x32_bf16 a[192:195], v[88:91], a[96:99], a[192:195]
    v_exp_f32 v24, v24
    v_mfma_f32_16x16x32_bf16 a[196:199], v[88:91], a[100:103], a[196:199]
    v_exp_f32 v26, v26
    v_mfma_f32_16x16x32_bf16 a[228:231], v[92:95], a[100:103], a[228:231]
    ds_read_b64_tr_b16 a[118:119], v129 offset:24576
    v_cvt_pk_bf16_f32 v49, v2, v3
    v_mfma_f32_16x16x32_bf16 a[224:227], v[92:95], a[96:99], a[224:227]
    s_waitcnt lgkmcnt(4)
    v_add_u32 v132, 8192, v132
    v_mfma_f32_16x16x32_bf16 a[232:235], v[92:95], a[104:107], a[232:235]
    ds_read_b64_tr_b16 a[120:121], v130 offset:16384
    v_mfma_f32_16x16x32_bf16 a[132:135], v[92:95], a[144:147], a[132:135]
    ds_read_b64_tr_b16 a[122:123], v130 offset:24576
    v_cvt_pk_bf16_f32 v64, v32, v33
    v_mfma_f32_16x16x32_bf16 a[236:239], v[92:95], a[108:111], a[236:239]
    ds_read_b64_tr_b16 a[124:125], v131 offset:16384
    v_mfma_f32_16x16x32_bf16 a[204:207], v[88:91], a[108:111], a[204:207]
    v_cvt_pk_bf16_f32 v61, v26, v27
    v_mfma_f32_16x16x32_bf16 a[132:135], v[88:91], a[140:143], a[132:135]
    ds_read_b64_tr_b16 a[126:127], v131 offset:24576
    v_cvt_pk_bf16_f32 v53, v10, v11
    v_mfma_f32_16x16x32_bf16 a[200:203], v[88:91], a[104:107], a[200:203]
    v_exp_f32 v4, v4
    v_mfma_f32_16x16x32_bf16 v[248:251], v[84:87], a[104:107], v[248:251]
    v_exp_f32 v21, v21
    v_mfma_f32_16x16x32_bf16 v[252:255], v[84:87], a[108:111], v[252:255]
    v_cvt_pk_bf16_f32 v56, v16, v17
    v_cvt_pk_bf16_f32 v60, v24, v25
    v_mfma_f32_16x16x32_bf16 v[220:223], v[80:83], a[108:111], v[220:223]
    v_exp_f32 v6, v6
    v_mfma_f32_16x16x32_bf16 v[216:219], v[80:83], a[104:107], v[216:219]
    v_exp_f32 v42, v42
    v_mfma_f32_16x16x32_bf16 v[184:187], v[76:79], a[104:107], v[184:187]
    v_exp_f32 v12, v12
    v_mfma_f32_16x16x32_bf16 v[188:191], v[76:79], a[108:111], v[188:191]
    v_exp_f32 v15, v15
    v_mfma_f32_16x16x32_bf16 v[156:159], v[72:75], a[108:111], v[156:159]
    s_waitcnt lgkmcnt(0)
    v_mfma_f32_16x16x32_bf16 v[152:155], v[72:75], a[104:107], v[152:155]
    v_exp_f32 v14, v14
    v_mfma_f32_16x16x32_bf16 v[160:163], v[72:75], a[112:115], v[160:163]
    v_exp_f32 v41, v41
    v_mfma_f32_16x16x32_bf16 v[164:167], v[72:75], a[116:119], v[164:167]
    v_exp_f32 v30, v30
    v_mfma_f32_16x16x32_bf16 v[196:199], v[76:79], a[116:119], v[196:199]
    ds_read_b128 a[96:99], v120 offset:16384
    v_cvt_pk_bf16_f32 v57, v18, v19
    v_mfma_f32_16x16x32_bf16 v[192:195], v[76:79], a[112:115], v[192:195]
    v_exp_f32 v7, v7
    v_mfma_f32_16x16x32_bf16 v[224:227], v[80:83], a[112:115], v[224:227]
    v_exp_f32 v13, v13
    v_mfma_f32_16x16x32_bf16 a[128:131], v[80:83], a[144:147], a[128:131]
    v_cvt_pk_bf16_f32 v65, v34, v35
    v_cvt_pk_bf16_f32 v55, v14, v15
    v_mfma_f32_16x16x32_bf16 v[228:231], v[80:83], a[116:119], v[228:231]
    v_exp_f32 v40, v40
    v_mfma_f32_16x16x32_bf16 a[180:183], v[84:87], a[116:119], a[180:183]
    v_exp_f32 v43, v43
    v_mfma_f32_16x16x32_bf16 a[176:179], v[84:87], a[112:115], a[176:179]
    ds_read_b128 a[100:103], v121 offset:16384
    v_mfma_f32_16x16x32_bf16 a[208:211], v[88:91], a[112:115], a[208:211]
    v_exp_f32 v28, v28
    v_mfma_f32_16x16x32_bf16 a[212:215], v[88:91], a[116:119], a[212:215]
    ds_read_b128 a[104:107], v122 offset:16384
    v_mfma_f32_16x16x32_bf16 a[244:247], v[92:95], a[116:119], a[244:247]
    ds_read_b128 a[108:111], v123 offset:16384
    v_mfma_f32_16x16x32_bf16 a[240:243], v[92:95], a[112:115], a[240:243]
    v_exp_f32 v22, v22
    v_mfma_f32_16x16x32_bf16 a[248:251], v[92:95], a[120:123], a[248:251]
    v_cvt_pk_bf16_f32 v69, v42, v43
    v_cvt_pk_bf16_f32 v50, v4, v5
    v_mfma_f32_16x16x32_bf16 a[252:255], v[92:95], a[124:127], a[252:255]
    v_cvt_pk_bf16_f32 v51, v6, v7
    v_mfma_f32_16x16x32_bf16 a[220:223], v[88:91], a[124:127], a[220:223]
    v_exp_f32 v29, v29
    v_mfma_f32_16x16x32_bf16 a[216:219], v[88:91], a[120:123], a[216:219]
    v_exp_f32 v31, v31
    v_mfma_f32_16x16x32_bf16 a[184:187], v[84:87], a[120:123], a[184:187]
    v_cvt_pk_bf16_f32 v68, v40, v41
    v_cvt_pk_bf16_f32 v62, v28, v29
    v_mfma_f32_16x16x32_bf16 a[132:135], v[84:87], a[136:139], a[132:135]
    v_exp_f32 v23, v23
    v_mfma_f32_16x16x32_bf16 a[188:191], v[84:87], a[124:127], a[188:191]
    v_exp_f32 v20, v20
    v_mfma_f32_16x16x32_bf16 v[236:239], v[80:83], a[124:127], v[236:239]
    v_mfma_f32_16x16x32_bf16 v[232:235], v[80:83], a[120:123], v[232:235]
    v_mfma_f32_16x16x32_bf16 v[200:203], v[76:79], a[120:123], v[200:203]
    s_waitcnt lgkmcnt(0)
    v_cvt_pk_bf16_f32 v54, v12, v13
    v_mfma_f32_16x16x32_bf16 v[204:207], v[76:79], a[124:127], v[204:207]
    v_cvt_pk_bf16_f32 v58, v20, v21
    v_cvt_pk_bf16_f32 v63, v30, v31
    v_mfma_f32_16x16x32_bf16 v[172:175], v[72:75], a[124:127], v[172:175]
    v_cvt_pk_bf16_f32 v59, v22, v23
    v_mfma_f32_16x16x32_bf16 v[168:171], v[72:75], a[120:123], v[168:171]
    v_mfma_f32_16x16x32_bf16 v[0:3], a[96:99], a[0:3], v[96:99]
    v_exp_f32 v46, v46
    v_mfma_f32_16x16x32_bf16 v[0:3], a[100:103], a[4:7], v[0:3]
    ds_read_b128 a[112:115], v120 offset:24576
    v_mfma_f32_16x16x32_bf16 v[0:3], a[104:107], a[8:11], v[0:3]
    v_exp_f32 v36, v36
    v_mfma_f32_16x16x32_bf16 v[0:3], a[108:111], a[12:15], v[0:3]
    v_exp_f32 v47, v47
    v_mfma_f32_16x16x32_bf16 v[8:11], a[108:111], a[28:31], v[100:103]
    v_exp_f32 v45, v45
    v_mfma_f32_16x16x32_bf16 v[8:11], a[104:107], a[24:27], v[8:11]
    v_mfma_f32_16x16x32_bf16 v[8:11], a[100:103], a[20:23], v[8:11]
    ds_read_b128 a[116:119], v121 offset:24576
    v_mfma_f32_16x16x32_bf16 v[8:11], a[96:99], a[16:19], v[8:11]
    v_exp_f32 v44, v44
    v_mfma_f32_16x16x32_bf16 v[16:19], a[96:99], a[32:35], v[104:107]
    v_exp_f32 v37, v37
    v_mfma_f32_16x16x32_bf16 v[16:19], a[100:103], a[36:39], v[16:19]
    v_exp_f32 v3, v3
    v_mfma_f32_16x16x32_bf16 v[16:19], a[104:107], a[40:43], v[16:19]
    v_exp_f32 v38, v38
    v_mfma_f32_16x16x32_bf16 v[16:19], a[108:111], a[44:47], v[16:19]
    ds_read_b128 a[120:123], v122 offset:24576
    v_mfma_f32_16x16x32_bf16 v[24:27], a[108:111], a[60:63], v[108:111]
    v_exp_f32 v39, v39
    v_mfma_f32_16x16x32_bf16 v[24:27], a[104:107], a[56:59], v[24:27]
    ds_read_b128 a[124:127], v123 offset:24576
    v_cvt_pk_bf16_f32 v70, v44, v45
    v_mfma_f32_16x16x32_bf16 v[24:27], a[100:103], a[52:55], v[24:27]
    v_exp_f32 v9, v9
    v_mfma_f32_16x16x32_bf16 v[24:27], a[96:99], a[48:51], v[24:27]
    v_exp_f32 v2, v2
    v_mfma_f32_16x16x32_bf16 v[32:35], a[96:99], a[64:67], v[112:115]
    v_mfma_f32_16x16x32_bf16 v[32:35], a[100:103], a[68:71], v[32:35]
    v_cvt_pk_bf16_f32 v71, v46, v47
    v_mfma_f32_16x16x32_bf16 v[32:35], a[104:107], a[72:75], v[32:35]
    v_cvt_pk_bf16_f32 v67, v38, v39
    v_mfma_f32_16x16x32_bf16 v[32:35], a[108:111], a[76:79], v[32:35]
    v_exp_f32 v0, v0
    v_mfma_f32_16x16x32_bf16 v[40:43], a[108:111], a[92:95], v[116:119]
    v_exp_f32 v1, v1
    v_mfma_f32_16x16x32_bf16 v[40:43], a[104:107], a[88:91], v[40:43]
    v_exp_f32 v16, v16
    v_mfma_f32_16x16x32_bf16 v[40:43], a[100:103], a[84:87], v[40:43]
    v_cvt_pk_bf16_f32 v66, v36, v37
    v_mfma_f32_16x16x32_bf16 v[40:43], a[96:99], a[80:83], v[40:43]
    s_waitcnt vmcnt(0) lgkmcnt(0)
    s_barrier
    v_mfma_f32_16x16x32_bf16 v[4:7], a[112:115], a[0:3], v[96:99]
    s_add_u32 m0, s30, 49152
    v_cvt_pk_bf16_f32 v72, v0, v1
    v_mfma_f32_16x16x32_bf16 v[4:7], a[116:119], a[4:7], v[4:7]
    v_mfma_f32_16x16x32_bf16 v[4:7], a[120:123], a[8:11], v[4:7]
    global_load_lds_dwordx4 v132, s[22:23] offset:1024 nt
    v_mfma_f32_16x16x32_bf16 v[4:7], a[124:127], a[12:15], v[4:7]
    ds_read_b64_tr_b16 a[96:97], v124 offset:32768
    v_mfma_f32_16x16x32_bf16 v[12:15], a[124:127], a[28:31], v[100:103]
    v_exp_f32 v8, v8
    v_mfma_f32_16x16x32_bf16 v[12:15], a[120:123], a[24:27], v[12:15]
    v_exp_f32 v17, v17
    v_mfma_f32_16x16x32_bf16 v[12:15], a[116:119], a[20:23], v[12:15]
    v_mfma_f32_16x16x32_bf16 v[12:15], a[112:115], a[16:19], v[12:15]
    global_load_lds_dwordx4 v132, s[16:17] nt
    v_mfma_f32_16x16x32_bf16 v[20:23], a[112:115], a[32:35], v[104:107]
    v_exp_f32 v10, v10
    v_mfma_f32_16x16x32_bf16 v[20:23], a[116:119], a[36:39], v[20:23]
    v_exp_f32 v11, v11
    v_mfma_f32_16x16x32_bf16 v[20:23], a[120:123], a[40:43], v[20:23]
    ds_read_b64_tr_b16 a[98:99], v124 offset:40960
    v_mfma_f32_16x16x32_bf16 v[20:23], a[124:127], a[44:47], v[20:23]
    v_cvt_pk_bf16_f32 v80, v16, v17
    v_mfma_f32_16x16x32_bf16 v[28:31], a[124:127], a[60:63], v[108:111]
    global_load_lds_dwordx4 v132, s[22:23] offset:3072 nt
    v_mfma_f32_16x16x32_bf16 v[28:31], a[120:123], a[56:59], v[28:31]
    ds_read_b64_tr_b16 a[100:101], v125 offset:32768
    v_cvt_pk_bf16_f32 v73, v2, v3
    v_mfma_f32_16x16x32_bf16 v[28:31], a[116:119], a[52:55], v[28:31]
    ds_read_b64_tr_b16 a[102:103], v125 offset:40960
    v_cvt_pk_bf16_f32 v76, v8, v9
    v_mfma_f32_16x16x32_bf16 v[28:31], a[112:115], a[48:51], v[28:31]
    v_exp_f32 v4, v4
    v_mfma_f32_16x16x32_bf16 v[36:39], a[112:115], a[64:67], v[112:115]
    ds_read_b64_tr_b16 a[104:105], v126 offset:32768
    v_mfma_f32_16x16x32_bf16 v[36:39], a[116:119], a[68:71], v[36:39]
    global_load_lds_dwordx4 v132, s[16:17] offset:2048 nt
    v_mfma_f32_16x16x32_bf16 v[36:39], a[120:123], a[72:75], v[36:39]
    v_exp_f32 v34, v34
    v_mfma_f32_16x16x32_bf16 v[36:39], a[124:127], a[76:79], v[36:39]
    v_exp_f32 v18, v18
    v_mfma_f32_16x16x32_bf16 v[44:47], a[124:127], a[92:95], v[116:119]
    ds_read_b64_tr_b16 a[106:107], v126 offset:40960
    v_mfma_f32_16x16x32_bf16 v[44:47], a[120:123], a[88:91], v[44:47]
    v_exp_f32 v19, v19
    v_mfma_f32_16x16x32_bf16 v[44:47], a[116:119], a[84:87], v[44:47]
    ds_read_b64_tr_b16 a[108:109], v127 offset:32768
    s_waitcnt lgkmcnt(3)
    v_mfma_f32_16x16x32_bf16 v[44:47], a[112:115], a[80:83], v[44:47]
    v_exp_f32 v26, v26
    v_mfma_f32_16x16x32_bf16 v[144:147], v[48:51], a[96:99], v[144:147]
    ds_read_b64_tr_b16 a[110:111], v127 offset:40960
    s_mov_b32 m0, s32
    v_mfma_f32_16x16x32_bf16 a[128:131], v[48:51], a[136:139], a[128:131]
    ds_read_b64_tr_b16 a[112:113], v128 offset:32768
    v_mfma_f32_16x16x32_bf16 v[148:151], v[48:51], a[100:103], v[148:151]
    global_load_lds_dwordx4 v133, s[20:21] nt
    v_mfma_f32_16x16x32_bf16 v[180:183], v[52:55], a[100:103], v[180:183]
    s_add_u32 s20, s20, 1024
    s_addc_u32 s21, s21, 0
    v_mfma_f32_16x16x32_bf16 a[128:131], v[52:55], a[140:143], a[128:131]
    ds_read_b64_tr_b16 a[114:115], v128 offset:40960
    v_mfma_f32_16x16x32_bf16 v[176:179], v[52:55], a[96:99], v[176:179]
    s_add_u32 s32, s32, 1024
    v_cvt_pk_bf16_f32 v81, v18, v19
    v_mfma_f32_16x16x32_bf16 v[208:211], v[56:59], a[96:99], v[208:211]
    v_exp_f32 v24, v24
    v_mfma_f32_16x16x32_bf16 v[212:215], v[56:59], a[100:103], v[212:215]
    v_exp_f32 v33, v33
    v_mfma_f32_16x16x32_bf16 v[244:247], v[60:63], a[100:103], v[244:247]
    ds_read_b64_tr_b16 a[116:117], v129 offset:32768
    s_waitcnt lgkmcnt(3)
    v_mfma_f32_16x16x32_bf16 v[240:243], v[60:63], a[96:99], v[240:243]
    ds_read_b64_tr_b16 a[118:119], v129 offset:40960
    v_mfma_f32_16x16x32_bf16 a[192:195], v[64:67], a[96:99], a[192:195]
    v_exp_f32 v43, v43
    v_mfma_f32_16x16x32_bf16 a[196:199], v[64:67], a[100:103], a[196:199]
    ds_read_b64_tr_b16 a[120:121], v130 offset:32768
    v_mfma_f32_16x16x32_bf16 a[228:231], v[68:71], a[100:103], a[228:231]
    v_exp_f32 v40, v40
    v_mfma_f32_16x16x32_bf16 a[224:227], v[68:71], a[96:99], a[224:227]
    v_exp_f32 v32, v32
    v_mfma_f32_16x16x32_bf16 a[232:235], v[68:71], a[104:107], a[232:235]
    v_exp_f32 v27, v27
    v_mfma_f32_16x16x32_bf16 a[132:135], v[68:71], a[144:147], a[132:135]
    ds_read_b64_tr_b16 a[122:123], v130 offset:40960
    v_cvt_pk_bf16_f32 v85, v26, v27
    v_mfma_f32_16x16x32_bf16 a[236:239], v[68:71], a[108:111], a[236:239]
    ds_read_b64_tr_b16 a[124:125], v131 offset:32768
    v_cvt_pk_bf16_f32 v88, v32, v33
    v_mfma_f32_16x16x32_bf16 a[204:207], v[64:67], a[108:111], a[204:207]
    v_exp_f32 v35, v35
    v_mfma_f32_16x16x32_bf16 a[132:135], v[64:67], a[140:143], a[132:135]
    ds_read_b64_tr_b16 a[126:127], v131 offset:40960
    v_cvt_pk_bf16_f32 v89, v34, v35
    v_mfma_f32_16x16x32_bf16 a[200:203], v[64:67], a[104:107], a[200:203]
    v_mfma_f32_16x16x32_bf16 v[248:251], v[60:63], a[104:107], v[248:251]
    v_exp_f32 v41, v41
    v_mfma_f32_16x16x32_bf16 v[252:255], v[60:63], a[108:111], v[252:255]
    v_exp_f32 v42, v42
    v_mfma_f32_16x16x32_bf16 v[220:223], v[56:59], a[108:111], v[220:223]
    v_exp_f32 v5, v5
    v_mfma_f32_16x16x32_bf16 v[216:219], v[56:59], a[104:107], v[216:219]
    v_exp_f32 v6, v6
    v_mfma_f32_16x16x32_bf16 v[184:187], v[52:55], a[104:107], v[184:187]
    v_cvt_pk_bf16_f32 v74, v4, v5
    v_mfma_f32_16x16x32_bf16 v[188:191], v[52:55], a[108:111], v[188:191]
    v_exp_f32 v29, v29
    v_mfma_f32_16x16x32_bf16 v[156:159], v[48:51], a[108:111], v[156:159]
    v_exp_f32 v25, v25
    v_mfma_f32_16x16x32_bf16 v[152:155], v[48:51], a[104:107], v[152:155]
    s_waitcnt lgkmcnt(0)
    v_mfma_f32_16x16x32_bf16 v[160:163], v[48:51], a[112:115], v[160:163]
    ds_read_b128 a[96:99], v120 offset:32768
    v_cvt_pk_bf16_f32 v93, v42, v43
    v_mfma_f32_16x16x32_bf16 v[164:167], v[48:51], a[116:119], v[164:167]
    v_exp_f32 v14, v14
    v_mfma_f32_16x16x32_bf16 v[196:199], v[52:55], a[116:119], v[196:199]
    v_exp_f32 v31, v31
    v_mfma_f32_16x16x32_bf16 v[192:195], v[52:55], a[112:115], v[192:195]
    ds_read_b128 a[100:103], v121 offset:32768
    v_cvt_pk_bf16_f32 v77, v10, v11
    v_mfma_f32_16x16x32_bf16 v[224:227], v[56:59], a[112:115], v[224:227]
    v_add_u32 v132, 8192, v132
    v_mfma_f32_16x16x32_bf16 a[128:131], v[56:59], a[144:147], a[128:131]
    v_mfma_f32_16x16x32_bf16 v[228:231], v[56:59], a[116:119], v[228:231]
    v_exp_f32 v7, v7
    v_mfma_f32_16x16x32_bf16 a[180:183], v[60:63], a[116:119], a[180:183]
    ds_read_b128 a[104:107], v122 offset:32768
    v_cvt_pk_bf16_f32 v92, v40, v41
    v_mfma_f32_16x16x32_bf16 a[176:179], v[60:63], a[112:115], a[176:179]
    v_exp_f32 v12, v12
    v_mfma_f32_16x16x32_bf16 a[208:211], v[64:67], a[112:115], a[208:211]
    v_exp_f32 v20, v20
    v_mfma_f32_16x16x32_bf16 a[212:215], v[64:67], a[116:119], a[212:215]
    v_exp_f32 v13, v13
    v_mfma_f32_16x16x32_bf16 a[244:247], v[68:71], a[116:119], a[244:247]
    v_exp_f32 v23, v23
    v_mfma_f32_16x16x32_bf16 a[240:243], v[68:71], a[112:115], a[240:243]
    v_mfma_f32_16x16x32_bf16 a[248:251], v[68:71], a[120:123], a[248:251]
    ds_read_b128 a[108:111], v123 offset:32768
    v_cvt_pk_bf16_f32 v84, v24, v25
    v_mfma_f32_16x16x32_bf16 a[252:255], v[68:71], a[124:127], a[252:255]
    v_exp_f32 v22, v22
    v_mfma_f32_16x16x32_bf16 a[220:223], v[64:67], a[124:127], a[220:223]
    v_exp_f32 v21, v21
    v_mfma_f32_16x16x32_bf16 a[216:219], v[64:67], a[120:123], a[216:219]
    v_exp_f32 v28, v28
    v_mfma_f32_16x16x32_bf16 a[184:187], v[60:63], a[120:123], a[184:187]
    v_cvt_pk_bf16_f32 v82, v20, v21
    v_mfma_f32_16x16x32_bf16 a[132:135], v[60:63], a[136:139], a[132:135]
    v_exp_f32 v15, v15
    v_mfma_f32_16x16x32_bf16 a[188:191], v[60:63], a[124:127], a[188:191]
    v_cvt_pk_bf16_f32 v79, v14, v15
    v_mfma_f32_16x16x32_bf16 v[236:239], v[56:59], a[124:127], v[236:239]
    v_exp_f32 v30, v30
    v_mfma_f32_16x16x32_bf16 v[232:235], v[56:59], a[120:123], v[232:235]
    v_cvt_pk_bf16_f32 v78, v12, v13
    v_mfma_f32_16x16x32_bf16 v[200:203], v[52:55], a[120:123], v[200:203]
    s_waitcnt lgkmcnt(0)
    v_cvt_pk_bf16_f32 v87, v30, v31
    v_mfma_f32_16x16x32_bf16 v[204:207], v[52:55], a[124:127], v[204:207]
    v_cvt_pk_bf16_f32 v75, v6, v7
    v_cvt_pk_bf16_f32 v86, v28, v29
    v_mfma_f32_16x16x32_bf16 v[172:175], v[48:51], a[124:127], v[172:175]
    v_cvt_pk_bf16_f32 v83, v22, v23
    v_mfma_f32_16x16x32_bf16 v[168:171], v[48:51], a[120:123], v[168:171]
    v_mfma_f32_16x16x32_bf16 v[0:3], a[96:99], a[0:3], v[96:99]
    v_exp_f32 v36, v36
    v_mfma_f32_16x16x32_bf16 v[0:3], a[100:103], a[4:7], v[0:3]
    ds_read_b128 a[112:115], v120 offset:40960
    v_mfma_f32_16x16x32_bf16 v[0:3], a[104:107], a[8:11], v[0:3]
    v_exp_f32 v37, v37
    v_mfma_f32_16x16x32_bf16 v[0:3], a[108:111], a[12:15], v[0:3]
    v_exp_f32 v44, v44
    v_mfma_f32_16x16x32_bf16 v[8:11], a[108:111], a[28:31], v[100:103]
    v_exp_f32 v45, v45
    v_mfma_f32_16x16x32_bf16 v[8:11], a[104:107], a[24:27], v[8:11]
    v_mfma_f32_16x16x32_bf16 v[8:11], a[100:103], a[20:23], v[8:11]
    ds_read_b128 a[116:119], v121 offset:40960
    v_cvt_pk_bf16_f32 v90, v36, v37
    v_mfma_f32_16x16x32_bf16 v[8:11], a[96:99], a[16:19], v[8:11]
    v_mfma_f32_16x16x32_bf16 v[16:19], a[96:99], a[32:35], v[104:107]
    v_exp_f32 v46, v46
    v_mfma_f32_16x16x32_bf16 v[16:19], a[100:103], a[36:39], v[16:19]
    v_exp_f32 v38, v38
    v_mfma_f32_16x16x32_bf16 v[16:19], a[104:107], a[40:43], v[16:19]
    v_exp_f32 v47, v47
    v_mfma_f32_16x16x32_bf16 v[16:19], a[108:111], a[44:47], v[16:19]
    ds_read_b128 a[120:123], v122 offset:40960
    v_mfma_f32_16x16x32_bf16 v[24:27], a[108:111], a[60:63], v[108:111]
    v_mfma_f32_16x16x32_bf16 v[24:27], a[104:107], a[56:59], v[24:27]
    ds_read_b128 a[124:127], v123 offset:40960
    s_add_u32 m0, s30, 0
    v_mfma_f32_16x16x32_bf16 v[24:27], a[100:103], a[52:55], v[24:27]
    v_cvt_pk_bf16_f32 v95, v46, v47
    v_mfma_f32_16x16x32_bf16 v[24:27], a[96:99], a[48:51], v[24:27]
    global_load_lds_dwordx4 v132, s[22:23] offset:1024 nt
    v_mfma_f32_16x16x32_bf16 v[32:35], a[96:99], a[64:67], v[112:115]
    v_exp_f32 v39, v39
    v_mfma_f32_16x16x32_bf16 v[32:35], a[100:103], a[68:71], v[32:35]
    v_exp_f32 v0, v0
    v_mfma_f32_16x16x32_bf16 v[32:35], a[104:107], a[72:75], v[32:35]
    v_cvt_pk_bf16_f32 v91, v38, v39
    v_cvt_pk_bf16_f32 v94, v44, v45
    v_mfma_f32_16x16x32_bf16 v[32:35], a[108:111], a[76:79], v[32:35]
    v_mfma_f32_16x16x32_bf16 v[40:43], a[108:111], a[92:95], v[116:119]
    global_load_lds_dwordx4 v132, s[16:17] nt
    v_mfma_f32_16x16x32_bf16 v[40:43], a[104:107], a[88:91], v[40:43]
    v_exp_f32 v2, v2
    v_mfma_f32_16x16x32_bf16 v[40:43], a[100:103], a[84:87], v[40:43]
    v_exp_f32 v3, v3
    v_mfma_f32_16x16x32_bf16 v[40:43], a[96:99], a[80:83], v[40:43]
    s_waitcnt vmcnt(3) lgkmcnt(0)
    s_barrier
    v_mfma_f32_16x16x32_bf16 v[4:7], a[112:115], a[0:3], v[96:99]
    v_mfma_f32_16x16x32_bf16 v[4:7], a[116:119], a[4:7], v[4:7]
    global_load_lds_dwordx4 v132, s[22:23] offset:3072 nt
    v_mfma_f32_16x16x32_bf16 v[4:7], a[120:123], a[8:11], v[4:7]
    v_exp_f32 v8, v8
    v_mfma_f32_16x16x32_bf16 v[4:7], a[124:127], a[12:15], v[4:7]
    v_exp_f32 v16, v16
    v_mfma_f32_16x16x32_bf16 v[12:15], a[124:127], a[28:31], v[100:103]
    v_exp_f32 v1, v1
    v_mfma_f32_16x16x32_bf16 v[12:15], a[120:123], a[24:27], v[12:15]
    ds_read_b64_tr_b16 a[96:97], v124 offset:49152
    v_mfma_f32_16x16x32_bf16 v[12:15], a[116:119], a[20:23], v[12:15]
    global_load_lds_dwordx4 v132, s[16:17] offset:2048 nt
    v_mfma_f32_16x16x32_bf16 v[12:15], a[112:115], a[16:19], v[12:15]
    ds_read_b64_tr_b16 a[98:99], v124 offset:57344
    v_cvt_pk_bf16_f32 v49, v2, v3
    v_mfma_f32_16x16x32_bf16 v[20:23], a[112:115], a[32:35], v[104:107]
    ds_read_b64_tr_b16 a[100:101], v125 offset:49152
    v_cvt_pk_bf16_f32 v48, v0, v1
    v_mfma_f32_16x16x32_bf16 v[20:23], a[116:119], a[36:39], v[20:23]
    v_exp_f32 v10, v10
    v_mfma_f32_16x16x32_bf16 v[20:23], a[120:123], a[40:43], v[20:23]
    v_exp_f32 v11, v11
    v_mfma_f32_16x16x32_bf16 v[20:23], a[124:127], a[44:47], v[20:23]
    v_exp_f32 v9, v9
    v_mfma_f32_16x16x32_bf16 v[28:31], a[124:127], a[60:63], v[108:111]
    ds_read_b64_tr_b16 a[102:103], v125 offset:57344
    v_mfma_f32_16x16x32_bf16 v[28:31], a[120:123], a[56:59], v[28:31]
    ds_read_b64_tr_b16 a[104:105], v126 offset:49152
    v_mfma_f32_16x16x32_bf16 v[28:31], a[116:119], a[52:55], v[28:31]
    v_exp_f32 v24, v24
    v_mfma_f32_16x16x32_bf16 v[28:31], a[112:115], a[48:51], v[28:31]
    ds_read_b64_tr_b16 a[106:107], v126 offset:57344
    v_cvt_pk_bf16_f32 v52, v8, v9
    v_mfma_f32_16x16x32_bf16 v[36:39], a[112:115], a[64:67], v[112:115]
    v_add_u32 v132, 8192, v132
    v_mfma_f32_16x16x32_bf16 v[36:39], a[116:119], a[68:71], v[36:39]
    v_exp_f32 v19, v19
    v_mfma_f32_16x16x32_bf16 v[36:39], a[120:123], a[72:75], v[36:39]
    v_mfma_f32_16x16x32_bf16 v[36:39], a[124:127], a[76:79], v[36:39]
    v_exp_f32 v33, v33
    v_mfma_f32_16x16x32_bf16 v[44:47], a[124:127], a[92:95], v[116:119]
    ds_read_b64_tr_b16 a[108:109], v127 offset:49152
    s_waitcnt lgkmcnt(3)
    v_mfma_f32_16x16x32_bf16 v[44:47], a[120:123], a[88:91], v[44:47]
    ds_read_b64_tr_b16 a[110:111], v127 offset:57344
    v_cvt_pk_bf16_f32 v53, v10, v11
    v_mfma_f32_16x16x32_bf16 v[44:47], a[116:119], a[84:87], v[44:47]
    v_exp_f32 v17, v17
    v_mfma_f32_16x16x32_bf16 v[44:47], a[112:115], a[80:83], v[44:47]
    v_exp_f32 v18, v18
    v_mfma_f32_16x16x32_bf16 v[144:147], v[72:75], a[96:99], v[144:147]
    ds_read_b64_tr_b16 a[112:113], v128 offset:49152
    s_mov_b32 m0, s32
    v_mfma_f32_16x16x32_bf16 a[128:131], v[72:75], a[136:139], a[128:131]
    ds_read_b64_tr_b16 a[114:115], v128 offset:57344
    v_mfma_f32_16x16x32_bf16 v[148:151], v[72:75], a[100:103], v[148:151]
    global_load_lds_dwordx4 v134, s[20:21] nt
    v_mfma_f32_16x16x32_bf16 v[180:183], v[76:79], a[100:103], v[180:183]
    s_add_u32 s20, s20, 1024
    s_addc_u32 s21, s21, 0
    v_mfma_f32_16x16x32_bf16 a[128:131], v[76:79], a[140:143], a[128:131]
    v_exp_f32 v32, v32
    v_mfma_f32_16x16x32_bf16 v[176:179], v[76:79], a[96:99], v[176:179]
    v_exp_f32 v25, v25
    v_mfma_f32_16x16x32_bf16 v[208:211], v[80:83], a[96:99], v[208:211]
    v_exp_f32 v26, v26
    v_mfma_f32_16x16x32_bf16 v[212:215], v[80:83], a[100:103], v[212:215]
    ds_read_b64_tr_b16 a[116:117], v129 offset:49152
    s_waitcnt lgkmcnt(3)
    v_mfma_f32_16x16x32_bf16 v[244:247], v[84:87], a[100:103], v[244:247]
    v_exp_f32 v34, v34
    v_mfma_f32_16x16x32_bf16 v[240:243], v[84:87], a[96:99], v[240:243]
    v_cvt_pk_bf16_f32 v64, v32, v33
    v_mfma_f32_16x16x32_bf16 a[192:195], v[88:91], a[96:99], a[192:195]
    ds_read_b64_tr_b16 a[118:119], v129 offset:57344
    v_mfma_f32_16x16x32_bf16 a[196:199], v[88:91], a[100:103], a[196:199]
    ds_read_b64_tr_b16 a[120:121], v130 offset:49152
    v_mfma_f32_16x16x32_bf16 a[228:231], v[92:95], a[100:103], a[228:231]
    ds_read_b64_tr_b16 a[122:123], v130 offset:57344
    v_cvt_pk_bf16_f32 v56, v16, v17
    v_mfma_f32_16x16x32_bf16 a[224:227], v[92:95], a[96:99], a[224:227]
    ds_read_b64_tr_b16 a[124:125], v131 offset:49152
    s_add_u32 s32, s32, 1024
    v_mfma_f32_16x16x32_bf16 a[232:235], v[92:95], a[104:107], a[232:235]
    v_exp_f32 v42, v42
    v_mfma_f32_16x16x32_bf16 a[132:135], v[92:95], a[144:147], a[132:135]
    v_exp_f32 v35, v35
    v_mfma_f32_16x16x32_bf16 a[236:239], v[92:95], a[108:111], a[236:239]
    v_cvt_pk_bf16_f32 v60, v24, v25
    v_mfma_f32_16x16x32_bf16 a[204:207], v[88:91], a[108:111], a[204:207]
    ds_read_b64_tr_b16 a[126:127], v131 offset:57344
    v_mfma_f32_16x16x32_bf16 a[132:135], v[88:91], a[140:143], a[132:135]
    v_exp_f32 v41, v41
    v_mfma_f32_16x16x32_bf16 a[200:203], v[88:91], a[104:107], a[200:203]
    v_exp_f32 v40, v40
    v_mfma_f32_16x16x32_bf16 v[248:251], v[84:87], a[104:107], v[248:251]
    v_exp_f32 v23, v23
    v_mfma_f32_16x16x32_bf16 v[252:255], v[84:87], a[108:111], v[252:255]
    v_exp_f32 v43, v43
    v_mfma_f32_16x16x32_bf16 v[220:223], v[80:83], a[108:111], v[220:223]
    v_exp_f32 v7, v7
    v_mfma_f32_16x16x32_bf16 v[216:219], v[80:83], a[104:107], v[216:219]
    v_exp_f32 v4, v4
    v_mfma_f32_16x16x32_bf16 v[184:187], v[76:79], a[104:107], v[184:187]
    v_exp_f32 v13, v13
    v_mfma_f32_16x16x32_bf16 v[188:191], v[76:79], a[108:111], v[188:191]
    v_exp_f32 v27, v27
    v_mfma_f32_16x16x32_bf16 v[156:159], v[72:75], a[108:111], v[156:159]
    s_waitcnt lgkmcnt(0)
    v_mfma_f32_16x16x32_bf16 v[152:155], v[72:75], a[104:107], v[152:155]
    v_exp_f32 v29, v29
    v_mfma_f32_16x16x32_bf16 v[160:163], v[72:75], a[112:115], v[160:163]
    v_exp_f32 v12, v12
    v_mfma_f32_16x16x32_bf16 v[164:167], v[72:75], a[116:119], v[164:167]
    v_exp_f32 v6, v6
    v_mfma_f32_16x16x32_bf16 v[196:199], v[76:79], a[116:119], v[196:199]
    v_exp_f32 v5, v5
    v_mfma_f32_16x16x32_bf16 v[192:195], v[76:79], a[112:115], v[192:195]
    v_cvt_pk_bf16_f32 v65, v34, v35
    v_mfma_f32_16x16x32_bf16 v[224:227], v[80:83], a[112:115], v[224:227]
    ds_read_b128 a[96:99], v120 offset:49152
    v_mfma_f32_16x16x32_bf16 a[128:131], v[80:83], a[144:147], a[128:131]
    v_cvt_pk_bf16_f32 v68, v40, v41
    v_mfma_f32_16x16x32_bf16 v[228:231], v[80:83], a[116:119], v[228:231]
    v_exp_f32 v15, v15
    v_mfma_f32_16x16x32_bf16 a[180:183], v[84:87], a[116:119], a[180:183]
    ds_read_b128 a[100:103], v121 offset:49152
    v_cvt_pk_bf16_f32 v57, v18, v19
    v_mfma_f32_16x16x32_bf16 a[176:179], v[84:87], a[112:115], a[176:179]
    ds_read_b128 a[104:107], v122 offset:49152
    v_cvt_pk_bf16_f32 v54, v12, v13
L_pad3:
    s_cbranch_vccz L_padret0
    v_mfma_f32_16x16x32_bf16 a[208:211], v[88:91], a[112:115], a[208:211]
    v_exp_f32 v20, v20
    v_mfma_f32_16x16x32_bf16 a[212:215], v[88:91], a[116:119], a[212:215]
    v_exp_f32 v14, v14
    v_mfma_f32_16x16x32_bf16 a[244:247], v[92:95], a[116:119], a[244:247]
    v_exp_f32 v22, v22
    v_mfma_f32_16x16x32_bf16 a[240:243], v[92:95], a[112:115], a[240:243]
    v_exp_f32 v31, v31
    v_mfma_f32_16x16x32_bf16 a[248:251], v[92:95], a[120:123], a[248:251]
    v_exp_f32 v21, v21
    v_mfma_f32_16x16x32_bf16 a[252:255], v[92:95], a[124:127], a[252:255]
    v_exp_f32 v28, v28
    v_mfma_f32_16x16x32_bf16 a[220:223], v[88:91], a[124:127], a[220:223]
    ds_read_b128 a[108:111], v123 offset:49152
    v_mfma_f32_16x16x32_bf16 a[216:219], v[88:91], a[120:123], a[216:219]
    v_mfma_f32_16x16x32_bf16 a[184:187], v[84:87], a[120:123], a[184:187]
    v_exp_f32 v30, v30
    v_mfma_f32_16x16x32_bf16 a[132:135], v[84:87], a[136:139], a[132:135]
    v_cvt_pk_bf16_f32 v55, v14, v15
    v_mfma_f32_16x16x32_bf16 a[188:191], v[84:87], a[124:127], a[188:191]
    v_cvt_pk_bf16_f32 v51, v6, v7
    v_cvt_pk_bf16_f32 v59, v22, v23
    v_mfma_f32_16x16x32_bf16 v[236:239], v[80:83], a[124:127], v[236:239]
    v_cvt_pk_bf16_f32 v61, v26, v27
    v_cvt_pk_bf16_f32 v69, v42, v43
    v_mfma_f32_16x16x32_bf16 v[232:235], v[80:83], a[120:123], v[232:235]
    v_cvt_pk_bf16_f32 v62, v28, v29
    v_mfma_f32_16x16x32_bf16 v[200:203], v[76:79], a[120:123], v[200:203]
    v_cvt_pk_bf16_f32 v58, v20, v21
    v_cvt_pk_bf16_f32 v63, v30, v31
    v_mfma_f32_16x16x32_bf16 v[204:207], v[76:79], a[124:127], v[204:207]
    v_mfma_f32_16x16x32_bf16 v[172:175], v[72:75], a[124:127], v[172:175]
    s_waitcnt lgkmcnt(0)
    v_cvt_pk_bf16_f32 v50, v4, v5
    v_mfma_f32_16x16x32_bf16 v[168:171], v[72:75], a[120:123], v[168:171]
.p2align 3
L_A:
    v_mfma_f32_16x16x32_bf16 v[0:3], a[96:99], a[0:3], v[96:99]
    s_add_u32 m0, s30, 16384
    v_mfma_f32_16x16x32_bf16 v[0:3], a[100:103], a[4:7], v[0:3]
    ds_read_b128 a[112:115], v120 offset:57344
    v_mfma_f32_16x16x32_bf16 v[0:3], a[104:107], a[8:11], v[0:3]
    global_load_lds_dwordx4 v132, s[22:23] offset:1024 nt
    v_mfma_f32_16x16x32_bf16 v[0:3], a[108:111], a[12:15], v[0:3]
    v_exp_f32 v38, v38
    v_mfma_f32_16x16x32_bf16 v[8:11], a[108:111], a[28:31], v[100:103]
    v_exp_f32 v36, v36
    v_mfma_f32_16x16x32_bf16 v[8:11], a[104:107], a[24:27], v[8:11]
    v_exp_f32 v39, v39
    v_mfma_f32_16x16x32_bf16 v[8:11], a[100:103], a[20:23], v[8:11]
    ds_read_b128 a[116:119], v121 offset:57344
    s_waitcnt vmcnt(6)
    v_mfma_f32_16x16x32_bf16 v[8:11], a[96:99], a[16:19], v[8:11]
    global_load_lds_dwordx4 v132, s[16:17] nt
    v_mfma_f32_16x16x32_bf16 v[16:19], a[96:99], a[32:35], v[104:107]
    v_exp_f32 v45, v45
    v_mfma_f32_16x16x32_bf16 v[16:19], a[100:103], a[36:39], v[16:19]
    v_exp_f32 v37, v37
    v_mfma_f32_16x16x32_bf16 v[16:19], a[104:107], a[40:43], v[16:19]
    v_exp_f32 v44, v44
    v_mfma_f32_16x16x32_bf16 v[16:19], a[108:111], a[44:47], v[16:19]
    ds_read_b128 a[120:123], v122 offset:57344
    v_mfma_f32_16x16x32_bf16 v[24:27], a[108:111], a[60:63], v[108:111]
    global_load_lds_dwordx4 v132, s[22:23] offset:3072 nt
    v_mfma_f32_16x16x32_bf16 v[24:27], a[104:107], a[56:59], v[24:27]
    ds_read_b128 a[124:127], v123 offset:57344
    v_cvt_pk_bf16_f32 v67, v38, v39
    v_mfma_f32_16x16x32_bf16 v[24:27], a[100:103], a[52:55], v[24:27]
    ds_read_b64 v[142:143], v140
    v_cvt_pk_bf16_f32 v66, v36, v37
    v_mfma_f32_16x16x32_bf16 v[24:27], a[96:99], a[48:51], v[24:27]
    v_exp_f32 v46, v46
    v_mfma_f32_16x16x32_bf16 v[32:35], a[96:99], a[64:67], v[112:115]
    v_mfma_f32_16x16x32_bf16 v[32:35], a[100:103], a[68:71], v[32:35]
    global_load_lds_dwordx4 v132, s[16:17] offset:2048 nt
    v_mfma_f32_16x16x32_bf16 v[32:35], a[104:107], a[72:75], v[32:35]
    v_exp_f32 v47, v47
    v_mfma_f32_16x16x32_bf16 v[32:35], a[108:111], a[76:79], v[32:35]
    v_exp_f32 v8, v8
    v_mfma_f32_16x16x32_bf16 v[40:43], a[108:111], a[92:95], v[116:119]
    v_exp_f32 v1, v1
    v_mfma_f32_16x16x32_bf16 v[40:43], a[104:107], a[88:91], v[40:43]
    v_exp_f32 v3, v3
    v_mfma_f32_16x16x32_bf16 v[40:43], a[100:103], a[84:87], v[40:43]
    s_waitcnt lgkmcnt(0)
    v_cvt_pk_bf16_f32 v71, v46, v47
    v_mfma_f32_16x16x32_bf16 v[40:43], a[96:99], a[80:83], v[40:43]
    s_waitcnt vmcnt(5) lgkmcnt(0)
    s_barrier
    v_mfma_f32_16x16x32_bf16 v[4:7], a[112:115], a[0:3], v[96:99]
    v_exp_f32 v0, v0
    v_mfma_f32_16x16x32_bf16 v[4:7], a[116:119], a[4:7], v[4:7]
    v_exp_f32 v11, v11
    v_mfma_f32_16x16x32_bf16 v[4:7], a[120:123], a[8:11], v[4:7]
    v_exp_f32 v2, v2
    v_mfma_f32_16x16x32_bf16 v[4:7], a[124:127], a[12:15], v[4:7]
    ds_read_b64_tr_b16 a[96:97], v124
    v_lshlrev_b32 v138, 16, v142
    v_mfma_f32_16x16x32_bf16 v[12:15], a[124:127], a[28:31], v[100:103]
    ds_read_b64_tr_b16 a[98:99], v124 offset:8192
    v_and_b32 v139, 0xffff0000, v142
    v_mfma_f32_16x16x32_bf16 v[12:15], a[120:123], a[24:27], v[12:15]
    v_mul_f32 v138, s38, v138
    v_cvt_pk_bf16_f32 v70, v44, v45
    v_mfma_f32_16x16x32_bf16 v[12:15], a[116:119], a[20:23], v[12:15]
    v_mul_f32 v139, s38, v139
    v_cvt_pk_bf16_f32 v142, v138, v139
    v_mfma_f32_16x16x32_bf16 v[12:15], a[112:115], a[16:19], v[12:15]
    v_exp_f32 v10, v10
    v_mfma_f32_16x16x32_bf16 v[20:23], a[112:115], a[32:35], v[104:107]
    ds_read_b64_tr_b16 a[100:101], v125
    v_add_u32 v132, 8192, v132
    v_mfma_f32_16x16x32_bf16 v[20:23], a[116:119], a[36:39], v[20:23]
    v_exp_f32 v9, v9
    v_mfma_f32_16x16x32_bf16 v[20:23], a[120:123], a[40:43], v[20:23]
    v_exp_f32 v17, v17
    v_mfma_f32_16x16x32_bf16 v[20:23], a[124:127], a[44:47], v[20:23]
    ds_read_b64_tr_b16 a[102:103], v125 offset:8192
    v_lshlrev_b32 v138, 16, v143
    v_mfma_f32_16x16x32_bf16 v[28:31], a[124:127], a[60:63], v[108:111]
    v_cvt_pk_bf16_f32 v72, v0, v1
    v_cvt_pk_bf16_f32 v76, v8, v9
    v_mfma_f32_16x16x32_bf16 v[28:31], a[120:123], a[56:59], v[28:31]
    ds_read_b64_tr_b16 a[104:105], v126
    v_cvt_pk_bf16_f32 v73, v2, v3
    v_mfma_f32_16x16x32_bf16 v[28:31], a[116:119], a[52:55], v[28:31]
    v_exp_f32 v26, v26
    v_mfma_f32_16x16x32_bf16 v[28:31], a[112:115], a[48:51], v[28:31]
    ds_read_b64_tr_b16 a[106:107], v126 offset:8192
    v_and_b32 v139, 0xffff0000, v143
    v_mfma_f32_16x16x32_bf16 v[36:39], a[112:115], a[64:67], v[112:115]
    v_exp_f32 v24, v24
    v_mfma_f32_16x16x32_bf16 v[36:39], a[116:119], a[68:71], v[36:39]
    v_mul_f32 v138, s38, v138
    v_mul_f32 v139, s38, v139
    v_mfma_f32_16x16x32_bf16 v[36:39], a[120:123], a[72:75], v[36:39]
    v_exp_f32 v16, v16
    v_mfma_f32_16x16x32_bf16 v[36:39], a[124:127], a[76:79], v[36:39]
    s_waitcnt lgkmcnt(2)
    v_cvt_pk_bf16_f32 v143, v138, v139
    v_mfma_f32_16x16x32_bf16 v[44:47], a[124:127], a[92:95], v[116:119]
    v_exp_f32 v34, v34
    v_mfma_f32_16x16x32_bf16 v[44:47], a[120:123], a[88:91], v[44:47]
    v_exp_f32 v32, v32
    v_mfma_f32_16x16x32_bf16 v[44:47], a[116:119], a[84:87], v[44:47]
    v_exp_f32 v25, v25
    v_mfma_f32_16x16x32_bf16 v[44:47], a[112:115], a[80:83], v[44:47]
    ds_write_b64 v140, v[142:143]
    v_mfma_f32_16x16x32_bf16 v[144:147], v[48:51], a[96:99], v[144:147]
    ds_read_b64_tr_b16 a[108:109], v127
    s_mov_b32 m0, s32
    v_mfma_f32_16x16x32_bf16 a[128:131], v[48:51], a[136:139], a[128:131]
    ds_read_b64_tr_b16 a[110:111], v127 offset:8192
    s_add_u32 s32, s32, 2048
    v_mfma_f32_16x16x32_bf16 v[148:151], v[48:51], a[100:103], v[148:151]
    global_load_lds_dwordx4 v133, s[20:21] nt
    v_mfma_f32_16x16x32_bf16 v[180:183], v[52:55], a[100:103], v[180:183]
    v_exp_f32 v18, v18
    v_mfma_f32_16x16x32_bf16 a[128:131], v[52:55], a[140:143], a[128:131]
    ds_read_b64 v[142:143], v140 offset:512
    v_mfma_f32_16x16x32_bf16 v[176:179], v[52:55], a[96:99], v[176:179]
    ds_read_b64_tr_b16 a[112:113], v128
    v_mfma_f32_16x16x32_bf16 v[208:211], v[56:59], a[96:99], v[208:211]
    v_exp_f32 v4, v4
    v_mfma_f32_16x16x32_bf16 v[212:215], v[56:59], a[100:103], v[212:215]
    v_exp_f32 v7, v7
    v_mfma_f32_16x16x32_bf16 v[244:247], v[60:63], a[100:103], v[244:247]
    v_exp_f32 v27, v27
    v_mfma_f32_16x16x32_bf16 v[240:243], v[60:63], a[96:99], v[240:243]
    ds_read_b64_tr_b16 a[114:115], v128 offset:8192
    v_cvt_pk_bf16_f32 v80, v16, v17
    v_mfma_f32_16x16x32_bf16 a[192:195], v[64:67], a[96:99], a[192:195]
    v_exp_f32 v33, v33
    v_mfma_f32_16x16x32_bf16 a[196:199], v[64:67], a[100:103], a[196:199]
    ds_read_b64_tr_b16 a[116:117], v129
    s_waitcnt lgkmcnt(3)
    v_mfma_f32_16x16x32_bf16 a[228:231], v[68:71], a[100:103], a[228:231]
    ds_read_b64_tr_b16 a[118:119], v129 offset:8192
    v_exp_f32 v43, v43
    v_mfma_f32_16x16x32_bf16 a[224:227], v[68:71], a[96:99], a[224:227]
    ds_read_b64_tr_b16 a[120:121], v130
    v_mfma_f32_16x16x32_bf16 a[232:235], v[68:71], a[104:107], a[232:235]
    global_load_lds_dwordx4 v134, s[20:21] offset:1024 nt
    v_mfma_f32_16x16x32_bf16 a[132:135], v[68:71], a[144:147], a[132:135]
    ds_read_b64_tr_b16 a[122:123], v130 offset:8192
    s_add_u32 s20, s20, 2048
    s_addc_u32 s21, s21, 0
    v_mfma_f32_16x16x32_bf16 a[236:239], v[68:71], a[108:111], a[236:239]
    v_exp_f32 v42, v42
    v_mfma_f32_16x16x32_bf16 a[204:207], v[64:67], a[108:111], a[204:207]
    ds_read_b64_tr_b16 a[124:125], v131
    v_cvt_pk_bf16_f32 v85, v26, v27
    v_mfma_f32_16x16x32_bf16 a[132:135], v[64:67], a[140:143], a[132:135]
    v_exp_f32 v19, v19
    v_mfma_f32_16x16x32_bf16 a[200:203], v[64:67], a[104:107], a[200:203]
    ds_read_b64_tr_b16 a[126:127], v131 offset:8192
    v_lshlrev_b32 v138, 16, v142
    v_mfma_f32_16x16x32_bf16 v[248:251], v[60:63], a[104:107], v[248:251]
    v_exp_f32 v41, v41
    v_mfma_f32_16x16x32_bf16 v[252:255], v[60:63], a[108:111], v[252:255]
    v_exp_f32 v40, v40
    v_mfma_f32_16x16x32_bf16 v[220:223], v[56:59], a[108:111], v[220:223]
    v_exp_f32 v13, v13
    v_mfma_f32_16x16x32_bf16 v[216:219], v[56:59], a[104:107], v[216:219]
    v_exp_f32 v35, v35
    v_mfma_f32_16x16x32_bf16 v[184:187], v[52:55], a[104:107], v[184:187]
    v_and_b32 v139, 0xffff0000, v142
    v_cvt_pk_bf16_f32 v93, v42, v43
    v_mfma_f32_16x16x32_bf16 v[188:191], v[52:55], a[108:111], v[188:191]
    v_exp_f32 v6, v6
    v_mfma_f32_16x16x32_bf16 v[156:159], v[48:51], a[108:111], v[156:159]
    v_exp_f32 v22, v22
    v_mfma_f32_16x16x32_bf16 v[152:155], v[48:51], a[104:107], v[152:155]
    s_waitcnt lgkmcnt(0)
    v_mul_f32 v138, s38, v138
    v_mfma_f32_16x16x32_bf16 v[160:163], v[48:51], a[112:115], v[160:163]
    ds_read_b128 a[96:99], v120
    v_cvt_pk_bf16_f32 v84, v24, v25
    v_mfma_f32_16x16x32_bf16 v[164:167], v[48:51], a[116:119], v[164:167]
    v_exp_f32 v5, v5
    v_mfma_f32_16x16x32_bf16 v[196:199], v[52:55], a[116:119], v[196:199]
    v_mul_f32 v139, s38, v139
    v_cvt_pk_bf16_f32 v75, v6, v7
    v_mfma_f32_16x16x32_bf16 v[192:195], v[52:55], a[112:115], v[192:195]
    v_exp_f32 v28, v28
    v_mfma_f32_16x16x32_bf16 v[224:227], v[56:59], a[112:115], v[224:227]
    ds_read_b128 a[100:103], v121
    v_cvt_pk_bf16_f32 v142, v138, v139
    v_mfma_f32_16x16x32_bf16 a[128:131], v[56:59], a[144:147], a[128:131]
    v_cvt_pk_bf16_f32 v92, v40, v41
    v_cvt_pk_bf16_f32 v74, v4, v5
    v_mfma_f32_16x16x32_bf16 v[228:231], v[56:59], a[116:119], v[228:231]
    v_lshlrev_b32 v138, 16, v143
    v_cvt_pk_bf16_f32 v88, v32, v33
    v_mfma_f32_16x16x32_bf16 a[180:183], v[60:63], a[116:119], a[180:183]
    v_and_b32 v139, 0xffff0000, v143
    v_mul_f32 v138, s38, v138
    v_mfma_f32_16x16x32_bf16 a[176:179], v[60:63], a[112:115], a[176:179]
    v_exp_f32 v21, v21
    v_mfma_f32_16x16x32_bf16 a[208:211], v[64:67], a[112:115], a[208:211]
    v_exp_f32 v20, v20
    v_mfma_f32_16x16x32_bf16 a[212:215], v[64:67], a[116:119], a[212:215]
    ds_read_b128 a[104:107], v122
    v_mul_f32 v139, s38, v139
    v_mfma_f32_16x16x32_bf16 a[244:247], v[68:71], a[116:119], a[244:247]
    v_exp_f32 v15, v15
    v_mfma_f32_16x16x32_bf16 a[240:243], v[68:71], a[112:115], a[240:243]
    ds_read_b128 a[108:111], v123
    v_cvt_pk_bf16_f32 v89, v34, v35
    v_mfma_f32_16x16x32_bf16 a[248:251], v[68:71], a[120:123], a[248:251]
    v_exp_f32 v12, v12
    v_mfma_f32_16x16x32_bf16 a[252:255], v[68:71], a[124:127], a[252:255]
    v_exp_f32 v23, v23
    v_mfma_f32_16x16x32_bf16 a[220:223], v[64:67], a[124:127], a[220:223]
    v_cvt_pk_bf16_f32 v143, v138, v139
    v_cvt_pk_bf16_f32 v81, v18, v19
    v_mfma_f32_16x16x32_bf16 a[216:219], v[64:67], a[120:123], a[216:219]
    v_exp_f32 v30, v30
    v_mfma_f32_16x16x32_bf16 a[184:187], v[60:63], a[120:123], a[184:187]
    v_cvt_pk_bf16_f32 v77, v10, v11
    v_cvt_pk_bf16_f32 v82, v20, v21
    v_mfma_f32_16x16x32_bf16 a[132:135], v[60:63], a[136:139], a[132:135]
    v_exp_f32 v29, v29
    v_mfma_f32_16x16x32_bf16 a[188:191], v[60:63], a[124:127], a[188:191]
    v_exp_f32 v31, v31
    v_mfma_f32_16x16x32_bf16 v[236:239], v[56:59], a[124:127], v[236:239]
    s_waitcnt lgkmcnt(0)
    v_cvt_pk_bf16_f32 v83, v22, v23
    v_mfma_f32_16x16x32_bf16 v[232:235], v[56:59], a[120:123], v[232:235]
    ds_write_b64 v140, v[142:143] offset:512
    v_mfma_f32_16x16x32_bf16 v[200:203], v[52:55], a[120:123], v[200:203]
    v_cvt_pk_bf16_f32 v78, v12, v13
    v_cvt_pk_bf16_f32 v87, v30, v31
    v_mfma_f32_16x16x32_bf16 v[204:207], v[52:55], a[124:127], v[204:207]
    v_exp_f32 v14, v14
    v_mfma_f32_16x16x32_bf16 v[172:175], v[48:51], a[124:127], v[172:175]
    v_cvt_pk_bf16_f32 v79, v14, v15
    v_cvt_pk_bf16_f32 v86, v28, v29
    v_mfma_f32_16x16x32_bf16 v[168:171], v[48:51], a[120:123], v[168:171]
    v_mfma_f32_16x16x32_bf16 v[0:3], a[96:99], a[0:3], v[96:99]
    s_add_u32 m0, s30, 32768
    v_mfma_f32_16x16x32_bf16 v[0:3], a[100:103], a[4:7], v[0:3]
    ds_read_b128 a[112:115], v120 offset:8192
    v_mfma_f32_16x16x32_bf16 v[0:3], a[104:107], a[8:11], v[0:3]
    global_load_lds_dwordx4 v132, s[22:23] offset:1024 nt
    v_mfma_f32_16x16x32_bf16 v[0:3], a[108:111], a[12:15], v[0:3]
    v_exp_f32 v38, v38
    v_mfma_f32_16x16x32_bf16 v[8:11], a[108:111], a[28:31], v[100:103]
    v_exp_f32 v36, v36
    v_mfma_f32_16x16x32_bf16 v[8:11], a[104:107], a[24:27], v[8:11]
    v_exp_f32 v39, v39
    v_mfma_f32_16x16x32_bf16 v[8:11], a[100:103], a[20:23], v[8:11]
    ds_read_b128 a[116:119], v121 offset:8192
    s_waitcnt vmcnt(7)
    v_mfma_f32_16x16x32_bf16 v[8:11], a[96:99], a[16:19], v[8:11]
    global_load_lds_dwordx4 v132, s[16:17] nt
    v_mfma_f32_16x16x32_bf16 v[16:19], a[96:99], a[32:35], v[104:107]
    v_exp_f32 v45, v45
    v_mfma_f32_16x16x32_bf16 v[16:19], a[100:103], a[36:39], v[16:19]
    v_exp_f32 v37, v37
    v_mfma_f32_16x16x32_bf16 v[16:19], a[104:107], a[40:43], v[16:19]
    v_exp_f32 v44, v44
    v_mfma_f32_16x16x32_bf16 v[16:19], a[108:111], a[44:47], v[16:19]
    ds_read_b128 a[120:123], v122 offset:8192
    v_mfma_f32_16x16x32_bf16 v[24:27], a[108:111], a[60:63], v[108:111]
    global_load_lds_dwordx4 v132, s[22:23] offset:3072 nt
    v_mfma_f32_16x16x32_bf16 v[24:27], a[104:107], a[56:59], v[24:27]
    ds_read_b128 a[124:127], v123 offset:8192
    v_cvt_pk_bf16_f32 v91, v38, v39
    v_mfma_f32_16x16x32_bf16 v[24:27], a[100:103], a[52:55], v[24:27]
    ds_read_b64 v[142:143], v140 offset:1024
    v_cvt_pk_bf16_f32 v90, v36, v37
    v_mfma_f32_16x16x32_bf16 v[24:27], a[96:99], a[48:51], v[24:27]
    v_exp_f32 v46, v46
    v_mfma_f32_16x16x32_bf16 v[32:35], a[96:99], a[64:67], v[112:115]
    v_mfma_f32_16x16x32_bf16 v[32:35], a[100:103], a[68:71], v[32:35]
    global_load_lds_dwordx4 v132, s[16:17] offset:2048 nt
    v_mfma_f32_16x16x32_bf16 v[32:35], a[104:107], a[72:75], v[32:35]
    v_exp_f32 v47, v47
    v_mfma_f32_16x16x32_bf16 v[32:35], a[108:111], a[76:79], v[32:35]
    v_exp_f32 v8, v8
    v_mfma_f32_16x16x32_bf16 v[40:43], a[108:111], a[92:95], v[116:119]
    v_exp_f32 v1, v1
    v_mfma_f32_16x16x32_bf16 v[40:43], a[104:107], a[88:91], v[40:43]
    v_exp_f32 v3, v3
    v_mfma_f32_16x16x32_bf16 v[40:43], a[100:103], a[84:87], v[40:43]
    s_waitcnt lgkmcnt(0)
    v_cvt_pk_bf16_f32 v95, v46, v47
    v_mfma_f32_16x16x32_bf16 v[40:43], a[96:99], a[80:83], v[40:43]
    s_waitcnt vmcnt(6) lgkmcnt(0)
    s_barrier
    v_mfma_f32_16x16x32_bf16 v[4:7], a[112:115], a[0:3], v[96:99]
    v_exp_f32 v0, v0
    v_mfma_f32_16x16x32_bf16 v[4:7], a[116:119], a[4:7], v[4:7]
    v_exp_f32 v11, v11
    v_mfma_f32_16x16x32_bf16 v[4:7], a[120:123], a[8:11], v[4:7]
    v_exp_f32 v2, v2
    v_mfma_f32_16x16x32_bf16 v[4:7], a[124:127], a[12:15], v[4:7]
    ds_read_b64_tr_b16 a[96:97], v124 offset:16384
    v_lshlrev_b32 v138, 16, v142
    v_mfma_f32_16x16x32_bf16 v[12:15], a[124:127], a[28:31], v[100:103]
    ds_read_b64_tr_b16 a[98:99], v124 offset:24576
    v_and_b32 v139, 0xffff0000, v142
    v_mfma_f32_16x16x32_bf16 v[12:15], a[120:123], a[24:27], v[12:15]
    v_mul_f32 v138, s38, v138
    v_cvt_pk_bf16_f32 v94, v44, v45
    v_mfma_f32_16x16x32_bf16 v[12:15], a[116:119], a[20:23], v[12:15]
    v_mul_f32 v139, s38, v139
    v_cvt_pk_bf16_f32 v142, v138, v139
    v_mfma_f32_16x16x32_bf16 v[12:15], a[112:115], a[16:19], v[12:15]
    v_exp_f32 v10, v10
    v_mfma_f32_16x16x32_bf16 v[20:23], a[112:115], a[32:35], v[104:107]
    ds_read_b64_tr_b16 a[100:101], v125 offset:16384
    v_add_u32 v132, 8192, v132
    v_mfma_f32_16x16x32_bf16 v[20:23], a[116:119], a[36:39], v[20:23]
    v_exp_f32 v9, v9
    v_mfma_f32_16x16x32_bf16 v[20:23], a[120:123], a[40:43], v[20:23]
    v_exp_f32 v17, v17
    v_mfma_f32_16x16x32_bf16 v[20:23], a[124:127], a[44:47], v[20:23]
    ds_read_b64_tr_b16 a[102:103], v125 offset:24576
    v_lshlrev_b32 v138, 16, v143
    v_mfma_f32_16x16x32_bf16 v[28:31], a[124:127], a[60:63], v[108:111]
    v_cvt_pk_bf16_f32 v48, v0, v1
    v_cvt_pk_bf16_f32 v52, v8, v9
    v_mfma_f32_16x16x32_bf16 v[28:31], a[120:123], a[56:59], v[28:31]
    ds_read_b64_tr_b16 a[104:105], v126 offset:16384
    v_cvt_pk_bf16_f32 v49, v2, v3
    v_mfma_f32_16x16x32_bf16 v[28:31], a[116:119], a[52:55], v[28:31]
    v_exp_f32 v26, v26
    v_mfma_f32_16x16x32_bf16 v[28:31], a[112:115], a[48:51], v[28:31]
    ds_read_b64_tr_b16 a[106:107], v126 offset:24576
    v_and_b32 v139, 0xffff0000, v143
    v_mfma_f32_16x16x32_bf16 v[36:39], a[112:115], a[64:67], v[112:115]
    v_exp_f32 v24, v24
    v_mfma_f32_16x16x32_bf16 v[36:39], a[116:119], a[68:71], v[36:39]
    v_mul_f32 v138, s38, v138
    v_mul_f32 v139, s38, v139
    v_mfma_f32_16x16x32_bf16 v[36:39], a[120:123], a[72:75], v[36:39]
    v_exp_f32 v16, v16
    v_mfma_f32_16x16x32_bf16 v[36:39], a[124:127], a[76:79], v[36:39]
    s_waitcnt lgkmcnt(2)
    v_cvt_pk_bf16_f32 v143, v138, v139
    v_mfma_f32_16x16x32_bf16 v[44:47], a[124:127], a[92:95], v[116:119]
    v_exp_f32 v34, v34
    v_mfma_f32_16x16x32_bf16 v[44:47], a[120:123], a[88:91], v[44:47]
    v_exp_f32 v32, v32
    v_mfma_f32_16x16x32_bf16 v[44:47], a[116:119], a[84:87], v[44:47]
    v_exp_f32 v25, v25
    v_mfma_f32_16x16x32_bf16 v[44:47], a[112:115], a[80:83], v[44:47]
    ds_write_b64 v140, v[142:143] offset:1024
    v_mfma_f32_16x16x32_bf16 v[144:147], v[72:75], a[96:99], v[144:147]
    ds_read_b64_tr_b16 a[108:109], v127 offset:16384
    s_mov_b32 m0, s32
    v_mfma_f32_16x16x32_bf16 a[128:131], v[72:75], a[136:139], a[128:131]
    ds_read_b64_tr_b16 a[110:111], v127 offset:24576
    s_add_u32 s32, s32, 2048
    v_mfma_f32_16x16x32_bf16 v[148:151], v[72:75], a[100:103], v[148:151]
    global_load_lds_dwordx4 v133, s[20:21] nt
    v_mfma_f32_16x16x32_bf16 v[180:183], v[76:79], a[100:103], v[180:183]
    v_exp_f32 v18, v18
    v_mfma_f32_16x16x32_bf16 a[128:131], v[76:79], a[140:143], a[128:131]
    ds_read_b64 v[142:143], v140 offset:1536
    v_mfma_f32_16x16x32_bf16 v[176:179], v[76:79], a[96:99], v[176:179]
    ds_read_b64_tr_b16 a[112:113], v128 offset:16384
    v_mfma_f32_16x16x32_bf16 v[208:211], v[80:83], a[96:99], v[208:211]
    v_exp_f32 v4, v4
    v_mfma_f32_16x16x32_bf16 v[212:215], v[80:83], a[100:103], v[212:215]
    v_exp_f32 v7, v7
    v_mfma_f32_16x16x32_bf16 v[244:247], v[84:87], a[100:103], v[244:247]
    v_exp_f32 v27, v27
    v_mfma_f32_16x16x32_bf16 v[240:243], v[84:87], a[96:99], v[240:243]
    ds_read_b64_tr_b16 a[114:115], v128 offset:24576
    v_cvt_pk_bf16_f32 v56, v16, v17
    v_mfma_f32_16x16x32_bf16 a[192:195], v[88:91], a[96:99], a[192:195]
    v_exp_f32 v33, v33
    v_mfma_f32_16x16x32_bf16 a[196:199], v[88:91], a[100:103], a[196:199]
    ds_read_b64_tr_b16 a[116:117], v129 offset:16384
    s_waitcnt lgkmcnt(3)
    v_mfma_f32_16x16x32_bf16 a[228:231], v[92:95], a[100:103], a[228:231]
    ds_read_b64_tr_b16 a[118:119], v129 offset:24576
    v_exp_f32 v43, v43
    v_mfma_f32_16x16x32_bf16 a[224:227], v[92:95], a[96:99], a[224:227]
    ds_read_b64_tr_b16 a[120:121], v130 offset:16384
    v_mfma_f32_16x16x32_bf16 a[232:235], v[92:95], a[104:107], a[232:235]
    global_load_lds_dwordx4 v134, s[20:21] offset:1024 nt
    v_mfma_f32_16x16x32_bf16 a[132:135], v[92:95], a[144:147], a[132:135]
    ds_read_b64_tr_b16 a[122:123], v130 offset:24576
    s_add_u32 s20, s20, 2048
    s_addc_u32 s21, s21, 0
    v_mfma_f32_16x16x32_bf16 a[236:239], v[92:95], a[108:111], a[236:239]
    v_exp_f32 v42, v42
    v_mfma_f32_16x16x32_bf16 a[204:207], v[88:91], a[108:111], a[204:207]
    ds_read_b64_tr_b16 a[124:125], v131 offset:16384
    v_cvt_pk_bf16_f32 v61, v26, v27
    v_mfma_f32_16x16x32_bf16 a[132:135], v[88:91], a[140:143], a[132:135]
    v_exp_f32 v19, v19
    v_mfma_f32_16x16x32_bf16 a[200:203], v[88:91], a[104:107], a[200:203]
    ds_read_b64_tr_b16 a[126:127], v131 offset:24576
    v_lshlrev_b32 v138, 16, v142
    v_mfma_f32_16x16x32_bf16 v[248:251], v[84:87], a[104:107], v[248:251]
    v_exp_f32 v41, v41
    v_mfma_f32_16x16x32_bf16 v[252:255], v[84:87], a[108:111], v[252:255]
    v_exp_f32 v40, v40
    v_mfma_f32_16x16x32_bf16 v[220:223], v[80:83], a[108:111], v[220:223]
    v_exp_f32 v13, v13
    v_mfma_f32_16x16x32_bf16 v[216:219], v[80:83], a[104:107], v[216:219]
    v_exp_f32 v35, v35
    v_mfma_f32_16x16x32_bf16 v[184:187], v[76:79], a[104:107], v[184:187]
    v_and_b32 v139, 0xffff0000, v142
    v_cvt_pk_bf16_f32 v69, v42, v43
    v_mfma_f32_16x16x32_bf16 v[188:191], v[76:79], a[108:111], v[188:191]
    v_exp_f32 v6, v6
    v_mfma_f32_16x16x32_bf16 v[156:159], v[72:75], a[108:111], v[156:159]
    v_exp_f32 v22, v22
    v_mfma_f32_16x16x32_bf16 v[152:155], v[72:75], a[104:107], v[152:155]
    s_waitcnt lgkmcnt(0)
    v_mul_f32 v138, s38, v138
    v_mfma_f32_16x16x32_bf16 v[160:163], v[72:75], a[112:115], v[160:163]
    ds_read_b128 a[96:99], v120 offset:16384
    v_cvt_pk_bf16_f32 v60, v24, v25
    v_mfma_f32_16x16x32_bf16 v[164:167], v[72:75], a[116:119], v[164:167]
    v_exp_f32 v5, v5
    v_mfma_f32_16x16x32_bf16 v[196:199], v[76:79], a[116:119], v[196:199]
    v_mul_f32 v139, s38, v139
    v_cvt_pk_bf16_f32 v51, v6, v7
    v_mfma_f32_16x16x32_bf16 v[192:195], v[76:79], a[112:115], v[192:195]
    v_exp_f32 v28, v28
    v_mfma_f32_16x16x32_bf16 v[224:227], v[80:83], a[112:115], v[224:227]
    ds_read_b128 a[100:103], v121 offset:16384
    v_cvt_pk_bf16_f32 v142, v138, v139
    v_mfma_f32_16x16x32_bf16 a[128:131], v[80:83], a[144:147], a[128:131]
    v_cvt_pk_bf16_f32 v68, v40, v41
    v_cvt_pk_bf16_f32 v50, v4, v5
    v_mfma_f32_16x16x32_bf16 v[228:231], v[80:83], a[116:119], v[228:231]
    v_lshlrev_b32 v138, 16, v143
    v_cvt_pk_bf16_f32 v64, v32, v33
    v_mfma_f32_16x16x32_bf16 a[180:183], v[84:87], a[116:119], a[180:183]
    v_and_b32 v139, 0xffff0000, v143
    v_mul_f32 v138, s38, v138
    v_mfma_f32_16x16x32_bf16 a[176:179], v[84:87], a[112:115], a[176:179]
    v_exp_f32 v21, v21
    v_mfma_f32_16x16x32_bf16 a[208:211], v[88:91], a[112:115], a[208:211]
    v_exp_f32 v20, v20
    v_mfma_f32_16x16x32_bf16 a[212:215], v[88:91], a[116:119], a[212:215]
    ds_read_b128 a[104:107], v122 offset:16384
    v_mul_f32 v139, s38, v139
    v_mfma_f32_16x16x32_bf16 a[244:247], v[92:95], a[116:119], a[244:247]
    v_exp_f32 v15, v15
    v_mfma_f32_16x16x32_bf16 a[240:243], v[92:95], a[112:115], a[240:243]
    ds_read_b128 a[108:111], v123 offset:16384
    v_cvt_pk_bf16_f32 v65, v34, v35
    v_mfma_f32_16x16x32_bf16 a[248:251], v[92:95], a[120:123], a[248:251]
    v_exp_f32 v12, v12
    v_mfma_f32_16x16x32_bf16 a[252:255], v[92:95], a[124:127], a[252:255]
    v_exp_f32 v23, v23
    v_mfma_f32_16x16x32_bf16 a[220:223], v[88:91], a[124:127], a[220:223]
    v_cvt_pk_bf16_f32 v143, v138, v139
    v_cvt_pk_bf16_f32 v57, v18, v19
    v_mfma_f32_16x16x32_bf16 a[216:219], v[88:91], a[120:123], a[216:219]
    v_exp_f32 v30, v30
    v_mfma_f32_16x16x32_bf16 a[184:187], v[84:87], a[120:123], a[184:187]
    v_cvt_pk_bf16_f32 v53, v10, v11
    v_cvt_pk_bf16_f32 v58, v20, v21
    v_mfma_f32_16x16x32_bf16 a[132:135], v[84:87], a[136:139], a[132:135]
    v_exp_f32 v29, v29
    v_mfma_f32_16x16x32_bf16 a[188:191], v[84:87], a[124:127], a[188:191]
    v_exp_f32 v31, v31
    v_mfma_f32_16x16x32_bf16 v[236:239], v[80:83], a[124:127], v[236:239]
    s_waitcnt lgkmcnt(0)
    v_cvt_pk_bf16_f32 v59, v22, v23
    v_mfma_f32_16x16x32_bf16 v[232:235], v[80:83], a[120:123], v[232:235]
    ds_write_b64 v140, v[142:143] offset:1536
    v_mfma_f32_16x16x32_bf16 v[200:203], v[76:79], a[120:123], v[200:203]
    v_cvt_pk_bf16_f32 v54, v12, v13
    v_cvt_pk_bf16_f32 v63, v30, v31
    v_mfma_f32_16x16x32_bf16 v[204:207], v[76:79], a[124:127], v[204:207]
    v_exp_f32 v14, v14
    v_mfma_f32_16x16x32_bf16 v[172:175], v[72:75], a[124:127], v[172:175]
    v_cvt_pk_bf16_f32 v55, v14, v15
    v_cvt_pk_bf16_f32 v62, v28, v29
    v_mfma_f32_16x16x32_bf16 v[168:171], v[72:75], a[120:123], v[168:171]
    v_mfma_f32_16x16x32_bf16 v[0:3], a[96:99], a[0:3], v[96:99]
    s_add_u32 m0, s30, 49152
    v_mfma_f32_16x16x32_bf16 v[0:3], a[100:103], a[4:7], v[0:3]
    ds_read_b128 a[112:115], v120 offset:24576
    v_mfma_f32_16x16x32_bf16 v[0:3], a[104:107], a[8:11], v[0:3]
    global_load_lds_dwordx4 v132, s[22:23] offset:1024 nt
    v_mfma_f32_16x16x32_bf16 v[0:3], a[108:111], a[12:15], v[0:3]
    v_exp_f32 v38, v38
    v_mfma_f32_16x16x32_bf16 v[8:11], a[108:111], a[28:31], v[100:103]
    v_exp_f32 v36, v36
    v_mfma_f32_16x16x32_bf16 v[8:11], a[104:107], a[24:27], v[8:11]
    v_exp_f32 v39, v39
    v_mfma_f32_16x16x32_bf16 v[8:11], a[100:103], a[20:23], v[8:11]
    ds_read_b128 a[116:119], v121 offset:24576
    s_waitcnt vmcnt(8)
    v_mfma_f32_16x16x32_bf16 v[8:11], a[96:99], a[16:19], v[8:11]
    global_load_lds_dwordx4 v132, s[16:17] nt
    v_mfma_f32_16x16x32_bf16 v[16:19], a[96:99], a[32:35], v[104:107]
    v_exp_f32 v45, v45
    v_mfma_f32_16x16x32_bf16 v[16:19], a[100:103], a[36:39], v[16:19]
    v_exp_f32 v37, v37
    v_mfma_f32_16x16x32_bf16 v[16:19], a[104:107], a[40:43], v[16:19]
    v_exp_f32 v44, v44
    v_mfma_f32_16x16x32_bf16 v[16:19], a[108:111], a[44:47], v[16:19]
    ds_read_b128 a[120:123], v122 offset:24576
    v_mfma_f32_16x16x32_bf16 v[24:27], a[108:111], a[60:63], v[108:111]
    global_load_lds_dwordx4 v132, s[22:23] offset:3072 nt
    v_mfma_f32_16x16x32_bf16 v[24:27], a[104:107], a[56:59], v[24:27]
    ds_read_b128 a[124:127], v123 offset:24576
    v_cvt_pk_bf16_f32 v67, v38, v39
    v_mfma_f32_16x16x32_bf16 v[24:27], a[100:103], a[52:55], v[24:27]
    ds_read_b64 v[142:143], v140 offset:2048
    v_cvt_pk_bf16_f32 v66, v36, v37
    v_mfma_f32_16x16x32_bf16 v[24:27], a[96:99], a[48:51], v[24:27]
    v_exp_f32 v46, v46
    v_mfma_f32_16x16x32_bf16 v[32:35], a[96:99], a[64:67], v[112:115]
    v_mfma_f32_16x16x32_bf16 v[32:35], a[100:103], a[68:71], v[32:35]
    global_load_lds_dwordx4 v132, s[16:17] offset:2048 nt
    v_mfma_f32_16x16x32_bf16 v[32:35], a[104:107], a[72:75], v[32:35]
    v_exp_f32 v47, v47
    v_mfma_f32_16x16x32_bf16 v[32:35], a[108:111], a[76:79], v[32:35]
    v_exp_f32 v8, v8
    v_mfma_f32_16x16x32_bf16 v[40:43], a[108:111], a[92:95], v[116:119]
    v_exp_f32 v1, v1
    v_mfma_f32_16x16x32_bf16 v[40:43], a[104:107], a[88:91], v[40:43]
    v_exp_f32 v3, v3
    v_mfma_f32_16x16x32_bf16 v[40:43], a[100:103], a[84:87], v[40:43]
    s_waitcnt lgkmcnt(0)
    v_cvt_pk_bf16_f32 v71, v46, v47
    v_mfma_f32_16x16x32_bf16 v[40:43], a[96:99], a[80:83], v[40:43]
    s_waitcnt vmcnt(6) lgkmcnt(0)
    s_barrier
    v_mfma_f32_16x16x32_bf16 v[4:7], a[112:115], a[0:3], v[96:99]
    v_exp_f32 v0, v0
    v_mfma_f32_16x16x32_bf16 v[4:7], a[116:119], a[4:7], v[4:7]
    v_exp_f32 v11, v11
    v_mfma_f32_16x16x32_bf16 v[4:7], a[120:123], a[8:11], v[4:7]
    v_exp_f32 v2, v2
    v_mfma_f32_16x16x32_bf16 v[4:7], a[124:127], a[12:15], v[4:7]
    ds_read_b64_tr_b16 a[96:97], v124 offset:32768
    v_lshlrev_b32 v138, 16, v142
    v_mfma_f32_16x16x32_bf16 v[12:15], a[124:127], a[28:31], v[100:103]
    ds_read_b64_tr_b16 a[98:99], v124 offset:40960
    v_and_b32 v139, 0xffff0000, v142
    v_mfma_f32_16x16x32_bf16 v[12:15], a[120:123], a[24:27], v[12:15]
    v_mul_f32 v138, s38, v138
    v_cvt_pk_bf16_f32 v70, v44, v45
    v_mfma_f32_16x16x32_bf16 v[12:15], a[116:119], a[20:23], v[12:15]
    v_mul_f32 v139, s38, v139
    v_cvt_pk_bf16_f32 v142, v138, v139
    v_mfma_f32_16x16x32_bf16 v[12:15], a[112:115], a[16:19], v[12:15]
    v_exp_f32 v10, v10
    v_mfma_f32_16x16x32_bf16 v[20:23], a[112:115], a[32:35], v[104:107]
    ds_read_b64_tr_b16 a[100:101], v125 offset:32768
    v_add_u32 v132, 8192, v132
    v_mfma_f32_16x16x32_bf16 v[20:23], a[116:119], a[36:39], v[20:23]
    v_exp_f32 v9, v9
    v_mfma_f32_16x16x32_bf16 v[20:23], a[120:123], a[40:43], v[20:23]
L_pad4:
    s_cbranch_vccz L_padret0
    v_exp_f32 v17, v17
    v_mfma_f32_16x16x32_bf16 v[20:23], a[124:127], a[44:47], v[20:23]
    ds_read_b64_tr_b16 a[102:103], v125 offset:40960
    v_lshlrev_b32 v138, 16, v143
    v_mfma_f32_16x16x32_bf16 v[28:31], a[124:127], a[60:63], v[108:111]
    v_cvt_pk_bf16_f32 v72, v0, v1
    v_cvt_pk_bf16_f32 v76, v8, v9
    v_mfma_f32_16x16x32_bf16 v[28:31], a[120:123], a[56:59], v[28:31]
    ds_read_b64_tr_b16 a[104:105], v126 offset:32768
    v_cvt_pk_bf16_f32 v73, v2, v3
    v_mfma_f32_16x16x32_bf16 v[28:31], a[116:119], a[52:55], v[28:31]
    v_exp_f32 v26, v26
    v_mfma_f32_16x16x32_bf16 v[28:31], a[112:115], a[48:51], v[28:31]
    ds_read_b64_tr_b16 a[106:107], v126 offset:40960
    v_and_b32 v139, 0xffff0000, v143
    v_mfma_f32_16x16x32_bf16 v[36:39], a[112:115], a[64:67], v[112:115]
    v_exp_f32 v24, v24
    v_mfma_f32_16x16x32_bf16 v[36:39], a[116:119], a[68:71], v[36:39]
    v_mul_f32 v138, s38, v138
    v_mul_f32 v139, s38, v139
    v_mfma_f32_16x16x32_bf16 v[36:39], a[120:123], a[72:75], v[36:39]
    v_exp_f32 v16, v16
    v_mfma_f32_16x16x32_bf16 v[36:39], a[124:127], a[76:79], v[36:39]
    s_waitcnt lgkmcnt(2)
    v_cvt_pk_bf16_f32 v143, v138, v139
    v_mfma_f32_16x16x32_bf16 v[44:47], a[124:127], a[92:95], v[116:119]
    v_exp_f32 v34, v34
    v_mfma_f32_16x16x32_bf16 v[44:47], a[120:123], a[88:91], v[44:47]
    v_exp_f32 v32, v32
    v_mfma_f32_16x16x32_bf16 v[44:47], a[116:119], a[84:87], v[44:47]
    v_exp_f32 v25, v25
    v_mfma_f32_16x16x32_bf16 v[44:47], a[112:115], a[80:83], v[44:47]
    ds_write_b64 v140, v[142:143] offset:2048
    v_mfma_f32_16x16x32_bf16 v[144:147], v[48:51], a[96:99], v[144:147]
    ds_read_b64_tr_b16 a[108:109], v127 offset:32768
    s_mov_b32 m0, s32
    v_mfma_f32_16x16x32_bf16 a[128:131], v[48:51], a[136:139], a[128:131]
    ds_read_b64_tr_b16 a[110:111], v127 offset:40960
    s_add_u32 s32, s32, 2048
    v_mfma_f32_16x16x32_bf16 v[148:151], v[48:51], a[100:103], v[148:151]
    global_load_lds_dwordx4 v133, s[20:21] nt
    v_mfma_f32_16x16x32_bf16 v[180:183], v[52:55], a[100:103], v[180:183]
    v_exp_f32 v18, v18
    v_mfma_f32_16x16x32_bf16 a[128:131], v[52:55], a[140:143], a[128:131]
    ds_read_b64 v[142:143], v140 offset:2560
    v_mfma_f32_16x16x32_bf16 v[176:179], v[52:55], a[96:99], v[176:179]
    ds_read_b64_tr_b16 a[112:113], v128 offset:32768
    v_mfma_f32_16x16x32_bf16 v[208:211], v[56:59], a[96:99], v[208:211]
    v_exp_f32 v4, v4
    v_mfma_f32_16x16x32_bf16 v[212:215], v[56:59], a[100:103], v[212:215]
    v_exp_f32 v7, v7
    v_mfma_f32_16x16x32_bf16 v[244:247], v[60:63], a[100:103], v[244:247]
    v_exp_f32 v27, v27
    v_mfma_f32_16x16x32_bf16 v[240:243], v[60:63], a[96:99], v[240:243]
    ds_read_b64_tr_b16 a[114:115], v128 offset:40960
    v_cvt_pk_bf16_f32 v80, v16, v17
    v_mfma_f32_16x16x32_bf16 a[192:195], v[64:67], a[96:99], a[192:195]
    v_exp_f32 v33, v33
    v_mfma_f32_16x16x32_bf16 a[196:199], v[64:67], a[100:103], a[196:199]
    ds_read_b64_tr_b16 a[116:117], v129 offset:32768
    s_waitcnt lgkmcnt(3)
    v_mfma_f32_16x16x32_bf16 a[228:231], v[68:71], a[100:103], a[228:231]
    ds_read_b64_tr_b16 a[118:119], v129 offset:40960
    v_exp_f32 v43, v43
    v_mfma_f32_16x16x32_bf16 a[224:227], v[68:71], a[96:99], a[224:227]
    ds_read_b64_tr_b16 a[120:121], v130 offset:32768
    v_mfma_f32_16x16x32_bf16 a[232:235], v[68:71], a[104:107], a[232:235]
    global_load_lds_dwordx4 v134, s[20:21] offset:1024 nt
    v_mfma_f32_16x16x32_bf16 a[132:135], v[68:71], a[144:147], a[132:135]
    ds_read_b64_tr_b16 a[122:123], v130 offset:40960
    s_add_u32 s20, s20, 2048
    s_addc_u32 s21, s21, 0
    v_mfma_f32_16x16x32_bf16 a[236:239], v[68:71], a[108:111], a[236:239]
    v_exp_f32 v42, v42
    v_mfma_f32_16x16x32_bf16 a[204:207], v[64:67], a[108:111], a[204:207]
    ds_read_b64_tr_b16 a[124:125], v131 offset:32768
    v_cvt_pk_bf16_f32 v85, v26, v27
    v_mfma_f32_16x16x32_bf16 a[132:135], v[64:67], a[140:143], a[132:135]
    v_exp_f32 v19, v19
    v_mfma_f32_16x16x32_bf16 a[200:203], v[64:67], a[104:107], a[200:203]
    ds_read_b64_tr_b16 a[126:127], v131 offset:40960
    v_lshlrev_b32 v138, 16, v142
    v_mfma_f32_16x16x32_bf16 v[248:251], v[60:63], a[104:107], v[248:251]
    v_exp_f32 v41, v41
    v_mfma_f32_16x16x32_bf16 v[252:255], v[60:63], a[108:111], v[252:255]
    v_exp_f32 v40, v40
    v_mfma_f32_16x16x32_bf16 v[220:223], v[56:59], a[108:111], v[220:223]
    v_exp_f32 v13, v13
    v_mfma_f32_16x16x32_bf16 v[216:219], v[56:59], a[104:107], v[216:219]
    v_exp_f32 v35, v35
    v_mfma_f32_16x16x32_bf16 v[184:187], v[52:55], a[104:107], v[184:187]
    v_and_b32 v139, 0xffff0000, v142
    v_cvt_pk_bf16_f32 v93, v42, v43
    v_mfma_f32_16x16x32_bf16 v[188:191], v[52:55], a[108:111], v[188:191]
    v_exp_f32 v6, v6
    v_mfma_f32_16x16x32_bf16 v[156:159], v[48:51], a[108:111], v[156:159]
    v_exp_f32 v22, v22
    v_mfma_f32_16x16x32_bf16 v[152:155], v[48:51], a[104:107], v[152:155]
    s_waitcnt lgkmcnt(0)
    v_mul_f32 v138, s38, v138
    v_mfma_f32_16x16x32_bf16 v[160:163], v[48:51], a[112:115], v[160:163]
    ds_read_b128 a[96:99], v120 offset:32768
    v_cvt_pk_bf16_f32 v84, v24, v25
    v_mfma_f32_16x16x32_bf16 v[164:167], v[48:51], a[116:119], v[164:167]
    v_exp_f32 v5, v5
    v_mfma_f32_16x16x32_bf16 v[196:199], v[52:55], a[116:119], v[196:199]
    v_mul_f32 v139, s38, v139
    v_cvt_pk_bf16_f32 v75, v6, v7
    v_mfma_f32_16x16x32_bf16 v[192:195], v[52:55], a[112:115], v[192:195]
    v_exp_f32 v28, v28
    v_mfma_f32_16x16x32_bf16 v[224:227], v[56:59], a[112:115], v[224:227]
    ds_read_b128 a[100:103], v121 offset:32768
    v_cvt_pk_bf16_f32 v142, v138, v139
    v_mfma_f32_16x16x32_bf16 a[128:131], v[56:59], a[144:147], a[128:131]
    v_cvt_pk_bf16_f32 v92, v40, v41
    v_cvt_pk_bf16_f32 v74, v4, v5
    v_mfma_f32_16x16x32_bf16 v[228:231], v[56:59], a[116:119], v[228:231]
    v_lshlrev_b32 v138, 16, v143
    v_cvt_pk_bf16_f32 v88, v32, v33
    v_mfma_f32_16x16x32_bf16 a[180:183], v[60:63], a[116:119], a[180:183]
    v_and_b32 v139, 0xffff0000, v143
    v_mul_f32 v138, s38, v138
    v_mfma_f32_16x16x32_bf16 a[176:179], v[60:63], a[112:115], a[176:179]
    v_exp_f32 v21, v21
    v_mfma_f32_16x16x32_bf16 a[208:211], v[64:67], a[112:115], a[208:211]
    v_exp_f32 v20, v20
    v_mfma_f32_16x16x32_bf16 a[212:215], v[64:67], a[116:119], a[212:215]
    ds_read_b128 a[104:107], v122 offset:32768
    v_mul_f32 v139, s38, v139
    v_mfma_f32_16x16x32_bf16 a[244:247], v[68:71], a[116:119], a[244:247]
    v_exp_f32 v15, v15
    v_mfma_f32_16x16x32_bf16 a[240:243], v[68:71], a[112:115], a[240:243]
    ds_read_b128 a[108:111], v123 offset:32768
    v_cvt_pk_bf16_f32 v89, v34, v35
    v_mfma_f32_16x16x32_bf16 a[248:251], v[68:71], a[120:123], a[248:251]
    v_exp_f32 v12, v12
    v_mfma_f32_16x16x32_bf16 a[252:255], v[68:71], a[124:127], a[252:255]
    v_exp_f32 v23, v23
    v_mfma_f32_16x16x32_bf16 a[220:223], v[64:67], a[124:127], a[220:223]
    v_cvt_pk_bf16_f32 v143, v138, v139
    v_cvt_pk_bf16_f32 v81, v18, v19
    v_mfma_f32_16x16x32_bf16 a[216:219], v[64:67], a[120:123], a[216:219]
    v_exp_f32 v30, v30
    v_mfma_f32_16x16x32_bf16 a[184:187], v[60:63], a[120:123], a[184:187]
    v_cvt_pk_bf16_f32 v77, v10, v11
    v_cvt_pk_bf16_f32 v82, v20, v21
    v_mfma_f32_16x16x32_bf16 a[132:135], v[60:63], a[136:139], a[132:135]
    v_exp_f32 v29, v29
    v_mfma_f32_16x16x32_bf16 a[188:191], v[60:63], a[124:127], a[188:191]
    v_exp_f32 v31, v31
    v_mfma_f32_16x16x32_bf16 v[236:239], v[56:59], a[124:127], v[236:239]
    s_waitcnt lgkmcnt(0)
    v_cvt_pk_bf16_f32 v83, v22, v23
    v_mfma_f32_16x16x32_bf16 v[232:235], v[56:59], a[120:123], v[232:235]
    ds_write_b64 v140, v[142:143] offset:2560
    v_mfma_f32_16x16x32_bf16 v[200:203], v[52:55], a[120:123], v[200:203]
    v_cvt_pk_bf16_f32 v78, v12, v13
    v_cvt_pk_bf16_f32 v87, v30, v31
    v_mfma_f32_16x16x32_bf16 v[204:207], v[52:55], a[124:127], v[204:207]
    v_exp_f32 v14, v14
    v_mfma_f32_16x16x32_bf16 v[172:175], v[48:51], a[124:127], v[172:175]
    v_cvt_pk_bf16_f32 v79, v14, v15
    v_cvt_pk_bf16_f32 v86, v28, v29
    v_mfma_f32_16x16x32_bf16 v[168:171], v[48:51], a[120:123], v[168:171]
    v_mfma_f32_16x16x32_bf16 v[0:3], a[96:99], a[0:3], v[96:99]
    s_add_u32 m0, s30, 0
    v_mfma_f32_16x16x32_bf16 v[0:3], a[100:103], a[4:7], v[0:3]
    ds_read_b128 a[112:115], v120 offset:40960
    v_mfma_f32_16x16x32_bf16 v[0:3], a[104:107], a[8:11], v[0:3]
    global_load_lds_dwordx4 v132, s[22:23] offset:1024 nt
    v_mfma_f32_16x16x32_bf16 v[0:3], a[108:111], a[12:15], v[0:3]
    v_exp_f32 v39, v39
    v_mfma_f32_16x16x32_bf16 v[8:11], a[108:111], a[28:31], v[100:103]
    v_exp_f32 v38, v38
    v_mfma_f32_16x16x32_bf16 v[8:11], a[104:107], a[24:27], v[8:11]
    v_exp_f32 v37, v37
    v_mfma_f32_16x16x32_bf16 v[8:11], a[100:103], a[20:23], v[8:11]
    ds_read_b128 a[116:119], v121 offset:40960
    v_mfma_f32_16x16x32_bf16 v[8:11], a[96:99], a[16:19], v[8:11]
    global_load_lds_dwordx4 v132, s[16:17] nt
    v_mfma_f32_16x16x32_bf16 v[16:19], a[96:99], a[32:35], v[104:107]
    v_exp_f32 v46, v46
    v_mfma_f32_16x16x32_bf16 v[16:19], a[100:103], a[36:39], v[16:19]
    ds_read_b64 v[142:143], v140 offset:3072
    v_exp_f32 v47, v47
    v_mfma_f32_16x16x32_bf16 v[16:19], a[104:107], a[40:43], v[16:19]
    v_exp_f32 v36, v36
    v_mfma_f32_16x16x32_bf16 v[16:19], a[108:111], a[44:47], v[16:19]
    ds_read_b128 a[120:123], v122 offset:40960
    v_mfma_f32_16x16x32_bf16 v[24:27], a[108:111], a[60:63], v[108:111]
    global_load_lds_dwordx4 v132, s[22:23] offset:3072 nt
    v_mfma_f32_16x16x32_bf16 v[24:27], a[104:107], a[56:59], v[24:27]
    ds_read_b128 a[124:127], v123 offset:40960
    v_cvt_pk_bf16_f32 v90, v36, v37
    v_mfma_f32_16x16x32_bf16 v[24:27], a[100:103], a[52:55], v[24:27]
    v_exp_f32 v1, v1
    v_mfma_f32_16x16x32_bf16 v[24:27], a[96:99], a[48:51], v[24:27]
    v_exp_f32 v44, v44
    v_mfma_f32_16x16x32_bf16 v[32:35], a[96:99], a[64:67], v[112:115]
    s_waitcnt lgkmcnt(2)
    v_mfma_f32_16x16x32_bf16 v[32:35], a[100:103], a[68:71], v[32:35]
    global_load_lds_dwordx4 v132, s[16:17] offset:2048 nt
    v_mfma_f32_16x16x32_bf16 v[32:35], a[104:107], a[72:75], v[32:35]
    v_exp_f32 v45, v45
    v_mfma_f32_16x16x32_bf16 v[32:35], a[108:111], a[76:79], v[32:35]
    v_exp_f32 v8, v8
    v_mfma_f32_16x16x32_bf16 v[40:43], a[108:111], a[92:95], v[116:119]
    v_exp_f32 v10, v10
    v_mfma_f32_16x16x32_bf16 v[40:43], a[104:107], a[88:91], v[40:43]
    v_lshlrev_b32 v138, 16, v142
    v_and_b32 v139, 0xffff0000, v142
    v_mfma_f32_16x16x32_bf16 v[40:43], a[100:103], a[84:87], v[40:43]
    v_mul_f32 v138, s38, v138
    v_cvt_pk_bf16_f32 v91, v38, v39
    v_mfma_f32_16x16x32_bf16 v[40:43], a[96:99], a[80:83], v[40:43]
    s_waitcnt vmcnt(6) lgkmcnt(0)
    s_barrier
    v_mfma_f32_16x16x32_bf16 v[4:7], a[112:115], a[0:3], v[96:99]
    ds_read_b64_tr_b16 a[96:97], v124 offset:49152
    v_mul_f32 v139, s38, v139
    v_mfma_f32_16x16x32_bf16 v[4:7], a[116:119], a[4:7], v[4:7]
    ds_read_b64_tr_b16 a[98:99], v124 offset:57344
    v_cvt_pk_bf16_f32 v142, v138, v139
    v_mfma_f32_16x16x32_bf16 v[4:7], a[120:123], a[8:11], v[4:7]
    v_cvt_pk_bf16_f32 v94, v44, v45
    v_cvt_pk_bf16_f32 v95, v46, v47
    v_mfma_f32_16x16x32_bf16 v[4:7], a[124:127], a[12:15], v[4:7]
    v_exp_f32 v17, v17
    v_mfma_f32_16x16x32_bf16 v[12:15], a[124:127], a[28:31], v[100:103]
    ds_read_b64_tr_b16 a[100:101], v125 offset:49152
    v_mfma_f32_16x16x32_bf16 v[12:15], a[120:123], a[24:27], v[12:15]
    v_lshlrev_b32 v138, 16, v143
    v_mfma_f32_16x16x32_bf16 v[12:15], a[116:119], a[20:23], v[12:15]
    ds_read_b64_tr_b16 a[102:103], v125 offset:57344
    v_add_u32 v132, 8192, v132
    v_mfma_f32_16x16x32_bf16 v[12:15], a[112:115], a[16:19], v[12:15]
    v_exp_f32 v40, v40
    v_mfma_f32_16x16x32_bf16 v[20:23], a[112:115], a[32:35], v[104:107]
    v_exp_f32 v0, v0
    v_mfma_f32_16x16x32_bf16 v[20:23], a[116:119], a[36:39], v[20:23]
    v_exp_f32 v34, v34
    v_mfma_f32_16x16x32_bf16 v[20:23], a[120:123], a[40:43], v[20:23]
    v_exp_f32 v2, v2
    v_mfma_f32_16x16x32_bf16 v[20:23], a[124:127], a[44:47], v[20:23]
    v_exp_f32 v16, v16
    v_mfma_f32_16x16x32_bf16 v[28:31], a[124:127], a[60:63], v[108:111]
    ds_read_b64_tr_b16 a[104:105], v126 offset:49152
    v_and_b32 v139, 0xffff0000, v143
    v_mfma_f32_16x16x32_bf16 v[28:31], a[120:123], a[56:59], v[28:31]
    ds_read_b64_tr_b16 a[106:107], v126 offset:57344
    v_mfma_f32_16x16x32_bf16 v[28:31], a[116:119], a[52:55], v[28:31]
    v_exp_f32 v3, v3
    v_mfma_f32_16x16x32_bf16 v[28:31], a[112:115], a[48:51], v[28:31]
    v_exp_f32 v18, v18
    v_mfma_f32_16x16x32_bf16 v[36:39], a[112:115], a[64:67], v[112:115]
    v_exp_f32 v11, v11
    v_mfma_f32_16x16x32_bf16 v[36:39], a[116:119], a[68:71], v[36:39]
    s_waitcnt lgkmcnt(2)
    v_mul_f32 v138, s38, v138
    v_mfma_f32_16x16x32_bf16 v[36:39], a[120:123], a[72:75], v[36:39]
    v_exp_f32 v9, v9
    v_mfma_f32_16x16x32_bf16 v[36:39], a[124:127], a[76:79], v[36:39]
    v_mul_f32 v139, s38, v139
    v_cvt_pk_bf16_f32 v143, v138, v139
    v_mfma_f32_16x16x32_bf16 v[44:47], a[124:127], a[92:95], v[116:119]
    ds_read_b64_tr_b16 a[108:109], v127 offset:49152
    v_cvt_pk_bf16_f32 v49, v2, v3
    v_mfma_f32_16x16x32_bf16 v[44:47], a[120:123], a[88:91], v[44:47]
    ds_read_b64_tr_b16 a[110:111], v127 offset:57344
    v_cvt_pk_bf16_f32 v53, v10, v11
    v_mfma_f32_16x16x32_bf16 v[44:47], a[116:119], a[84:87], v[44:47]
    v_exp_f32 v19, v19
    v_mfma_f32_16x16x32_bf16 v[44:47], a[112:115], a[80:83], v[44:47]
    ds_write_b64 v140, v[142:143] offset:3072
    v_mfma_f32_16x16x32_bf16 v[144:147], v[72:75], a[96:99], v[144:147]
    ds_read_b64_tr_b16 a[112:113], v128 offset:49152
    s_mov_b32 m0, s32
    v_mfma_f32_16x16x32_bf16 a[128:131], v[72:75], a[136:139], a[128:131]
    ds_read_b64_tr_b16 a[114:115], v128 offset:57344
    v_mfma_f32_16x16x32_bf16 v[148:151], v[72:75], a[100:103], v[148:151]
    global_load_lds_dwordx4 v133, s[20:21] nt
    v_mfma_f32_16x16x32_bf16 v[180:183], v[76:79], a[100:103], v[180:183]
    v_exp_f32 v33, v33
    v_mfma_f32_16x16x32_bf16 a[128:131], v[76:79], a[140:143], a[128:131]
    v_exp_f32 v24, v24
    v_exp_f32 v35, v35
    v_mfma_f32_16x16x32_bf16 v[176:179], v[76:79], a[96:99], v[176:179]
    v_exp_f32 v4, v4
    v_mfma_f32_16x16x32_bf16 v[208:211], v[80:83], a[96:99], v[208:211]
    v_exp_f32 v26, v26
    v_mfma_f32_16x16x32_bf16 v[212:215], v[80:83], a[100:103], v[212:215]
    ds_read_b64_tr_b16 a[116:117], v129 offset:49152
    s_add_u32 s32, s32, 2048
    v_mfma_f32_16x16x32_bf16 v[244:247], v[84:87], a[100:103], v[244:247]
    v_exp_f32 v25, v25
    v_mfma_f32_16x16x32_bf16 v[240:243], v[84:87], a[96:99], v[240:243]
    ds_read_b64 v[142:143], v140 offset:3584
    v_cvt_pk_bf16_f32 v48, v0, v1
    v_mfma_f32_16x16x32_bf16 a[192:195], v[88:91], a[96:99], a[192:195]
    ds_read_b64_tr_b16 a[118:119], v129 offset:57344
    v_cvt_pk_bf16_f32 v56, v16, v17
    v_mfma_f32_16x16x32_bf16 a[196:199], v[88:91], a[100:103], a[196:199]
    v_exp_f32 v32, v32
    v_mfma_f32_16x16x32_bf16 a[228:231], v[92:95], a[100:103], a[228:231]
    ds_read_b64_tr_b16 a[120:121], v130 offset:49152
    v_cvt_pk_bf16_f32 v57, v18, v19
    v_mfma_f32_16x16x32_bf16 a[224:227], v[92:95], a[96:99], a[224:227]
    ds_read_b64_tr_b16 a[122:123], v130 offset:57344
    s_waitcnt lgkmcnt(8)
    v_mfma_f32_16x16x32_bf16 a[232:235], v[92:95], a[104:107], a[232:235]
    global_load_lds_dwordx4 v134, s[20:21] offset:1024 nt
    v_mfma_f32_16x16x32_bf16 a[132:135], v[92:95], a[144:147], a[132:135]
    s_add_u32 s20, s20, 2048
    s_addc_u32 s21, s21, 0
    v_mfma_f32_16x16x32_bf16 a[236:239], v[92:95], a[108:111], a[236:239]
    ds_read_b64_tr_b16 a[124:125], v131 offset:49152
    v_cvt_pk_bf16_f32 v64, v32, v33
    v_mfma_f32_16x16x32_bf16 a[204:207], v[88:91], a[108:111], a[204:207]
    v_exp_f32 v5, v5
    v_mfma_f32_16x16x32_bf16 a[132:135], v[88:91], a[140:143], a[132:135]
    ds_read_b64_tr_b16 a[126:127], v131 offset:57344
    s_waitcnt lgkmcnt(5)
    v_mfma_f32_16x16x32_bf16 a[200:203], v[88:91], a[104:107], a[200:203]
    v_exp_f32 v27, v27
    v_mfma_f32_16x16x32_bf16 v[248:251], v[84:87], a[104:107], v[248:251]
    v_exp_f32 v20, v20
    v_mfma_f32_16x16x32_bf16 v[252:255], v[84:87], a[108:111], v[252:255]
    v_exp_f32 v15, v15
    v_mfma_f32_16x16x32_bf16 v[220:223], v[80:83], a[108:111], v[220:223]
    v_exp_f32 v41, v41
    v_mfma_f32_16x16x32_bf16 v[216:219], v[80:83], a[104:107], v[216:219]
    v_cvt_pk_bf16_f32 v60, v24, v25
    v_cvt_pk_bf16_f32 v50, v4, v5
    v_mfma_f32_16x16x32_bf16 v[184:187], v[76:79], a[104:107], v[184:187]
    v_cvt_pk_bf16_f32 v68, v40, v41
    v_exp_f32 v43, v43
    v_mfma_f32_16x16x32_bf16 v[188:191], v[76:79], a[108:111], v[188:191]
    v_exp_f32 v6, v6
    v_mfma_f32_16x16x32_bf16 v[156:159], v[72:75], a[108:111], v[156:159]
    s_waitcnt lgkmcnt(0)
    v_lshlrev_b32 v138, 16, v142
    v_mfma_f32_16x16x32_bf16 v[152:155], v[72:75], a[104:107], v[152:155]
    v_exp_f32 v42, v42
    v_mfma_f32_16x16x32_bf16 v[160:163], v[72:75], a[112:115], v[160:163]
    ds_read_b128 a[96:99], v120 offset:49152
    v_and_b32 v139, 0xffff0000, v142
    v_mfma_f32_16x16x32_bf16 v[164:167], v[72:75], a[116:119], v[164:167]
    v_exp_f32 v7, v7
    v_mfma_f32_16x16x32_bf16 v[196:199], v[76:79], a[116:119], v[196:199]
    ds_read_b128 a[100:103], v121 offset:49152
    v_cvt_pk_bf16_f32 v65, v34, v35
    v_mfma_f32_16x16x32_bf16 v[192:195], v[76:79], a[112:115], v[192:195]
    ds_read_b128 a[104:107], v122 offset:49152
    v_mul_f32 v138, s38, v138
    v_mfma_f32_16x16x32_bf16 v[224:227], v[80:83], a[112:115], v[224:227]
    v_exp_f32 v14, v14
    v_mfma_f32_16x16x32_bf16 a[128:131], v[80:83], a[144:147], a[128:131]
    v_exp_f32 v31, v31
    v_mfma_f32_16x16x32_bf16 v[228:231], v[80:83], a[116:119], v[228:231]
    v_exp_f32 v30, v30
    v_mfma_f32_16x16x32_bf16 a[180:183], v[84:87], a[116:119], a[180:183]
    v_exp_f32 v28, v28
    v_mfma_f32_16x16x32_bf16 a[176:179], v[84:87], a[112:115], a[176:179]
    v_mul_f32 v139, s38, v139
    v_cvt_pk_bf16_f32 v142, v138, v139
    v_mfma_f32_16x16x32_bf16 a[208:211], v[88:91], a[112:115], a[208:211]
    ds_read_b128 a[108:111], v123 offset:49152
    v_cvt_pk_bf16_f32 v69, v42, v43
    v_mfma_f32_16x16x32_bf16 a[212:215], v[88:91], a[116:119], a[212:215]
    v_lshlrev_b32 v138, 16, v143
    v_and_b32 v139, 0xffff0000, v143
    v_mfma_f32_16x16x32_bf16 a[244:247], v[92:95], a[116:119], a[244:247]
    v_exp_f32 v12, v12
    v_mfma_f32_16x16x32_bf16 a[240:243], v[92:95], a[112:115], a[240:243]
    v_exp_f32 v21, v21
    v_mfma_f32_16x16x32_bf16 a[248:251], v[92:95], a[120:123], a[248:251]
    v_exp_f32 v13, v13
    v_mfma_f32_16x16x32_bf16 a[252:255], v[92:95], a[124:127], a[252:255]
    v_mul_f32 v138, s38, v138
    v_mul_f32 v139, s38, v139
    v_mfma_f32_16x16x32_bf16 a[220:223], v[88:91], a[124:127], a[220:223]
    v_exp_f32 v29, v29
    v_mfma_f32_16x16x32_bf16 a[216:219], v[88:91], a[120:123], a[216:219]
    v_exp_f32 v22, v22
    v_mfma_f32_16x16x32_bf16 a[184:187], v[84:87], a[120:123], a[184:187]
    v_exp_f32 v23, v23
    v_mfma_f32_16x16x32_bf16 a[132:135], v[84:87], a[136:139], a[132:135]
    v_cvt_pk_bf16_f32 v143, v138, v139
    v_cvt_pk_bf16_f32 v61, v26, v27
    v_mfma_f32_16x16x32_bf16 a[188:191], v[84:87], a[124:127], a[188:191]
    v_cvt_pk_bf16_f32 v58, v20, v21
    v_cvt_pk_bf16_f32 v62, v28, v29
    v_mfma_f32_16x16x32_bf16 v[236:239], v[80:83], a[124:127], v[236:239]
    v_cvt_pk_bf16_f32 v55, v14, v15
    v_cvt_pk_bf16_f32 v59, v22, v23
    v_mfma_f32_16x16x32_bf16 v[232:235], v[80:83], a[120:123], v[232:235]
    ds_write_b64 v140, v[142:143] offset:3584
    v_mfma_f32_16x16x32_bf16 v[200:203], v[76:79], a[120:123], v[200:203]
    v_cvt_pk_bf16_f32 v52, v8, v9
    v_cvt_pk_bf16_f32 v51, v6, v7
    v_mfma_f32_16x16x32_bf16 v[204:207], v[76:79], a[124:127], v[204:207]
    v_add_u32 v140, 4096, v140
    v_cvt_pk_bf16_f32 v54, v12, v13
    v_mfma_f32_16x16x32_bf16 v[172:175], v[72:75], a[124:127], v[172:175]
    s_waitcnt lgkmcnt(1)
    v_cvt_pk_bf16_f32 v63, v30, v31
    v_mfma_f32_16x16x32_bf16 v[168:171], v[72:75], a[120:123], v[168:171]
    s_sub_u32 s3, s3, 1
    s_cbranch_scc0 L_A
    v_mfma_f32_16x16x32_bf16 v[0:3], a[96:99], a[0:3], v[96:99]
    s_add_u32 m0, s30, 16384
    v_mfma_f32_16x16x32_bf16 v[0:3], a[100:103], a[4:7], v[0:3]
    ds_read_b128 a[112:115], v120 offset:57344
    v_mfma_f32_16x16x32_bf16 v[0:3], a[104:107], a[8:11], v[0:3]
    global_load_lds_dwordx4 v132, s[22:23] offset:1024 nt
    v_mfma_f32_16x16x32_bf16 v[0:3], a[108:111], a[12:15], v[0:3]
    v_exp_f32 v36, v36
    v_mfma_f32_16x16x32_bf16 v[8:11], a[108:111], a[28:31], v[100:103]
    v_exp_f32 v37, v37
    v_mfma_f32_16x16x32_bf16 v[8:11], a[104:107], a[24:27], v[8:11]
    v_cvt_pk_bf16_f32 v66, v36, v37
    v_mfma_f32_16x16x32_bf16 v[8:11], a[100:103], a[20:23], v[8:11]
    ds_read_b128 a[116:119], v121 offset:57344
    v_mfma_f32_16x16x32_bf16 v[8:11], a[96:99], a[16:19], v[8:11]
    global_load_lds_dwordx4 v132, s[16:17] nt
    v_mfma_f32_16x16x32_bf16 v[16:19], a[96:99], a[32:35], v[104:107]
    v_exp_f32 v38, v38
    v_mfma_f32_16x16x32_bf16 v[16:19], a[100:103], a[36:39], v[16:19]
    v_exp_f32 v39, v39
    v_mfma_f32_16x16x32_bf16 v[16:19], a[104:107], a[40:43], v[16:19]
    v_cvt_pk_bf16_f32 v67, v38, v39
    v_mfma_f32_16x16x32_bf16 v[16:19], a[108:111], a[44:47], v[16:19]
    ds_read_b128 a[120:123], v122 offset:57344
    v_mfma_f32_16x16x32_bf16 v[24:27], a[108:111], a[60:63], v[108:111]
    global_load_lds_dwordx4 v132, s[22:23] offset:3072 nt
    v_mfma_f32_16x16x32_bf16 v[24:27], a[104:107], a[56:59], v[24:27]
    ds_read_b128 a[124:127], v123 offset:57344
    v_mfma_f32_16x16x32_bf16 v[24:27], a[100:103], a[52:55], v[24:27]
    v_exp_f32 v44, v44
    v_mfma_f32_16x16x32_bf16 v[24:27], a[96:99], a[48:51], v[24:27]
    v_exp_f32 v45, v45
    v_mfma_f32_16x16x32_bf16 v[32:35], a[96:99], a[64:67], v[112:115]
    v_mfma_f32_16x16x32_bf16 v[32:35], a[100:103], a[68:71], v[32:35]
    global_load_lds_dwordx4 v132, s[16:17] offset:2048 nt
    v_mfma_f32_16x16x32_bf16 v[32:35], a[104:107], a[72:75], v[32:35]
    v_exp_f32 v46, v46
    v_mfma_f32_16x16x32_bf16 v[32:35], a[108:111], a[76:79], v[32:35]
    v_add_u32 v132, 8192, v132
    v_cvt_pk_bf16_f32 v70, v44, v45
    v_mfma_f32_16x16x32_bf16 v[40:43], a[108:111], a[92:95], v[116:119]
    v_exp_f32 v47, v47
    v_mfma_f32_16x16x32_bf16 v[40:43], a[104:107], a[88:91], v[40:43]
    v_cvt_pk_bf16_f32 v71, v46, v47
    v_mfma_f32_16x16x32_bf16 v[40:43], a[100:103], a[84:87], v[40:43]
    v_mfma_f32_16x16x32_bf16 v[40:43], a[96:99], a[80:83], v[40:43]
    s_waitcnt vmcnt(6) lgkmcnt(0)
    s_barrier
    v_mfma_f32_16x16x32_bf16 v[4:7], a[112:115], a[0:3], v[96:99]
    v_exp_f32 v0, v0
    v_mfma_f32_16x16x32_bf16 v[4:7], a[116:119], a[4:7], v[4:7]
    v_exp_f32 v1, v1
    v_mfma_f32_16x16x32_bf16 v[4:7], a[120:123], a[8:11], v[4:7]
    ds_read_b64_tr_b16 a[96:97], v124
    v_cvt_pk_bf16_f32 v72, v0, v1
    v_mfma_f32_16x16x32_bf16 v[4:7], a[124:127], a[12:15], v[4:7]
    v_exp_f32 v2, v2
    v_mfma_f32_16x16x32_bf16 v[12:15], a[124:127], a[28:31], v[100:103]
    ds_read_b64_tr_b16 a[98:99], v124 offset:8192
    v_mfma_f32_16x16x32_bf16 v[12:15], a[120:123], a[24:27], v[12:15]
    v_exp_f32 v3, v3
    v_mfma_f32_16x16x32_bf16 v[12:15], a[116:119], a[20:23], v[12:15]
    ds_read_b64_tr_b16 a[100:101], v125
    v_cvt_pk_bf16_f32 v73, v2, v3
    v_mfma_f32_16x16x32_bf16 v[12:15], a[112:115], a[16:19], v[12:15]
    v_exp_f32 v8, v8
    v_mfma_f32_16x16x32_bf16 v[20:23], a[112:115], a[32:35], v[104:107]
    ds_read_b64_tr_b16 a[102:103], v125 offset:8192
    v_mfma_f32_16x16x32_bf16 v[20:23], a[116:119], a[36:39], v[20:23]
    v_exp_f32 v9, v9
    v_mfma_f32_16x16x32_bf16 v[20:23], a[120:123], a[40:43], v[20:23]
    ds_read_b64_tr_b16 a[104:105], v126
    v_cvt_pk_bf16_f32 v76, v8, v9
    v_mfma_f32_16x16x32_bf16 v[20:23], a[124:127], a[44:47], v[20:23]
    v_exp_f32 v10, v10
    v_mfma_f32_16x16x32_bf16 v[28:31], a[124:127], a[60:63], v[108:111]
    v_exp_f32 v11, v11
    v_mfma_f32_16x16x32_bf16 v[28:31], a[120:123], a[56:59], v[28:31]
    ds_read_b64_tr_b16 a[106:107], v126 offset:8192
    v_cvt_pk_bf16_f32 v77, v10, v11
    v_mfma_f32_16x16x32_bf16 v[28:31], a[116:119], a[52:55], v[28:31]
    v_exp_f32 v16, v16
    v_mfma_f32_16x16x32_bf16 v[28:31], a[112:115], a[48:51], v[28:31]
    ds_read_b64_tr_b16 a[108:109], v127
    v_mfma_f32_16x16x32_bf16 v[36:39], a[112:115], a[64:67], v[112:115]
    v_exp_f32 v17, v17
    v_mfma_f32_16x16x32_bf16 v[36:39], a[116:119], a[68:71], v[36:39]
    s_waitcnt lgkmcnt(3)
    v_cvt_pk_bf16_f32 v80, v16, v17
    v_mfma_f32_16x16x32_bf16 v[36:39], a[120:123], a[72:75], v[36:39]
    v_exp_f32 v18, v18
    v_mfma_f32_16x16x32_bf16 v[36:39], a[124:127], a[76:79], v[36:39]
    ds_read_b64_tr_b16 a[110:111], v127 offset:8192
    v_mfma_f32_16x16x32_bf16 v[44:47], a[124:127], a[92:95], v[116:119]
    v_exp_f32 v19, v19
    v_mfma_f32_16x16x32_bf16 v[44:47], a[120:123], a[88:91], v[44:47]
    v_cvt_pk_bf16_f32 v81, v18, v19
    v_mfma_f32_16x16x32_bf16 v[44:47], a[116:119], a[84:87], v[44:47]
    v_exp_f32 v24, v24
    v_mfma_f32_16x16x32_bf16 v[44:47], a[112:115], a[80:83], v[44:47]
    v_mfma_f32_16x16x32_bf16 v[144:147], v[48:51], a[96:99], v[144:147]
    ds_read_b64_tr_b16 a[112:113], v128
    s_mov_b32 m0, s32
    v_mfma_f32_16x16x32_bf16 a[128:131], v[48:51], a[136:139], a[128:131]
    ds_read_b64_tr_b16 a[114:115], v128 offset:8192
    s_add_u32 s32, s32, 1024
    v_mfma_f32_16x16x32_bf16 v[148:151], v[48:51], a[100:103], v[148:151]
    global_load_lds_dwordx4 v133, s[20:21] nt
    v_mfma_f32_16x16x32_bf16 v[180:183], v[52:55], a[100:103], v[180:183]
    s_add_u32 s20, s20, 1024
    s_addc_u32 s21, s21, 0
    v_mfma_f32_16x16x32_bf16 a[128:131], v[52:55], a[140:143], a[128:131]
    v_exp_f32 v25, v25
    v_mfma_f32_16x16x32_bf16 v[176:179], v[52:55], a[96:99], v[176:179]
    v_exp_f32 v26, v26
    v_mfma_f32_16x16x32_bf16 v[208:211], v[56:59], a[96:99], v[208:211]
    s_waitcnt lgkmcnt(2)
    v_cvt_pk_bf16_f32 v84, v24, v25
    v_mfma_f32_16x16x32_bf16 v[212:215], v[56:59], a[100:103], v[212:215]
    v_exp_f32 v27, v27
    v_mfma_f32_16x16x32_bf16 v[244:247], v[60:63], a[100:103], v[244:247]
    ds_read_b64_tr_b16 a[116:117], v129
    v_cvt_pk_bf16_f32 v85, v26, v27
    v_mfma_f32_16x16x32_bf16 v[240:243], v[60:63], a[96:99], v[240:243]
    v_exp_f32 v32, v32
    v_mfma_f32_16x16x32_bf16 a[192:195], v[64:67], a[96:99], a[192:195]
    v_exp_f32 v33, v33
    v_mfma_f32_16x16x32_bf16 a[196:199], v[64:67], a[100:103], a[196:199]
    ds_read_b64_tr_b16 a[118:119], v129 offset:8192
    v_cvt_pk_bf16_f32 v88, v32, v33
    v_mfma_f32_16x16x32_bf16 a[228:231], v[68:71], a[100:103], a[228:231]
    v_exp_f32 v34, v34
    v_mfma_f32_16x16x32_bf16 a[224:227], v[68:71], a[96:99], a[224:227]
    ds_read_b64_tr_b16 a[120:121], v130
    v_mfma_f32_16x16x32_bf16 a[232:235], v[68:71], a[104:107], a[232:235]
    v_exp_f32 v35, v35
    v_mfma_f32_16x16x32_bf16 a[132:135], v[68:71], a[144:147], a[132:135]
    ds_read_b64_tr_b16 a[122:123], v130 offset:8192
    v_cvt_pk_bf16_f32 v89, v34, v35
    v_mfma_f32_16x16x32_bf16 a[236:239], v[68:71], a[108:111], a[236:239]
    v_exp_f32 v40, v40
    v_mfma_f32_16x16x32_bf16 a[204:207], v[64:67], a[108:111], a[204:207]
    ds_read_b64_tr_b16 a[124:125], v131
    v_mfma_f32_16x16x32_bf16 a[132:135], v[64:67], a[140:143], a[132:135]
    v_exp_f32 v41, v41
    v_mfma_f32_16x16x32_bf16 a[200:203], v[64:67], a[104:107], a[200:203]
    ds_read_b64_tr_b16 a[126:127], v131 offset:8192
    v_cvt_pk_bf16_f32 v92, v40, v41
    v_mfma_f32_16x16x32_bf16 v[248:251], v[60:63], a[104:107], v[248:251]
    v_exp_f32 v42, v42
    v_mfma_f32_16x16x32_bf16 v[252:255], v[60:63], a[108:111], v[252:255]
    v_exp_f32 v43, v43
    v_mfma_f32_16x16x32_bf16 v[220:223], v[56:59], a[108:111], v[220:223]
    v_cvt_pk_bf16_f32 v93, v42, v43
    v_mfma_f32_16x16x32_bf16 v[216:219], v[56:59], a[104:107], v[216:219]
    v_exp_f32 v4, v4
    v_mfma_f32_16x16x32_bf16 v[184:187], v[52:55], a[104:107], v[184:187]
    v_exp_f32 v6, v6
    v_mfma_f32_16x16x32_bf16 v[188:191], v[52:55], a[108:111], v[188:191]
    v_exp_f32 v5, v5
    v_mfma_f32_16x16x32_bf16 v[156:159], v[48:51], a[108:111], v[156:159]
    v_cvt_pk_bf16_f32 v74, v4, v5
    v_mfma_f32_16x16x32_bf16 v[152:155], v[48:51], a[104:107], v[152:155]
    s_waitcnt lgkmcnt(0)
    v_mfma_f32_16x16x32_bf16 v[160:163], v[48:51], a[112:115], v[160:163]
    ds_read_b128 a[96:99], v120
    v_mfma_f32_16x16x32_bf16 v[164:167], v[48:51], a[116:119], v[164:167]
    v_exp_f32 v7, v7
    v_mfma_f32_16x16x32_bf16 v[196:199], v[52:55], a[116:119], v[196:199]
    ds_read_b128 a[100:103], v121
    v_cvt_pk_bf16_f32 v75, v6, v7
    v_mfma_f32_16x16x32_bf16 v[192:195], v[52:55], a[112:115], v[192:195]
    v_exp_f32 v12, v12
    v_mfma_f32_16x16x32_bf16 v[224:227], v[56:59], a[112:115], v[224:227]
    ds_read_b128 a[104:107], v122
    v_mfma_f32_16x16x32_bf16 a[128:131], v[56:59], a[144:147], a[128:131]
    v_exp_f32 v13, v13
    v_mfma_f32_16x16x32_bf16 v[228:231], v[56:59], a[116:119], v[228:231]
    v_exp_f32 v14, v14
    v_mfma_f32_16x16x32_bf16 a[180:183], v[60:63], a[116:119], a[180:183]
    ds_read_b128 a[108:111], v123
    v_cvt_pk_bf16_f32 v78, v12, v13
    v_mfma_f32_16x16x32_bf16 a[176:179], v[60:63], a[112:115], a[176:179]
    v_exp_f32 v15, v15
    v_mfma_f32_16x16x32_bf16 a[208:211], v[64:67], a[112:115], a[208:211]
    v_cvt_pk_bf16_f32 v79, v14, v15
L_pad5:
    s_cbranch_vccz L_padret1
    v_mfma_f32_16x16x32_bf16 a[212:215], v[64:67], a[116:119], a[212:215]
    v_exp_f32 v20, v20
    v_mfma_f32_16x16x32_bf16 a[244:247], v[68:71], a[116:119], a[244:247]
    v_mfma_f32_16x16x32_bf16 a[240:243], v[68:71], a[112:115], a[240:243]
    v_exp_f32 v21, v21
    v_mfma_f32_16x16x32_bf16 a[248:251], v[68:71], a[120:123], a[248:251]
    v_cvt_pk_bf16_f32 v82, v20, v21
    v_mfma_f32_16x16x32_bf16 a[252:255], v[68:71], a[124:127], a[252:255]
    v_exp_f32 v22, v22
    v_mfma_f32_16x16x32_bf16 a[220:223], v[64:67], a[124:127], a[220:223]
    s_waitcnt lgkmcnt(0)
    v_mfma_f32_16x16x32_bf16 a[216:219], v[64:67], a[120:123], a[216:219]
    v_exp_f32 v23, v23
    v_mfma_f32_16x16x32_bf16 a[184:187], v[60:63], a[120:123], a[184:187]
    v_cvt_pk_bf16_f32 v83, v22, v23
    v_mfma_f32_16x16x32_bf16 a[132:135], v[60:63], a[136:139], a[132:135]
    v_exp_f32 v28, v28
    v_mfma_f32_16x16x32_bf16 a[188:191], v[60:63], a[124:127], a[188:191]
    v_exp_f32 v29, v29
    v_mfma_f32_16x16x32_bf16 v[236:239], v[56:59], a[124:127], v[236:239]
    v_cvt_pk_bf16_f32 v86, v28, v29
    v_mfma_f32_16x16x32_bf16 v[232:235], v[56:59], a[120:123], v[232:235]
    v_exp_f32 v30, v30
    v_mfma_f32_16x16x32_bf16 v[200:203], v[52:55], a[120:123], v[200:203]
    v_mfma_f32_16x16x32_bf16 v[204:207], v[52:55], a[124:127], v[204:207]
    v_exp_f32 v31, v31
    v_mfma_f32_16x16x32_bf16 v[172:175], v[48:51], a[124:127], v[172:175]
    v_cvt_pk_bf16_f32 v87, v30, v31
    v_mfma_f32_16x16x32_bf16 v[168:171], v[48:51], a[120:123], v[168:171]
    v_mfma_f32_16x16x32_bf16 v[0:3], a[96:99], a[0:3], v[96:99]
    s_add_u32 m0, s30, 32768
    v_mfma_f32_16x16x32_bf16 v[0:3], a[100:103], a[4:7], v[0:3]
    ds_read_b128 a[112:115], v120 offset:8192
    v_mfma_f32_16x16x32_bf16 v[0:3], a[104:107], a[8:11], v[0:3]
    global_load_lds_dwordx4 v132, s[22:23] offset:1024 nt
    v_mfma_f32_16x16x32_bf16 v[0:3], a[108:111], a[12:15], v[0:3]
    v_exp_f32 v36, v36
    v_mfma_f32_16x16x32_bf16 v[8:11], a[108:111], a[28:31], v[100:103]
    v_exp_f32 v37, v37
    v_mfma_f32_16x16x32_bf16 v[8:11], a[104:107], a[24:27], v[8:11]
    v_cvt_pk_bf16_f32 v90, v36, v37
    v_mfma_f32_16x16x32_bf16 v[8:11], a[100:103], a[20:23], v[8:11]
    ds_read_b128 a[116:119], v121 offset:8192
    v_mfma_f32_16x16x32_bf16 v[8:11], a[96:99], a[16:19], v[8:11]
    global_load_lds_dwordx4 v132, s[16:17] nt
    v_mfma_f32_16x16x32_bf16 v[16:19], a[96:99], a[32:35], v[104:107]
    v_exp_f32 v38, v38
    v_mfma_f32_16x16x32_bf16 v[16:19], a[100:103], a[36:39], v[16:19]
    v_exp_f32 v39, v39
    v_mfma_f32_16x16x32_bf16 v[16:19], a[104:107], a[40:43], v[16:19]
    v_cvt_pk_bf16_f32 v91, v38, v39
    v_mfma_f32_16x16x32_bf16 v[16:19], a[108:111], a[44:47], v[16:19]
    ds_read_b128 a[120:123], v122 offset:8192
    v_mfma_f32_16x16x32_bf16 v[24:27], a[108:111], a[60:63], v[108:111]
    global_load_lds_dwordx4 v132, s[22:23] offset:3072 nt
    v_mfma_f32_16x16x32_bf16 v[24:27], a[104:107], a[56:59], v[24:27]
    ds_read_b128 a[124:127], v123 offset:8192
    v_mfma_f32_16x16x32_bf16 v[24:27], a[100:103], a[52:55], v[24:27]
    v_exp_f32 v44, v44
    v_mfma_f32_16x16x32_bf16 v[24:27], a[96:99], a[48:51], v[24:27]
    v_exp_f32 v45, v45
    v_mfma_f32_16x16x32_bf16 v[32:35], a[96:99], a[64:67], v[112:115]
    v_mfma_f32_16x16x32_bf16 v[32:35], a[100:103], a[68:71], v[32:35]
    global_load_lds_dwordx4 v132, s[16:17] offset:2048 nt
    v_mfma_f32_16x16x32_bf16 v[32:35], a[104:107], a[72:75], v[32:35]
    v_exp_f32 v46, v46
    v_mfma_f32_16x16x32_bf16 v[32:35], a[108:111], a[76:79], v[32:35]
    v_add_u32 v132, 8192, v132
    v_cvt_pk_bf16_f32 v94, v44, v45
    v_mfma_f32_16x16x32_bf16 v[40:43], a[108:111], a[92:95], v[116:119]
    v_exp_f32 v47, v47
    v_mfma_f32_16x16x32_bf16 v[40:43], a[104:107], a[88:91], v[40:43]
    v_cvt_pk_bf16_f32 v95, v46, v47
    v_mfma_f32_16x16x32_bf16 v[40:43], a[100:103], a[84:87], v[40:43]
    v_mfma_f32_16x16x32_bf16 v[40:43], a[96:99], a[80:83], v[40:43]
    s_waitcnt vmcnt(5) lgkmcnt(0)
    s_barrier
    v_mfma_f32_16x16x32_bf16 v[4:7], a[112:115], a[0:3], v[96:99]
    v_exp_f32 v0, v0
    v_mfma_f32_16x16x32_bf16 v[4:7], a[116:119], a[4:7], v[4:7]
    v_exp_f32 v1, v1
    v_mfma_f32_16x16x32_bf16 v[4:7], a[120:123], a[8:11], v[4:7]
    ds_read_b64_tr_b16 a[96:97], v124 offset:16384
    v_cvt_pk_bf16_f32 v48, v0, v1
    v_mfma_f32_16x16x32_bf16 v[4:7], a[124:127], a[12:15], v[4:7]
    v_exp_f32 v2, v2
    v_mfma_f32_16x16x32_bf16 v[12:15], a[124:127], a[28:31], v[100:103]
    ds_read_b64_tr_b16 a[98:99], v124 offset:24576
    v_mfma_f32_16x16x32_bf16 v[12:15], a[120:123], a[24:27], v[12:15]
    v_exp_f32 v3, v3
    v_mfma_f32_16x16x32_bf16 v[12:15], a[116:119], a[20:23], v[12:15]
    ds_read_b64_tr_b16 a[100:101], v125 offset:16384
    v_cvt_pk_bf16_f32 v49, v2, v3
    v_mfma_f32_16x16x32_bf16 v[12:15], a[112:115], a[16:19], v[12:15]
    v_exp_f32 v8, v8
    v_mfma_f32_16x16x32_bf16 v[20:23], a[112:115], a[32:35], v[104:107]
    ds_read_b64_tr_b16 a[102:103], v125 offset:24576
    v_mfma_f32_16x16x32_bf16 v[20:23], a[116:119], a[36:39], v[20:23]
    v_exp_f32 v9, v9
    v_mfma_f32_16x16x32_bf16 v[20:23], a[120:123], a[40:43], v[20:23]
    v_exp_f32 v10, v10
    v_mfma_f32_16x16x32_bf16 v[20:23], a[124:127], a[44:47], v[20:23]
    ds_read_b64_tr_b16 a[104:105], v126 offset:16384
    v_cvt_pk_bf16_f32 v52, v8, v9
    v_mfma_f32_16x16x32_bf16 v[28:31], a[124:127], a[60:63], v[108:111]
    v_exp_f32 v11, v11
    v_mfma_f32_16x16x32_bf16 v[28:31], a[120:123], a[56:59], v[28:31]
    ds_read_b64_tr_b16 a[106:107], v126 offset:24576
    v_cvt_pk_bf16_f32 v53, v10, v11
    v_mfma_f32_16x16x32_bf16 v[28:31], a[116:119], a[52:55], v[28:31]
    v_exp_f32 v16, v16
    v_mfma_f32_16x16x32_bf16 v[28:31], a[112:115], a[48:51], v[28:31]
    ds_read_b64_tr_b16 a[108:109], v127 offset:16384
    v_mfma_f32_16x16x32_bf16 v[36:39], a[112:115], a[64:67], v[112:115]
    v_exp_f32 v17, v17
    v_mfma_f32_16x16x32_bf16 v[36:39], a[116:119], a[68:71], v[36:39]
    v_exp_f32 v18, v18
    v_mfma_f32_16x16x32_bf16 v[36:39], a[120:123], a[72:75], v[36:39]
    s_waitcnt lgkmcnt(3)
    v_cvt_pk_bf16_f32 v56, v16, v17
    v_mfma_f32_16x16x32_bf16 v[36:39], a[124:127], a[76:79], v[36:39]
    v_exp_f32 v19, v19
    v_mfma_f32_16x16x32_bf16 v[44:47], a[124:127], a[92:95], v[116:119]
    ds_read_b64_tr_b16 a[110:111], v127 offset:24576
    v_cvt_pk_bf16_f32 v57, v18, v19
    v_mfma_f32_16x16x32_bf16 v[44:47], a[120:123], a[88:91], v[44:47]
    v_exp_f32 v24, v24
    v_mfma_f32_16x16x32_bf16 v[44:47], a[116:119], a[84:87], v[44:47]
    v_mfma_f32_16x16x32_bf16 v[44:47], a[112:115], a[80:83], v[44:47]
    v_exp_f32 v25, v25
    v_mfma_f32_16x16x32_bf16 v[144:147], v[72:75], a[96:99], v[144:147]
    ds_read_b64_tr_b16 a[112:113], v128 offset:16384
    v_cvt_pk_bf16_f32 v60, v24, v25
    v_mfma_f32_16x16x32_bf16 a[128:131], v[72:75], a[136:139], a[128:131]
    v_exp_f32 v26, v26
    v_mfma_f32_16x16x32_bf16 v[148:151], v[72:75], a[100:103], v[148:151]
    v_exp_f32 v27, v27
    v_mfma_f32_16x16x32_bf16 v[180:183], v[76:79], a[100:103], v[180:183]
    ds_read_b64_tr_b16 a[114:115], v128 offset:24576
    v_cvt_pk_bf16_f32 v61, v26, v27
    v_mfma_f32_16x16x32_bf16 a[128:131], v[76:79], a[140:143], a[128:131]
    v_exp_f32 v32, v32
    v_mfma_f32_16x16x32_bf16 v[176:179], v[76:79], a[96:99], v[176:179]
    ds_read_b64_tr_b16 a[116:117], v129 offset:16384
    s_waitcnt lgkmcnt(3)
    v_mfma_f32_16x16x32_bf16 v[208:211], v[80:83], a[96:99], v[208:211]
    v_exp_f32 v33, v33
    v_mfma_f32_16x16x32_bf16 v[212:215], v[80:83], a[100:103], v[212:215]
    ds_read_b64_tr_b16 a[118:119], v129 offset:24576
    v_cvt_pk_bf16_f32 v64, v32, v33
    v_mfma_f32_16x16x32_bf16 v[244:247], v[84:87], a[100:103], v[244:247]
    v_exp_f32 v34, v34
    v_mfma_f32_16x16x32_bf16 v[240:243], v[84:87], a[96:99], v[240:243]
    ds_read_b64_tr_b16 a[120:121], v130 offset:16384
    v_mfma_f32_16x16x32_bf16 a[192:195], v[88:91], a[96:99], a[192:195]
    v_exp_f32 v35, v35
    v_mfma_f32_16x16x32_bf16 a[196:199], v[88:91], a[100:103], a[196:199]
    v_exp_f32 v40, v40
    v_mfma_f32_16x16x32_bf16 a[228:231], v[92:95], a[100:103], a[228:231]
    ds_read_b64_tr_b16 a[122:123], v130 offset:24576
    v_cvt_pk_bf16_f32 v65, v34, v35
    v_mfma_f32_16x16x32_bf16 a[224:227], v[92:95], a[96:99], a[224:227]
    v_exp_f32 v41, v41
    v_mfma_f32_16x16x32_bf16 a[232:235], v[92:95], a[104:107], a[232:235]
    ds_read_b64_tr_b16 a[124:125], v131 offset:16384
    v_cvt_pk_bf16_f32 v68, v40, v41
    v_mfma_f32_16x16x32_bf16 a[132:135], v[92:95], a[144:147], a[132:135]
    v_exp_f32 v42, v42
    v_mfma_f32_16x16x32_bf16 a[236:239], v[92:95], a[108:111], a[236:239]
    ds_read_b64_tr_b16 a[126:127], v131 offset:24576
    v_mfma_f32_16x16x32_bf16 a[204:207], v[88:91], a[108:111], a[204:207]
    v_exp_f32 v43, v43
    v_mfma_f32_16x16x32_bf16 a[132:135], v[88:91], a[140:143], a[132:135]
    v_cvt_pk_bf16_f32 v69, v42, v43
    v_mfma_f32_16x16x32_bf16 a[200:203], v[88:91], a[104:107], a[200:203]
    v_exp_f32 v4, v4
    v_mfma_f32_16x16x32_bf16 v[248:251], v[84:87], a[104:107], v[248:251]
    v_exp_f32 v5, v5
    v_mfma_f32_16x16x32_bf16 v[252:255], v[84:87], a[108:111], v[252:255]
    v_cvt_pk_bf16_f32 v50, v4, v5
    v_mfma_f32_16x16x32_bf16 v[220:223], v[80:83], a[108:111], v[220:223]
    v_exp_f32 v6, v6
    v_mfma_f32_16x16x32_bf16 v[216:219], v[80:83], a[104:107], v[216:219]
    v_mfma_f32_16x16x32_bf16 v[184:187], v[76:79], a[104:107], v[184:187]
    v_exp_f32 v7, v7
    v_mfma_f32_16x16x32_bf16 v[188:191], v[76:79], a[108:111], v[188:191]
    s_waitcnt lgkmcnt(0)
    v_cvt_pk_bf16_f32 v51, v6, v7
    v_mfma_f32_16x16x32_bf16 v[156:159], v[72:75], a[108:111], v[156:159]
    v_exp_f32 v12, v12
    v_mfma_f32_16x16x32_bf16 v[152:155], v[72:75], a[104:107], v[152:155]
    v_mfma_f32_16x16x32_bf16 v[160:163], v[72:75], a[112:115], v[160:163]
    v_exp_f32 v13, v13
    v_mfma_f32_16x16x32_bf16 v[164:167], v[72:75], a[116:119], v[164:167]
    v_exp_f32 v14, v14
    v_mfma_f32_16x16x32_bf16 v[196:199], v[76:79], a[116:119], v[196:199]
    ds_read_b128 a[96:99], v120 offset:16384
    v_cvt_pk_bf16_f32 v54, v12, v13
    v_mfma_f32_16x16x32_bf16 v[192:195], v[76:79], a[112:115], v[192:195]
    v_exp_f32 v15, v15
    v_mfma_f32_16x16x32_bf16 v[224:227], v[80:83], a[112:115], v[224:227]
    s_add_u32 m0, s30, 49152
    v_cvt_pk_bf16_f32 v55, v14, v15
    v_mfma_f32_16x16x32_bf16 a[128:131], v[80:83], a[144:147], a[128:131]
    ds_read_b128 a[100:103], v121 offset:16384
    v_mfma_f32_16x16x32_bf16 v[228:231], v[80:83], a[116:119], v[228:231]
    global_load_lds_dwordx4 v132, s[22:23] offset:1024 nt
    v_mfma_f32_16x16x32_bf16 a[180:183], v[84:87], a[116:119], a[180:183]
    v_exp_f32 v20, v20
    v_mfma_f32_16x16x32_bf16 a[176:179], v[84:87], a[112:115], a[176:179]
    v_exp_f32 v21, v21
    v_mfma_f32_16x16x32_bf16 a[208:211], v[88:91], a[112:115], a[208:211]
    ds_read_b128 a[104:107], v122 offset:16384
    v_cvt_pk_bf16_f32 v58, v20, v21
    v_mfma_f32_16x16x32_bf16 a[212:215], v[88:91], a[116:119], a[212:215]
    ds_read_b128 a[108:111], v123 offset:16384
    v_mfma_f32_16x16x32_bf16 a[244:247], v[92:95], a[116:119], a[244:247]
    global_load_lds_dwordx4 v132, s[16:17] nt
    v_mfma_f32_16x16x32_bf16 a[240:243], v[92:95], a[112:115], a[240:243]
    v_exp_f32 v22, v22
    v_mfma_f32_16x16x32_bf16 a[248:251], v[92:95], a[120:123], a[248:251]
    v_exp_f32 v23, v23
    v_mfma_f32_16x16x32_bf16 a[252:255], v[92:95], a[124:127], a[252:255]
    v_cvt_pk_bf16_f32 v59, v22, v23
    v_mfma_f32_16x16x32_bf16 a[220:223], v[88:91], a[124:127], a[220:223]
    v_mfma_f32_16x16x32_bf16 a[216:219], v[88:91], a[120:123], a[216:219]
    global_load_lds_dwordx4 v132, s[22:23] offset:3072 nt
    v_mfma_f32_16x16x32_bf16 a[184:187], v[84:87], a[120:123], a[184:187]
    v_exp_f32 v28, v28
    v_mfma_f32_16x16x32_bf16 a[132:135], v[84:87], a[136:139], a[132:135]
    v_exp_f32 v29, v29
    v_mfma_f32_16x16x32_bf16 a[188:191], v[84:87], a[124:127], a[188:191]
    s_waitcnt lgkmcnt(0)
    v_cvt_pk_bf16_f32 v62, v28, v29
    v_mfma_f32_16x16x32_bf16 v[236:239], v[80:83], a[124:127], v[236:239]
    v_mfma_f32_16x16x32_bf16 v[232:235], v[80:83], a[120:123], v[232:235]
    global_load_lds_dwordx4 v132, s[16:17] offset:2048 nt
    v_mfma_f32_16x16x32_bf16 v[200:203], v[76:79], a[120:123], v[200:203]
    v_exp_f32 v30, v30
    v_mfma_f32_16x16x32_bf16 v[204:207], v[76:79], a[124:127], v[204:207]
    v_exp_f32 v31, v31
    v_mfma_f32_16x16x32_bf16 v[172:175], v[72:75], a[124:127], v[172:175]
    v_add_u32 v132, 8192, v132
    v_cvt_pk_bf16_f32 v63, v30, v31
    v_mfma_f32_16x16x32_bf16 v[168:171], v[72:75], a[120:123], v[168:171]
    v_mfma_f32_16x16x32_bf16 v[0:3], a[96:99], a[0:3], v[96:99]
    v_exp_f32 v46, v46
    v_mfma_f32_16x16x32_bf16 v[0:3], a[100:103], a[4:7], v[0:3]
    ds_read_b128 a[112:115], v120 offset:24576
    v_xor_b32 v139, 192, v136
    v_mfma_f32_16x16x32_bf16 v[0:3], a[104:107], a[8:11], v[0:3]
    v_exp_f32 v44, v44
    v_mfma_f32_16x16x32_bf16 v[0:3], a[108:111], a[12:15], v[0:3]
    v_exp_f32 v47, v47
    v_mfma_f32_16x16x32_bf16 v[8:11], a[108:111], a[28:31], v[100:103]
    v_exp_f32 v45, v45
    v_mfma_f32_16x16x32_bf16 v[8:11], a[104:107], a[24:27], v[8:11]
    v_exp_f32 v36, v36
    v_mfma_f32_16x16x32_bf16 v[8:11], a[100:103], a[20:23], v[8:11]
    ds_read_b128 a[116:119], v121 offset:24576
    v_cvt_pk_bf16_f32 v71, v46, v47
    v_mfma_f32_16x16x32_bf16 v[8:11], a[96:99], a[16:19], v[8:11]
    v_exp_f32 v39, v39
    v_mfma_f32_16x16x32_bf16 v[16:19], a[96:99], a[32:35], v[104:107]
    v_xor_b32 v138, 128, v136
    v_mfma_f32_16x16x32_bf16 v[16:19], a[100:103], a[36:39], v[16:19]
    v_exp_f32 v0, v0
    v_mfma_f32_16x16x32_bf16 v[16:19], a[104:107], a[40:43], v[16:19]
    v_exp_f32 v37, v37
    v_mfma_f32_16x16x32_bf16 v[16:19], a[108:111], a[44:47], v[16:19]
    ds_read_b128 a[120:123], v122 offset:24576
    v_mfma_f32_16x16x32_bf16 v[24:27], a[108:111], a[60:63], v[108:111]
    v_exp_f32 v38, v38
    v_mfma_f32_16x16x32_bf16 v[24:27], a[104:107], a[56:59], v[24:27]
    ds_read_b128 a[124:127], v123 offset:24576
    v_mfma_f32_16x16x32_bf16 v[24:27], a[100:103], a[52:55], v[24:27]
    v_exp_f32 v11, v11
    v_mfma_f32_16x16x32_bf16 v[24:27], a[96:99], a[48:51], v[24:27]
    v_exp_f32 v10, v10
    v_mfma_f32_16x16x32_bf16 v[32:35], a[96:99], a[64:67], v[112:115]
    v_exp_f32 v8, v8
    v_mfma_f32_16x16x32_bf16 v[32:35], a[100:103], a[68:71], v[32:35]
    v_exp_f32 v3, v3
    v_mfma_f32_16x16x32_bf16 v[32:35], a[104:107], a[72:75], v[32:35]
    v_exp_f32 v1, v1
    v_mfma_f32_16x16x32_bf16 v[32:35], a[108:111], a[76:79], v[32:35]
    v_exp_f32 v9, v9
    v_mfma_f32_16x16x32_bf16 v[40:43], a[108:111], a[92:95], v[116:119]
    v_cvt_pk_bf16_f32 v66, v36, v37
    v_cvt_pk_bf16_f32 v67, v38, v39
    v_mfma_f32_16x16x32_bf16 v[40:43], a[104:107], a[88:91], v[40:43]
    v_exp_f32 v17, v17
    v_mfma_f32_16x16x32_bf16 v[40:43], a[100:103], a[84:87], v[40:43]
    v_exp_f32 v2, v2
    v_mfma_f32_16x16x32_bf16 v[40:43], a[96:99], a[80:83], v[40:43]
    s_waitcnt vmcnt(4) lgkmcnt(0)
    s_barrier
    v_mfma_f32_16x16x32_bf16 v[4:7], a[112:115], a[0:3], v[96:99]
    ds_read_b64_tr_b16 a[96:97], v124 offset:32768
    v_cvt_pk_bf16_f32 v70, v44, v45
    v_mfma_f32_16x16x32_bf16 v[4:7], a[116:119], a[4:7], v[4:7]
    s_mov_b32 m0, s32
    v_subrev_u32 v140, 8192, v140
    v_mfma_f32_16x16x32_bf16 v[4:7], a[120:123], a[8:11], v[4:7]
    ds_read_b64_tr_b16 a[98:99], v124 offset:40960
    v_mfma_f32_16x16x32_bf16 v[4:7], a[124:127], a[12:15], v[4:7]
    global_load_lds_dwordx4 v134, s[20:21] nt
    v_mfma_f32_16x16x32_bf16 v[12:15], a[124:127], a[28:31], v[100:103]
    v_exp_f32 v24, v24
    v_mfma_f32_16x16x32_bf16 v[12:15], a[120:123], a[24:27], v[12:15]
    v_exp_f32 v34, v34
    v_mfma_f32_16x16x32_bf16 v[12:15], a[116:119], a[20:23], v[12:15]
    v_exp_f32 v25, v25
    v_mfma_f32_16x16x32_bf16 v[12:15], a[112:115], a[16:19], v[12:15]
    v_exp_f32 v16, v16
    v_mfma_f32_16x16x32_bf16 v[20:23], a[112:115], a[32:35], v[104:107]
    ds_read_b64_tr_b16 a[100:101], v125 offset:32768
    v_cvt_pk_bf16_f32 v72, v0, v1
    v_mfma_f32_16x16x32_bf16 v[20:23], a[116:119], a[36:39], v[20:23]
    v_exp_f32 v27, v27
    v_mfma_f32_16x16x32_bf16 v[20:23], a[120:123], a[40:43], v[20:23]
    v_exp_f32 v18, v18
    v_mfma_f32_16x16x32_bf16 v[20:23], a[124:127], a[44:47], v[20:23]
    ds_read_b64_tr_b16 a[102:103], v125 offset:40960
    v_mfma_f32_16x16x32_bf16 v[28:31], a[124:127], a[60:63], v[108:111]
    global_load_lds_dwordx4 v133, s[20:21] offset:1024 nt
    v_mfma_f32_16x16x32_bf16 v[28:31], a[120:123], a[56:59], v[28:31]
    ds_read_b64_tr_b16 a[104:105], v126 offset:32768
    s_add_u32 s32, s32, 4096
    v_mfma_f32_16x16x32_bf16 v[28:31], a[116:119], a[52:55], v[28:31]
    v_exp_f32 v26, v26
    v_mfma_f32_16x16x32_bf16 v[28:31], a[112:115], a[48:51], v[28:31]
    v_cvt_pk_bf16_f32 v77, v10, v11
    v_cvt_pk_bf16_f32 v85, v26, v27
    v_mfma_f32_16x16x32_bf16 v[36:39], a[112:115], a[64:67], v[112:115]
    v_exp_f32 v35, v35
    v_mfma_f32_16x16x32_bf16 v[36:39], a[116:119], a[68:71], v[36:39]
    v_cvt_pk_bf16_f32 v76, v8, v9
    v_cvt_pk_bf16_f32 v80, v16, v17
    v_mfma_f32_16x16x32_bf16 v[36:39], a[120:123], a[72:75], v[36:39]
    v_exp_f32 v12, v12
    v_mfma_f32_16x16x32_bf16 v[36:39], a[124:127], a[76:79], v[36:39]
    v_exp_f32 v43, v43
    v_mfma_f32_16x16x32_bf16 v[44:47], a[124:127], a[92:95], v[116:119]
    ds_read_b64_tr_b16 a[106:107], v126 offset:40960
    s_waitcnt lgkmcnt(2)
    v_mfma_f32_16x16x32_bf16 v[44:47], a[120:123], a[88:91], v[44:47]
    global_load_lds_dwordx4 v134, s[20:21] offset:2048 nt
    v_mfma_f32_16x16x32_bf16 v[44:47], a[116:119], a[84:87], v[44:47]
    ds_read_b64_tr_b16 a[108:109], v127 offset:32768
    v_cvt_pk_bf16_f32 v73, v2, v3
    v_mfma_f32_16x16x32_bf16 v[44:47], a[112:115], a[80:83], v[44:47]
    v_exp_f32 v32, v32
    v_mfma_f32_16x16x32_bf16 v[144:147], v[48:51], a[96:99], v[144:147]
    v_exp_f32 v42, v42
    v_mfma_f32_16x16x32_bf16 a[128:131], v[48:51], a[136:139], a[128:131]
    v_exp_f32 v33, v33
    v_mfma_f32_16x16x32_bf16 v[148:151], v[48:51], a[100:103], v[148:151]
    v_exp_f32 v19, v19
    v_mfma_f32_16x16x32_bf16 v[180:183], v[52:55], a[100:103], v[180:183]
    v_exp_f32 v41, v41
    v_mfma_f32_16x16x32_bf16 a[128:131], v[52:55], a[140:143], a[128:131]
    ds_read_b64_tr_b16 a[110:111], v127 offset:40960
    v_mfma_f32_16x16x32_bf16 v[176:179], v[52:55], a[96:99], v[176:179]
    ds_read_b64_tr_b16 a[112:113], v128 offset:32768
    v_mfma_f32_16x16x32_bf16 v[208:211], v[56:59], a[96:99], v[208:211]
    global_load_lds_dwordx4 v133, s[20:21] offset:3072 nt
    v_mfma_f32_16x16x32_bf16 v[212:215], v[56:59], a[100:103], v[212:215]
    s_add_u32 s20, s20, 4096
    s_addc_u32 s21, s21, 0
    v_mfma_f32_16x16x32_bf16 v[244:247], v[60:63], a[100:103], v[244:247]
    ds_read_b64_tr_b16 a[114:115], v128 offset:40960
    v_cvt_pk_bf16_f32 v89, v34, v35
    v_mfma_f32_16x16x32_bf16 v[240:243], v[60:63], a[96:99], v[240:243]
    v_exp_f32 v5, v5
    v_mfma_f32_16x16x32_bf16 a[192:195], v[64:67], a[96:99], a[192:195]
    v_exp_f32 v40, v40
    v_mfma_f32_16x16x32_bf16 a[196:199], v[64:67], a[100:103], a[196:199]
    ds_read_b64_tr_b16 a[116:117], v129 offset:32768
    v_cvt_pk_bf16_f32 v92, v40, v41
    v_mfma_f32_16x16x32_bf16 a[228:231], v[68:71], a[100:103], a[228:231]
    ds_read_b64_tr_b16 a[118:119], v129 offset:40960
    v_cvt_pk_bf16_f32 v84, v24, v25
    v_mfma_f32_16x16x32_bf16 a[224:227], v[68:71], a[96:99], a[224:227]
    ds_read_b64_tr_b16 a[120:121], v130 offset:32768
    s_waitcnt lgkmcnt(5)
    v_mfma_f32_16x16x32_bf16 a[232:235], v[68:71], a[104:107], a[232:235]
    ds_read_b64_tr_b16 a[122:123], v130 offset:40960
    v_cvt_pk_bf16_f32 v81, v18, v19
    v_mfma_f32_16x16x32_bf16 a[132:135], v[68:71], a[144:147], a[132:135]
    ds_read_b64_tr_b16 a[124:125], v131 offset:32768
    v_mfma_f32_16x16x32_bf16 a[236:239], v[68:71], a[108:111], a[236:239]
    ds_read_b64_tr_b16 a[126:127], v131 offset:40960
    v_cvt_pk_bf16_f32 v88, v32, v33
    v_mfma_f32_16x16x32_bf16 a[204:207], v[64:67], a[108:111], a[204:207]
    v_exp_f32 v4, v4
    v_mfma_f32_16x16x32_bf16 a[132:135], v[64:67], a[140:143], a[132:135]
    v_exp_f32 v15, v15
    v_mfma_f32_16x16x32_bf16 a[200:203], v[64:67], a[104:107], a[200:203]
    v_exp_f32 v13, v13
    v_mfma_f32_16x16x32_bf16 v[248:251], v[60:63], a[104:107], v[248:251]
    v_exp_f32 v21, v21
    v_mfma_f32_16x16x32_bf16 v[252:255], v[60:63], a[108:111], v[252:255]
    v_exp_f32 v30, v30
    v_mfma_f32_16x16x32_bf16 v[220:223], v[56:59], a[108:111], v[220:223]
    v_exp_f32 v14, v14
    v_mfma_f32_16x16x32_bf16 v[216:219], v[56:59], a[104:107], v[216:219]
    v_exp_f32 v31, v31
    v_mfma_f32_16x16x32_bf16 v[184:187], v[52:55], a[104:107], v[184:187]
    v_exp_f32 v22, v22
    v_mfma_f32_16x16x32_bf16 v[188:191], v[52:55], a[108:111], v[188:191]
    v_exp_f32 v20, v20
    v_mfma_f32_16x16x32_bf16 v[156:159], v[48:51], a[108:111], v[156:159]
    s_waitcnt lgkmcnt(0)
    v_cvt_pk_bf16_f32 v78, v12, v13
    v_mfma_f32_16x16x32_bf16 v[152:155], v[48:51], a[104:107], v[152:155]
    v_exp_f32 v37, v37
    v_mfma_f32_16x16x32_bf16 v[160:163], v[48:51], a[112:115], v[160:163]
    v_exp_f32 v36, v36
    v_mfma_f32_16x16x32_bf16 v[164:167], v[48:51], a[116:119], v[164:167]
    v_exp_f32 v39, v39
    v_mfma_f32_16x16x32_bf16 v[196:199], v[52:55], a[116:119], v[196:199]
    v_exp_f32 v7, v7
    v_mfma_f32_16x16x32_bf16 v[192:195], v[52:55], a[112:115], v[192:195]
    ds_read_b128 a[96:99], v120 offset:32768
    v_mfma_f32_16x16x32_bf16 v[224:227], v[56:59], a[112:115], v[224:227]
    ds_read_b128 a[100:103], v121 offset:32768
    v_cvt_pk_bf16_f32 v74, v4, v5
    v_mfma_f32_16x16x32_bf16 a[128:131], v[56:59], a[144:147], a[128:131]
    v_exp_f32 v29, v29
    v_mfma_f32_16x16x32_bf16 v[228:231], v[56:59], a[116:119], v[228:231]
    v_exp_f32 v23, v23
    v_mfma_f32_16x16x32_bf16 a[180:183], v[60:63], a[116:119], a[180:183]
    ds_read_b128 a[104:107], v122 offset:32768
    v_cvt_pk_bf16_f32 v90, v36, v37
    v_mfma_f32_16x16x32_bf16 a[176:179], v[60:63], a[112:115], a[176:179]
    v_exp_f32 v38, v38
    v_mfma_f32_16x16x32_bf16 a[208:211], v[64:67], a[112:115], a[208:211]
    v_mfma_f32_16x16x32_bf16 a[212:215], v[64:67], a[116:119], a[212:215]
    v_exp_f32 v6, v6
    v_mfma_f32_16x16x32_bf16 a[244:247], v[68:71], a[116:119], a[244:247]
    v_exp_f32 v47, v47
    v_mfma_f32_16x16x32_bf16 a[240:243], v[68:71], a[112:115], a[240:243]
    v_exp_f32 v28, v28
    v_mfma_f32_16x16x32_bf16 a[248:251], v[68:71], a[120:123], a[248:251]
    v_exp_f32 v44, v44
    v_mfma_f32_16x16x32_bf16 a[252:255], v[68:71], a[124:127], a[252:255]
    ds_read_b128 a[108:111], v123 offset:32768
    v_cvt_pk_bf16_f32 v83, v22, v23
    v_mfma_f32_16x16x32_bf16 a[220:223], v[64:67], a[124:127], a[220:223]
    v_cvt_pk_bf16_f32 v82, v20, v21
    v_mfma_f32_16x16x32_bf16 a[216:219], v[64:67], a[120:123], a[216:219]
    s_waitcnt vmcnt(4)
    s_barrier
    v_mfma_f32_16x16x32_bf16 a[184:187], v[60:63], a[120:123], a[184:187]
    ds_read_b64_tr_b16 a[64:65], v124 offset:49152
    v_mfma_f32_16x16x32_bf16 a[132:135], v[60:63], a[136:139], a[132:135]
    v_exp_f32 v45, v45
    v_mfma_f32_16x16x32_bf16 a[188:191], v[60:63], a[124:127], a[188:191]
    ds_read_b64_tr_b16 a[66:67], v124 offset:57344
    v_cvt_pk_bf16_f32 v86, v28, v29
    v_mfma_f32_16x16x32_bf16 v[236:239], v[56:59], a[124:127], v[236:239]
    v_exp_f32 v46, v46
    v_mfma_f32_16x16x32_bf16 v[232:235], v[56:59], a[120:123], v[232:235]
    ds_read_b64_tr_b16 a[68:69], v125 offset:49152
    v_mfma_f32_16x16x32_bf16 v[200:203], v[52:55], a[120:123], v[200:203]
    v_cvt_pk_bf16_f32 v91, v38, v39
    v_cvt_pk_bf16_f32 v94, v44, v45
    v_mfma_f32_16x16x32_bf16 v[204:207], v[52:55], a[124:127], v[204:207]
    ds_read_b64_tr_b16 a[70:71], v125 offset:57344
    v_cvt_pk_bf16_f32 v95, v46, v47
    v_mfma_f32_16x16x32_bf16 v[172:175], v[48:51], a[124:127], v[172:175]
    v_cvt_pk_bf16_f32 v79, v14, v15
    v_cvt_pk_bf16_f32 v87, v30, v31
    v_mfma_f32_16x16x32_bf16 v[168:171], v[48:51], a[120:123], v[168:171]
    v_cvt_pk_bf16_f32 v93, v42, v43
    v_cvt_pk_bf16_f32 v75, v6, v7
    s_nop 1
    v_mfma_f32_16x16x32_bf16 a[128:131], v[72:75], a[136:139], a[128:131]
    v_mfma_f32_16x16x32_bf16 a[128:131], v[76:79], a[140:143], a[128:131]
    ds_read_b128 v[16:19], v136 offset:8192
    v_mfma_f32_16x16x32_bf16 a[128:131], v[80:83], a[144:147], a[128:131]
    ds_read_b64_tr_b16 a[72:73], v126 offset:49152
    v_mfma_f32_16x16x32_bf16 a[132:135], v[84:87], a[136:139], a[132:135]
    ds_read_b64_tr_b16 a[74:75], v126 offset:57344
    v_mfma_f32_16x16x32_bf16 a[132:135], v[88:91], a[140:143], a[132:135]
    ds_read_b64_tr_b16 a[76:77], v127 offset:49152
    s_waitcnt lgkmcnt(4)
    v_mfma_f32_16x16x32_bf16 a[132:135], v[92:95], a[144:147], a[132:135]
    ds_read_b64_tr_b16 a[78:79], v127 offset:57344
    v_mfma_f32_16x16x32_bf16 v[144:147], v[72:75], a[64:67], v[144:147]
    s_add_u32 m0, s31, 20480
    s_mov_b32 s32, 118784
    v_mfma_f32_16x16x32_bf16 v[148:151], v[72:75], a[68:71], v[148:151]
    ds_read_b64_tr_b16 a[80:81], v128 offset:49152
    s_waitcnt lgkmcnt(5)
    v_mfma_f32_16x16x32_bf16 v[180:183], v[76:79], a[68:71], v[180:183]
    buffer_load_dwordx4 v134, s[12:15], s32 offen offset:3072 nt lds
    v_mfma_f32_16x16x32_bf16 v[176:179], v[76:79], a[64:67], v[176:179]
    ds_read_b64_tr_b16 a[82:83], v128 offset:57344
    v_lshlrev_b32 v0, 16, v16
    v_mfma_f32_16x16x32_bf16 v[208:211], v[80:83], a[64:67], v[208:211]
    ds_read_b64_tr_b16 a[84:85], v129 offset:49152
    v_accvgpr_read_b32 v112, a128
    v_mfma_f32_16x16x32_bf16 v[212:215], v[80:83], a[68:71], v[212:215]
    ds_read_b64_tr_b16 a[86:87], v129 offset:57344
    s_waitcnt lgkmcnt(4)
    v_mfma_f32_16x16x32_bf16 v[244:247], v[84:87], a[68:71], v[244:247]
    ds_read_b64_tr_b16 a[88:89], v130 offset:49152
    v_accvgpr_read_b32 v113, a129
    v_mfma_f32_16x16x32_bf16 v[240:243], v[84:87], a[64:67], v[240:243]
    ds_read_b64_tr_b16 a[90:91], v130 offset:57344
    v_accvgpr_read_b32 v114, a130
    v_mfma_f32_16x16x32_bf16 a[192:195], v[88:91], a[64:67], a[192:195]
    ds_read_b64_tr_b16 a[92:93], v131 offset:49152
    v_accvgpr_read_b32 v115, a131
    v_mfma_f32_16x16x32_bf16 a[196:199], v[88:91], a[68:71], a[196:199]
    ds_read_b64_tr_b16 a[94:95], v131 offset:57344
    v_add_f32 v60, v112, v113
    v_mfma_f32_16x16x32_bf16 a[228:231], v[92:95], a[68:71], a[228:231]
    v_add_f32 v60, v60, v114
    v_add_f32 v60, v60, v115
    v_mfma_f32_16x16x32_bf16 a[224:227], v[92:95], a[64:67], a[224:227]
    v_rcp_f32 v112, v112
    v_mfma_f32_16x16x32_bf16 a[232:235], v[92:95], a[72:75], a[232:235]
    s_add_u32 m0, s30, 0
    v_and_b32 v1, 0xffff0000, v16
    v_mfma_f32_16x16x32_bf16 a[236:239], v[92:95], a[76:79], a[236:239]
    v_mfma_f32_16x16x32_bf16 a[204:207], v[88:91], a[76:79], a[204:207]
    global_load_lds_dwordx4 v132, s[22:23] offset:1024 nt
    v_mfma_f32_16x16x32_bf16 a[200:203], v[88:91], a[72:75], a[200:203]
    s_waitcnt lgkmcnt(0)
    v_mul_f32 v0, s38, v0
    v_mfma_f32_16x16x32_bf16 v[248:251], v[84:87], a[72:75], v[248:251]
    v_rcp_f32 v113, v113
    v_mfma_f32_16x16x32_bf16 v[252:255], v[84:87], a[76:79], v[252:255]
    v_rcp_f32 v114, v114
    v_mfma_f32_16x16x32_bf16 v[220:223], v[80:83], a[76:79], v[220:223]
    ds_read_b128 a[112:115], v120 offset:40960
    v_mul_f32 v1, s38, v1
    v_mfma_f32_16x16x32_bf16 v[216:219], v[80:83], a[72:75], v[216:219]
    ds_read_b128 a[116:119], v121 offset:40960
    v_lshlrev_b32 v2, 16, v17
    v_mfma_f32_16x16x32_bf16 v[184:187], v[76:79], a[72:75], v[184:187]
    ds_read_b128 a[120:123], v122 offset:40960
    v_and_b32 v3, 0xffff0000, v17
    v_mfma_f32_16x16x32_bf16 v[188:191], v[76:79], a[76:79], v[188:191]
    ds_read_b128 a[124:127], v123 offset:40960
    v_mul_f32 v2, s38, v2
    v_mfma_f32_16x16x32_bf16 v[156:159], v[72:75], a[76:79], v[156:159]
    ds_read_b128 a[0:3], v136
    v_mul_f32 v3, s38, v3
    v_mfma_f32_16x16x32_bf16 v[152:155], v[72:75], a[72:75], v[152:155]
    ds_read_b128 a[4:7], v137
    v_lshlrev_b32 v4, 16, v18
    v_mfma_f32_16x16x32_bf16 v[160:163], v[72:75], a[80:83], v[160:163]
    ds_read_b128 a[8:11], v138
    v_and_b32 v5, 0xffff0000, v18
    v_mfma_f32_16x16x32_bf16 v[164:167], v[72:75], a[84:87], v[164:167]
    ds_read_b128 a[12:15], v139
    v_mfma_f32_16x16x32_bf16 v[196:199], v[76:79], a[84:87], v[196:199]
    global_load_lds_dwordx4 v132, s[16:17] nt
    v_mfma_f32_16x16x32_bf16 v[192:195], v[76:79], a[80:83], v[192:195]
    v_mul_f32 v4, s38, v4
    v_mfma_f32_16x16x32_bf16 v[224:227], v[80:83], a[80:83], v[224:227]
    ds_read_b128 a[16:19], v136 offset:4096
    v_mul_f32 v5, s38, v5
    v_mfma_f32_16x16x32_bf16 v[228:231], v[80:83], a[84:87], v[228:231]
    ds_read_b128 a[20:23], v137 offset:4096
    v_lshlrev_b32 v6, 16, v19
    v_mfma_f32_16x16x32_bf16 a[180:183], v[84:87], a[84:87], a[180:183]
    ds_read_b128 a[24:27], v138 offset:4096
    v_and_b32 v7, 0xffff0000, v19
    v_mfma_f32_16x16x32_bf16 a[176:179], v[84:87], a[80:83], a[176:179]
    ds_read_b128 a[28:31], v139 offset:4096
    v_mul_f32 v6, s38, v6
    v_mfma_f32_16x16x32_bf16 a[208:211], v[88:91], a[80:83], a[208:211]
    v_rcp_f32 v115, v115
    v_mfma_f32_16x16x32_bf16 a[212:215], v[88:91], a[84:87], a[212:215]
    v_accvgpr_read_b32 v116, a132
    v_accvgpr_read_b32 v117, a133
    v_mfma_f32_16x16x32_bf16 a[244:247], v[92:95], a[84:87], a[244:247]
    v_accvgpr_read_b32 v118, a134
    v_accvgpr_read_b32 v119, a135
    v_mfma_f32_16x16x32_bf16 a[240:243], v[92:95], a[80:83], a[240:243]
    v_add_f32 v61, v116, v117
    v_add_f32 v61, v61, v118
    v_mfma_f32_16x16x32_bf16 a[248:251], v[92:95], a[88:91], a[248:251]
    v_add_f32 v61, v61, v119
    v_mul_f32 v7, s38, v7
    v_mfma_f32_16x16x32_bf16 a[252:255], v[92:95], a[92:95], a[252:255]
L_pad6:
    s_cbranch_vccz L_padret1
    v_mfma_f32_16x16x32_bf16 a[220:223], v[88:91], a[92:95], a[220:223]
    global_load_lds_dwordx4 v132, s[22:23] offset:3072 nt
    v_mfma_f32_16x16x32_bf16 a[216:219], v[88:91], a[88:91], a[216:219]
    v_rcp_f32 v116, v116
    v_mfma_f32_16x16x32_bf16 a[184:187], v[84:87], a[88:91], a[184:187]
    v_rcp_f32 v117, v117
    v_mfma_f32_16x16x32_bf16 a[188:191], v[84:87], a[92:95], a[188:191]
    v_rcp_f32 v118, v118
    v_mfma_f32_16x16x32_bf16 v[236:239], v[80:83], a[92:95], v[236:239]
    v_rcp_f32 v119, v119
    v_mfma_f32_16x16x32_bf16 v[232:235], v[80:83], a[88:91], v[232:235]
    v_add_f32 v60, v60, v61
    v_cvt_pk_bf16_f32 v8, v0, v1
    v_mfma_f32_16x16x32_bf16 v[200:203], v[76:79], a[88:91], v[200:203]
    v_cvt_pk_bf16_f32 v9, v2, v3
    v_cvt_pk_bf16_f32 v10, v4, v5
    v_mfma_f32_16x16x32_bf16 v[204:207], v[76:79], a[92:95], v[204:207]
    v_cvt_pk_bf16_f32 v11, v6, v7
    v_accvgpr_write_b32 a32, v8
    v_mfma_f32_16x16x32_bf16 v[172:175], v[72:75], a[92:95], v[172:175]
    v_accvgpr_write_b32 a33, v9
    v_accvgpr_write_b32 a34, v10
    v_mfma_f32_16x16x32_bf16 v[168:171], v[72:75], a[88:91], v[168:171]
    s_waitcnt lgkmcnt(0)
    s_barrier
    v_accvgpr_write_b32 a35, v11
    v_mfma_f32_16x16x32_bf16 v[0:3], a[96:99], a[0:3], 0
    ds_read_b128 a[36:39], v137 offset:8192
    v_cmp_nlt_f32 s[40:41], v60, s37
    v_mfma_f32_16x16x32_bf16 v[0:3], a[100:103], a[4:7], v[0:3]
    ds_read_b128 a[40:43], v138 offset:8192
    v_mfma_f32_16x16x32_bf16 v[0:3], a[104:107], a[8:11], v[0:3]
    ds_read_b128 a[44:47], v139 offset:8192
    v_mfma_f32_16x16x32_bf16 v[0:3], a[108:111], a[12:15], v[0:3]
    v_mfma_f32_16x16x32_bf16 v[4:7], a[124:127], a[12:15], 0
    ds_read_b128 a[48:51], v136 offset:12288
    v_mfma_f32_16x16x32_bf16 v[4:7], a[120:123], a[8:11], v[4:7]
    ds_read_b128 a[52:55], v137 offset:12288
    v_mfma_f32_16x16x32_bf16 v[4:7], a[116:119], a[4:7], v[4:7]
    ds_read_b128 a[56:59], v138 offset:12288
    v_mfma_f32_16x16x32_bf16 v[4:7], a[112:115], a[0:3], v[4:7]
    ds_read_b128 a[60:63], v139 offset:12288
    s_cmp_lg_u64 s[40:41], 0
    s_cselect_b32 s33, 1, 0
    s_or_b32 s36, s36, s33
    v_mov_b64_dpp v[72:73], v[112:113] row_newbcast:0 row_mask:0xf bank_mask:0xf
    v_mov_b64_dpp v[74:75], v[114:115] row_newbcast:0 row_mask:0xf bank_mask:0xf
    v_pk_mul_f32 v[144:145], v[144:145], v[72:73]
    v_pk_mul_f32 v[146:147], v[146:147], v[74:75]
    v_pk_mul_f32 v[148:149], v[148:149], v[72:73]
    v_pk_mul_f32 v[150:151], v[150:151], v[74:75]
    v_pk_mul_f32 v[152:153], v[152:153], v[72:73]
    v_pk_mul_f32 v[154:155], v[154:155], v[74:75]
    v_pk_mul_f32 v[156:157], v[156:157], v[72:73]
    v_pk_mul_f32 v[158:159], v[158:159], v[74:75]
    v_cvt_pk_bf16_f32 v76, v144, v148
    v_cvt_pk_bf16_f32 v77, v152, v156
    v_cvt_pk_bf16_f32 v78, v145, v149
    v_cvt_pk_bf16_f32 v79, v153, v157
    v_cvt_pk_bf16_f32 v80, v146, v150
    v_cvt_pk_bf16_f32 v81, v154, v158
    v_cvt_pk_bf16_f32 v82, v147, v151
    v_cvt_pk_bf16_f32 v83, v155, v159
    ds_write2st64_b64 v140, v[76:77], v[78:79] offset0:0 offset1:1
    ds_write2st64_b64 v140, v[80:81], v[82:83] offset0:2 offset1:3
    global_load_lds_dwordx4 v132, s[16:17] offset:2048 nt
    v_pk_mul_f32 v[160:161], v[160:161], v[72:73]
    v_pk_mul_f32 v[162:163], v[162:163], v[74:75]
    v_pk_mul_f32 v[164:165], v[164:165], v[72:73]
    v_pk_mul_f32 v[166:167], v[166:167], v[74:75]
    v_pk_mul_f32 v[168:169], v[168:169], v[72:73]
    v_pk_mul_f32 v[170:171], v[170:171], v[74:75]
    v_pk_mul_f32 v[172:173], v[172:173], v[72:73]
    v_pk_mul_f32 v[174:175], v[174:175], v[74:75]
    v_cvt_pk_bf16_f32 v76, v160, v164
    v_cvt_pk_bf16_f32 v77, v168, v172
    v_cvt_pk_bf16_f32 v78, v161, v165
    v_cvt_pk_bf16_f32 v79, v169, v173
    v_cvt_pk_bf16_f32 v80, v162, v166
    v_cvt_pk_bf16_f32 v81, v170, v174
    v_cvt_pk_bf16_f32 v82, v163, v167
    v_cvt_pk_bf16_f32 v83, v171, v175
    ds_write2st64_b64 v140, v[76:77], v[78:79] offset0:4 offset1:5
    ds_write2st64_b64 v140, v[80:81], v[82:83] offset0:6 offset1:7
    v_add_u32 v132, 8192, v132
    s_add_u32 m0, s30, 16384
    s_nop 0
    global_load_lds_dwordx4 v132, s[22:23] offset:1024 nt
    s_waitcnt lgkmcnt(8)
    v_mfma_f32_16x16x32_bf16 v[8:11], a[96:99], a[16:19], 0
    v_max3_f32 v96, v0, v1, v2
    v_max3_f32 v97, v3, v4, v5
    v_mfma_f32_16x16x32_bf16 v[8:11], a[100:103], a[20:23], v[8:11]
    v_max3_f32 v96, v96, v6, v7
    v_max_f32 v96, v96, v97
    v_mfma_f32_16x16x32_bf16 v[8:11], a[104:107], a[24:27], v[8:11]
    v_mov_b32 v97, v96
    v_mfma_f32_16x16x32_bf16 v[8:11], a[108:111], a[28:31], v[8:11]
    s_nop 0
    v_permlane32_swap_b32 v96, v97
    v_mfma_f32_16x16x32_bf16 v[12:15], a[124:127], a[28:31], 0
    v_max_f32 v96, v96, v97
    v_mov_b32 v97, v96
    v_mfma_f32_16x16x32_bf16 v[12:15], a[120:123], a[24:27], v[12:15]
    s_nop 0
    v_permlane16_swap_b32 v96, v97
    v_mfma_f32_16x16x32_bf16 v[12:15], a[116:119], a[20:23], v[12:15]
    v_max_f32 v96, v96, v97
    v_sub_f32 v97, 0, v96
    v_mfma_f32_16x16x32_bf16 v[12:15], a[112:115], a[16:19], v[12:15]
    v_sub_f32 v98, 0, v96
    v_sub_f32 v99, 0, v96
    v_sub_f32 v96, 0, v96
    v_mov_b64_dpp v[72:73], v[112:113] row_newbcast:1 row_mask:0xf bank_mask:0xf
    v_mov_b64_dpp v[74:75], v[114:115] row_newbcast:1 row_mask:0xf bank_mask:0xf
    v_pk_mul_f32 v[176:177], v[176:177], v[72:73]
    v_pk_mul_f32 v[178:179], v[178:179], v[74:75]
    v_pk_mul_f32 v[180:181], v[180:181], v[72:73]
    v_pk_mul_f32 v[182:183], v[182:183], v[74:75]
    v_pk_mul_f32 v[184:185], v[184:185], v[72:73]
    v_pk_mul_f32 v[186:187], v[186:187], v[74:75]
    v_pk_mul_f32 v[188:189], v[188:189], v[72:73]
    v_pk_mul_f32 v[190:191], v[190:191], v[74:75]
    v_cvt_pk_bf16_f32 v76, v176, v180
    v_cvt_pk_bf16_f32 v77, v184, v188
    v_cvt_pk_bf16_f32 v78, v177, v181
    v_cvt_pk_bf16_f32 v79, v185, v189
    v_cvt_pk_bf16_f32 v80, v178, v182
    v_cvt_pk_bf16_f32 v81, v186, v190
    v_cvt_pk_bf16_f32 v82, v179, v183
    v_cvt_pk_bf16_f32 v83, v187, v191
    ds_write2st64_b64 v140, v[76:77], v[78:79] offset0:8 offset1:9
    ds_write2st64_b64 v140, v[80:81], v[82:83] offset0:10 offset1:11
    global_load_lds_dwordx4 v132, s[16:17] nt
    v_pk_add_f32 v[0:1], v[0:1], v[96:97]
    v_pk_add_f32 v[2:3], v[2:3], v[96:97]
    v_pk_add_f32 v[4:5], v[4:5], v[96:97]
    v_pk_add_f32 v[6:7], v[6:7], v[96:97]
    v_exp_f32 v0, v0
    v_exp_f32 v1, v1
    v_exp_f32 v2, v2
    v_cvt_pk_bf16_f32 v48, v0, v1
    v_exp_f32 v3, v3
    v_exp_f32 v4, v4
    v_cvt_pk_bf16_f32 v49, v2, v3
    v_exp_f32 v5, v5
    v_exp_f32 v6, v6
    v_cvt_pk_bf16_f32 v50, v4, v5
    v_exp_f32 v7, v7
    s_nop 0
    v_cvt_pk_bf16_f32 v51, v6, v7
    v_pk_mul_f32 v[192:193], v[192:193], v[72:73]
    v_pk_mul_f32 v[194:195], v[194:195], v[74:75]
    v_pk_mul_f32 v[196:197], v[196:197], v[72:73]
    v_pk_mul_f32 v[198:199], v[198:199], v[74:75]
    v_pk_mul_f32 v[200:201], v[200:201], v[72:73]
    v_pk_mul_f32 v[202:203], v[202:203], v[74:75]
    v_pk_mul_f32 v[204:205], v[204:205], v[72:73]
    v_pk_mul_f32 v[206:207], v[206:207], v[74:75]
    v_cvt_pk_bf16_f32 v76, v192, v196
    v_cvt_pk_bf16_f32 v77, v200, v204
    v_cvt_pk_bf16_f32 v78, v193, v197
    v_cvt_pk_bf16_f32 v79, v201, v205
    v_cvt_pk_bf16_f32 v80, v194, v198
    v_cvt_pk_bf16_f32 v81, v202, v206
    v_cvt_pk_bf16_f32 v82, v195, v199
    v_cvt_pk_bf16_f32 v83, v203, v207
    ds_write2st64_b64 v140, v[76:77], v[78:79] offset0:12 offset1:13
    ds_write2st64_b64 v140, v[80:81], v[82:83] offset0:14 offset1:15
    global_load_lds_dwordx4 v132, s[22:23] offset:3072 nt
    global_load_lds_dwordx4 v132, s[16:17] offset:2048 nt
    s_waitcnt vmcnt(12)
    s_waitcnt lgkmcnt(8)
    v_mfma_f32_16x16x32_bf16 v[84:87], a[166:169], a[36:39], 0
    ds_read_b128 a[64:67], v136 offset:16384
    v_max3_f32 v100, v8, v9, v10
    v_mfma_f32_16x16x32_bf16 v[84:87], a[170:173], a[36:39], v[84:87]
    ds_read_b128 a[68:71], v137 offset:16384
    v_max3_f32 v101, v11, v12, v13
    v_mfma_f32_16x16x32_bf16 v[88:91], a[164:167], a[36:39], 0
    ds_read_b128 a[72:75], v138 offset:16384
    v_max3_f32 v100, v100, v14, v15
    v_mfma_f32_16x16x32_bf16 v[88:91], a[168:171], a[36:39], v[88:91]
    ds_read_b128 a[76:79], v139 offset:16384
    v_max_f32 v100, v100, v101
    v_mfma_f32_16x16x32_bf16 v[76:79], a[166:169], a[40:43], 0
    v_cvt_pk_bf16_f32 v92, v84, v85
    v_cvt_pk_bf16_f32 v93, v86, v87
    v_mfma_f32_16x16x32_bf16 v[76:79], a[170:173], a[40:43], v[76:79]
    v_accvgpr_write_b32 a36, v92
    v_accvgpr_write_b32 a37, v93
    v_mfma_f32_16x16x32_bf16 v[80:83], a[164:167], a[40:43], 0
    v_cvt_pk_bf16_f32 v94, v88, v89
    v_cvt_pk_bf16_f32 v95, v90, v91
    v_mfma_f32_16x16x32_bf16 v[80:83], a[168:171], a[40:43], v[80:83]
    v_accvgpr_write_b32 a38, v94
    v_accvgpr_write_b32 a39, v95
    v_mfma_f32_16x16x32_bf16 v[84:87], a[166:169], a[44:47], 0
    v_cvt_pk_bf16_f32 v92, v76, v77
    v_cvt_pk_bf16_f32 v93, v78, v79
    v_mfma_f32_16x16x32_bf16 v[84:87], a[170:173], a[44:47], v[84:87]
    v_accvgpr_write_b32 a40, v92
    v_accvgpr_write_b32 a41, v93
    v_mfma_f32_16x16x32_bf16 v[88:91], a[164:167], a[44:47], 0
    v_cvt_pk_bf16_f32 v94, v80, v81
    v_cvt_pk_bf16_f32 v95, v82, v83
    v_mfma_f32_16x16x32_bf16 v[88:91], a[168:171], a[44:47], v[88:91]
    v_accvgpr_write_b32 a42, v94
    v_accvgpr_write_b32 a43, v95
    v_mfma_f32_16x16x32_bf16 v[76:79], a[166:169], a[48:51], 0
    v_cvt_pk_bf16_f32 v92, v84, v85
    v_cvt_pk_bf16_f32 v93, v86, v87
    v_mfma_f32_16x16x32_bf16 v[76:79], a[170:173], a[48:51], v[76:79]
    v_accvgpr_write_b32 a44, v92
    v_accvgpr_write_b32 a45, v93
    v_mfma_f32_16x16x32_bf16 v[80:83], a[164:167], a[48:51], 0
    v_cvt_pk_bf16_f32 v94, v88, v89
    v_cvt_pk_bf16_f32 v95, v90, v91
    v_mfma_f32_16x16x32_bf16 v[80:83], a[168:171], a[48:51], v[80:83]
    v_accvgpr_write_b32 a46, v94
    v_accvgpr_write_b32 a47, v95
    v_mfma_f32_16x16x32_bf16 v[16:19], a[96:99], a[32:35], 0
    v_cvt_pk_bf16_f32 v92, v76, v77
    v_cvt_pk_bf16_f32 v93, v78, v79
    v_mfma_f32_16x16x32_bf16 v[16:19], a[100:103], a[36:39], v[16:19]
    v_accvgpr_write_b32 a48, v92
    v_accvgpr_write_b32 a49, v93
    v_mfma_f32_16x16x32_bf16 v[16:19], a[104:107], a[40:43], v[16:19]
    v_cvt_pk_bf16_f32 v94, v80, v81
    v_cvt_pk_bf16_f32 v95, v82, v83
    v_mfma_f32_16x16x32_bf16 v[16:19], a[108:111], a[44:47], v[16:19]
    v_accvgpr_write_b32 a50, v94
    v_accvgpr_write_b32 a51, v95
    v_mfma_f32_16x16x32_bf16 v[20:23], a[124:127], a[44:47], 0
    v_mov_b32 v101, v100
    v_mfma_f32_16x16x32_bf16 v[20:23], a[120:123], a[40:43], v[20:23]
    s_nop 0
    v_permlane32_swap_b32 v100, v101
    v_mfma_f32_16x16x32_bf16 v[20:23], a[116:119], a[36:39], v[20:23]
    v_max_f32 v100, v100, v101
    v_mov_b32 v101, v100
    v_mfma_f32_16x16x32_bf16 v[20:23], a[112:115], a[32:35], v[20:23]
    s_nop 0
    v_permlane16_swap_b32 v100, v101
    v_max_f32 v100, v100, v101
    v_sub_f32 v101, 0, v100
    v_sub_f32 v102, 0, v100
    v_sub_f32 v103, 0, v100
    v_sub_f32 v100, 0, v100
    v_mov_b64_dpp v[72:73], v[112:113] row_newbcast:2 row_mask:0xf bank_mask:0xf
    v_mov_b64_dpp v[74:75], v[114:115] row_newbcast:2 row_mask:0xf bank_mask:0xf
    v_pk_mul_f32 v[208:209], v[208:209], v[72:73]
    v_pk_mul_f32 v[210:211], v[210:211], v[74:75]
    v_pk_mul_f32 v[212:213], v[212:213], v[72:73]
    v_pk_mul_f32 v[214:215], v[214:215], v[74:75]
    v_pk_mul_f32 v[216:217], v[216:217], v[72:73]
    v_pk_mul_f32 v[218:219], v[218:219], v[74:75]
    v_pk_mul_f32 v[220:221], v[220:221], v[72:73]
    v_pk_mul_f32 v[222:223], v[222:223], v[74:75]
    v_cvt_pk_bf16_f32 v76, v208, v212
    v_cvt_pk_bf16_f32 v77, v216, v220
    v_cvt_pk_bf16_f32 v78, v209, v213
    v_cvt_pk_bf16_f32 v79, v217, v221
    v_cvt_pk_bf16_f32 v80, v210, v214
    v_cvt_pk_bf16_f32 v81, v218, v222
    v_cvt_pk_bf16_f32 v82, v211, v215
    v_cvt_pk_bf16_f32 v83, v219, v223
    ds_write2st64_b64 v140, v[76:77], v[78:79] offset0:16 offset1:17
    ds_write2st64_b64 v140, v[80:81], v[82:83] offset0:18 offset1:19
    v_add_u32 v132, 8192, v132
    s_add_u32 m0, s30, 32768
    s_nop 0
    global_load_lds_dwordx4 v132, s[22:23] offset:1024 nt
    global_load_lds_dwordx4 v132, s[16:17] nt
    v_pk_add_f32 v[8:9], v[8:9], v[100:101]
    v_pk_add_f32 v[10:11], v[10:11], v[100:101]
    v_pk_add_f32 v[12:13], v[12:13], v[100:101]
    v_pk_add_f32 v[14:15], v[14:15], v[100:101]
    v_exp_f32 v8, v8
    v_exp_f32 v9, v9
    v_exp_f32 v10, v10
    v_cvt_pk_bf16_f32 v52, v8, v9
    v_exp_f32 v11, v11
    v_exp_f32 v12, v12
    v_cvt_pk_bf16_f32 v53, v10, v11
    v_exp_f32 v13, v13
    v_exp_f32 v14, v14
    v_cvt_pk_bf16_f32 v54, v12, v13
    v_exp_f32 v15, v15
    s_nop 0
    v_cvt_pk_bf16_f32 v55, v14, v15
    v_pk_mul_f32 v[224:225], v[224:225], v[72:73]
    v_pk_mul_f32 v[226:227], v[226:227], v[74:75]
    v_pk_mul_f32 v[228:229], v[228:229], v[72:73]
    v_pk_mul_f32 v[230:231], v[230:231], v[74:75]
    v_pk_mul_f32 v[232:233], v[232:233], v[72:73]
    v_pk_mul_f32 v[234:235], v[234:235], v[74:75]
    v_pk_mul_f32 v[236:237], v[236:237], v[72:73]
    v_pk_mul_f32 v[238:239], v[238:239], v[74:75]
    v_cvt_pk_bf16_f32 v76, v224, v228
    v_cvt_pk_bf16_f32 v77, v232, v236
    v_cvt_pk_bf16_f32 v78, v225, v229
    v_cvt_pk_bf16_f32 v79, v233, v237
    v_cvt_pk_bf16_f32 v80, v226, v230
    v_cvt_pk_bf16_f32 v81, v234, v238
    v_cvt_pk_bf16_f32 v82, v227, v231
    v_cvt_pk_bf16_f32 v83, v235, v239
    ds_write2st64_b64 v140, v[76:77], v[78:79] offset0:20 offset1:21
    ds_write2st64_b64 v140, v[80:81], v[82:83] offset0:22 offset1:23
    global_load_lds_dwordx4 v132, s[22:23] offset:3072 nt
    global_load_lds_dwordx4 v132, s[16:17] offset:2048 nt
    v_add_u32 v132, 8192, v132
    s_waitcnt vmcnt(12)
    s_waitcnt lgkmcnt(4)
    v_mfma_f32_16x16x32_bf16 v[84:87], a[166:169], a[52:55], 0
    ds_read_b128 a[80:83], v136 offset:20480
    v_max3_f32 v104, v16, v17, v18
    v_mfma_f32_16x16x32_bf16 v[84:87], a[170:173], a[52:55], v[84:87]
    ds_read_b128 a[84:87], v137 offset:20480
    v_max3_f32 v105, v19, v20, v21
    v_mfma_f32_16x16x32_bf16 v[88:91], a[164:167], a[52:55], 0
    ds_read_b128 a[88:91], v138 offset:20480
    v_max3_f32 v104, v104, v22, v23
    v_mfma_f32_16x16x32_bf16 v[88:91], a[168:171], a[52:55], v[88:91]
    ds_read_b128 a[92:95], v139 offset:20480
    v_max_f32 v104, v104, v105
    v_mfma_f32_16x16x32_bf16 v[76:79], a[166:169], a[56:59], 0
    ds_read_b64_tr_b16 a[148:149], v141
    v_cvt_pk_bf16_f32 v92, v84, v85
    v_cvt_pk_bf16_f32 v93, v86, v87
    v_mfma_f32_16x16x32_bf16 v[76:79], a[170:173], a[56:59], v[76:79]
    ds_read_b64_tr_b16 a[150:151], v141 offset:32
    v_accvgpr_write_b32 a52, v92
    v_accvgpr_write_b32 a53, v93
    v_mfma_f32_16x16x32_bf16 v[80:83], a[164:167], a[56:59], 0
    ds_read_b64_tr_b16 a[152:153], v141 offset:128
    v_cvt_pk_bf16_f32 v94, v88, v89
    v_cvt_pk_bf16_f32 v95, v90, v91
    v_mfma_f32_16x16x32_bf16 v[80:83], a[168:171], a[56:59], v[80:83]
    ds_read_b64_tr_b16 a[154:155], v141 offset:160
    v_accvgpr_write_b32 a54, v94
    v_accvgpr_write_b32 a55, v95
    v_mfma_f32_16x16x32_bf16 v[84:87], a[166:169], a[60:63], 0
    v_cvt_pk_bf16_f32 v92, v76, v77
    v_cvt_pk_bf16_f32 v93, v78, v79
    v_mfma_f32_16x16x32_bf16 v[84:87], a[170:173], a[60:63], v[84:87]
    v_accvgpr_write_b32 a56, v92
    v_accvgpr_write_b32 a57, v93
    v_mfma_f32_16x16x32_bf16 v[88:91], a[164:167], a[60:63], 0
    v_cvt_pk_bf16_f32 v94, v80, v81
    v_cvt_pk_bf16_f32 v95, v82, v83
    v_mfma_f32_16x16x32_bf16 v[88:91], a[168:171], a[60:63], v[88:91]
    v_accvgpr_write_b32 a58, v94
    v_accvgpr_write_b32 a59, v95
    v_mfma_f32_16x16x32_bf16 v[76:79], a[166:169], a[64:67], 0
    v_cvt_pk_bf16_f32 v92, v84, v85
    v_cvt_pk_bf16_f32 v93, v86, v87
    v_mfma_f32_16x16x32_bf16 v[76:79], a[170:173], a[64:67], v[76:79]
    v_accvgpr_write_b32 a60, v92
    v_accvgpr_write_b32 a61, v93
    v_mfma_f32_16x16x32_bf16 v[80:83], a[164:167], a[64:67], 0
    v_cvt_pk_bf16_f32 v94, v88, v89
    v_cvt_pk_bf16_f32 v95, v90, v91
    v_mfma_f32_16x16x32_bf16 v[80:83], a[168:171], a[64:67], v[80:83]
    v_accvgpr_write_b32 a62, v94
    v_accvgpr_write_b32 a63, v95
    v_mfma_f32_16x16x32_bf16 v[24:27], a[96:99], a[48:51], 0
    v_cvt_pk_bf16_f32 v92, v76, v77
    v_cvt_pk_bf16_f32 v93, v78, v79
    v_mfma_f32_16x16x32_bf16 v[24:27], a[100:103], a[52:55], v[24:27]
    v_accvgpr_write_b32 a64, v92
    v_accvgpr_write_b32 a65, v93
    v_mfma_f32_16x16x32_bf16 v[24:27], a[104:107], a[56:59], v[24:27]
    v_cvt_pk_bf16_f32 v94, v80, v81
    v_cvt_pk_bf16_f32 v95, v82, v83
    v_mfma_f32_16x16x32_bf16 v[24:27], a[108:111], a[60:63], v[24:27]
    v_accvgpr_write_b32 a66, v94
    v_accvgpr_write_b32 a67, v95
    v_mfma_f32_16x16x32_bf16 v[28:31], a[124:127], a[60:63], 0
    v_mov_b32 v105, v104
    v_accvgpr_read_b32 v192, a176
    v_mfma_f32_16x16x32_bf16 v[28:31], a[120:123], a[56:59], v[28:31]
    v_permlane32_swap_b32 v104, v105
    v_mfma_f32_16x16x32_bf16 v[28:31], a[116:119], a[52:55], v[28:31]
    v_max_f32 v104, v104, v105
    v_mov_b32 v105, v104
    v_mfma_f32_16x16x32_bf16 v[28:31], a[112:115], a[48:51], v[28:31]
    s_nop 0
    v_permlane16_swap_b32 v104, v105
    v_max_f32 v104, v104, v105
    v_sub_f32 v105, 0, v104
    v_sub_f32 v106, 0, v104
    v_sub_f32 v107, 0, v104
    v_sub_f32 v104, 0, v104
    v_mov_b64_dpp v[72:73], v[116:117] row_newbcast:0 row_mask:0xf bank_mask:0xf
    v_mov_b64_dpp v[74:75], v[118:119] row_newbcast:0 row_mask:0xf bank_mask:0xf
    v_pk_mul_f32 v[240:241], v[240:241], v[72:73]
    v_pk_mul_f32 v[242:243], v[242:243], v[74:75]
    v_pk_mul_f32 v[244:245], v[244:245], v[72:73]
    v_pk_mul_f32 v[246:247], v[246:247], v[74:75]
    v_pk_mul_f32 v[248:249], v[248:249], v[72:73]
    v_pk_mul_f32 v[250:251], v[250:251], v[74:75]
    v_pk_mul_f32 v[252:253], v[252:253], v[72:73]
    v_pk_mul_f32 v[254:255], v[254:255], v[74:75]
    v_cvt_pk_bf16_f32 v76, v240, v244
    v_cvt_pk_bf16_f32 v77, v248, v252
    v_cvt_pk_bf16_f32 v78, v241, v245
    v_cvt_pk_bf16_f32 v79, v249, v253
    v_cvt_pk_bf16_f32 v80, v242, v246
    v_cvt_pk_bf16_f32 v81, v250, v254
    v_cvt_pk_bf16_f32 v82, v243, v247
    v_cvt_pk_bf16_f32 v83, v251, v255
    ds_write2st64_b64 v140, v[76:77], v[78:79] offset0:24 offset1:25
    ds_write2st64_b64 v140, v[80:81], v[82:83] offset0:26 offset1:27
    s_mov_b32 s34, 0
    s_waitcnt lgkmcnt(2)
    buffer_store_dwordx4 a[148:151], v135, s[24:27], s34 offen sc1
    buffer_store_dwordx4 a[152:155], v135, s[24:27], s34 offen offset:1024 sc1
    v_pk_add_f32 v[16:17], v[16:17], v[104:105]
    v_pk_add_f32 v[18:19], v[18:19], v[104:105]
    v_pk_add_f32 v[20:21], v[20:21], v[104:105]
    v_pk_add_f32 v[22:23], v[22:23], v[104:105]
    v_exp_f32 v16, v16
    v_exp_f32 v17, v17
    v_exp_f32 v18, v18
    v_cvt_pk_bf16_f32 v56, v16, v17
    ds_read_b64_tr_b16 a[156:157], v141 offset:256
    ds_read_b64_tr_b16 a[158:159], v141 offset:288
    ds_read_b64_tr_b16 a[160:161], v141 offset:384
    ds_read_b64_tr_b16 a[162:163], v141 offset:416
    v_exp_f32 v19, v19
    v_exp_f32 v20, v20
    v_cvt_pk_bf16_f32 v57, v18, v19
    v_exp_f32 v21, v21
    v_exp_f32 v22, v22
    v_cvt_pk_bf16_f32 v58, v20, v21
    v_exp_f32 v23, v23
    s_nop 0
    v_cvt_pk_bf16_f32 v59, v22, v23
    v_accvgpr_read_b32 v193, a177
    v_accvgpr_read_b32 v194, a178
    v_accvgpr_read_b32 v195, a179
    v_accvgpr_read_b32 v196, a180
    v_accvgpr_read_b32 v197, a181
    v_accvgpr_read_b32 v198, a182
    v_accvgpr_read_b32 v199, a183
    v_accvgpr_read_b32 v200, a184
    v_accvgpr_read_b32 v201, a185
    v_accvgpr_read_b32 v202, a186
    v_accvgpr_read_b32 v203, a187
    v_accvgpr_read_b32 v204, a188
    v_accvgpr_read_b32 v205, a189
    v_accvgpr_read_b32 v206, a190
    v_accvgpr_read_b32 v207, a191
    v_pk_mul_f32 v[192:193], v[192:193], v[72:73]
    v_pk_mul_f32 v[194:195], v[194:195], v[74:75]
    v_pk_mul_f32 v[196:197], v[196:197], v[72:73]
    v_pk_mul_f32 v[198:199], v[198:199], v[74:75]
    v_pk_mul_f32 v[200:201], v[200:201], v[72:73]
    v_pk_mul_f32 v[202:203], v[202:203], v[74:75]
    v_pk_mul_f32 v[204:205], v[204:205], v[72:73]
    v_pk_mul_f32 v[206:207], v[206:207], v[74:75]
    v_cvt_pk_bf16_f32 v76, v192, v196
    v_cvt_pk_bf16_f32 v77, v200, v204
    v_cvt_pk_bf16_f32 v78, v193, v197
    v_cvt_pk_bf16_f32 v79, v201, v205
    v_cvt_pk_bf16_f32 v80, v194, v198
    v_cvt_pk_bf16_f32 v81, v202, v206
    v_cvt_pk_bf16_f32 v82, v195, v199
    v_cvt_pk_bf16_f32 v83, v203, v207
    ds_write2st64_b64 v140, v[76:77], v[78:79] offset0:28 offset1:29
    ds_write2st64_b64 v140, v[80:81], v[82:83] offset0:30 offset1:31
    s_mov_b32 s34, 2048
    s_waitcnt lgkmcnt(2)
    buffer_store_dwordx4 a[156:159], v135, s[24:27], s34 offen sc1
    buffer_store_dwordx4 a[160:163], v135, s[24:27], s34 offen offset:1024 sc1
    v_mfma_f32_16x16x32_bf16 v[84:87], a[166:169], a[68:71], 0
    v_max3_f32 v108, v24, v25, v26
    v_max3_f32 v109, v27, v28, v29
    v_mfma_f32_16x16x32_bf16 v[84:87], a[170:173], a[68:71], v[84:87]
    v_max3_f32 v108, v108, v30, v31
    v_max_f32 v108, v108, v109
    v_mfma_f32_16x16x32_bf16 v[88:91], a[164:167], a[68:71], 0
    v_mov_b32 v109, v108
    v_accvgpr_read_b32 v176, a192
    v_mfma_f32_16x16x32_bf16 v[88:91], a[168:171], a[68:71], v[88:91]
    v_permlane32_swap_b32 v108, v109
    v_mfma_f32_16x16x32_bf16 v[76:79], a[166:169], a[72:75], 0
    v_cvt_pk_bf16_f32 v92, v84, v85
    v_cvt_pk_bf16_f32 v93, v86, v87
    v_mfma_f32_16x16x32_bf16 v[76:79], a[170:173], a[72:75], v[76:79]
    v_accvgpr_write_b32 a68, v92
    v_accvgpr_write_b32 a69, v93
    v_mfma_f32_16x16x32_bf16 v[80:83], a[164:167], a[72:75], 0
    v_cvt_pk_bf16_f32 v94, v88, v89
    v_cvt_pk_bf16_f32 v95, v90, v91
    v_mfma_f32_16x16x32_bf16 v[80:83], a[168:171], a[72:75], v[80:83]
    v_accvgpr_write_b32 a70, v94
    v_accvgpr_write_b32 a71, v95
    v_mfma_f32_16x16x32_bf16 v[84:87], a[166:169], a[76:79], 0
    v_cvt_pk_bf16_f32 v92, v76, v77
    v_cvt_pk_bf16_f32 v93, v78, v79
    v_mfma_f32_16x16x32_bf16 v[84:87], a[170:173], a[76:79], v[84:87]
    v_accvgpr_write_b32 a72, v92
    v_accvgpr_write_b32 a73, v93
    v_mfma_f32_16x16x32_bf16 v[88:91], a[164:167], a[76:79], 0
    v_cvt_pk_bf16_f32 v94, v80, v81
    v_cvt_pk_bf16_f32 v95, v82, v83
    v_mfma_f32_16x16x32_bf16 v[88:91], a[168:171], a[76:79], v[88:91]
    v_accvgpr_write_b32 a74, v94
    v_accvgpr_write_b32 a75, v95
    v_mfma_f32_16x16x32_bf16 v[76:79], a[166:169], a[80:83], 0
    v_cvt_pk_bf16_f32 v92, v84, v85
    v_cvt_pk_bf16_f32 v93, v86, v87
    v_mfma_f32_16x16x32_bf16 v[76:79], a[170:173], a[80:83], v[76:79]
    v_accvgpr_write_b32 a76, v92
    v_accvgpr_write_b32 a77, v93
    v_mfma_f32_16x16x32_bf16 v[80:83], a[164:167], a[80:83], 0
    v_cvt_pk_bf16_f32 v94, v88, v89
    v_cvt_pk_bf16_f32 v95, v90, v91
    v_mfma_f32_16x16x32_bf16 v[80:83], a[168:171], a[80:83], v[80:83]
    v_accvgpr_write_b32 a78, v94
    v_accvgpr_write_b32 a79, v95
    v_mfma_f32_16x16x32_bf16 v[32:35], a[96:99], a[64:67], 0
    v_cvt_pk_bf16_f32 v92, v76, v77
    v_cvt_pk_bf16_f32 v93, v78, v79
    v_mfma_f32_16x16x32_bf16 v[32:35], a[100:103], a[68:71], v[32:35]
    v_accvgpr_write_b32 a80, v92
    v_accvgpr_write_b32 a81, v93
    v_mfma_f32_16x16x32_bf16 v[32:35], a[104:107], a[72:75], v[32:35]
    v_cvt_pk_bf16_f32 v94, v80, v81
    v_cvt_pk_bf16_f32 v95, v82, v83
    v_mfma_f32_16x16x32_bf16 v[32:35], a[108:111], a[76:79], v[32:35]
    v_accvgpr_write_b32 a82, v94
    v_accvgpr_write_b32 a83, v95
    v_mfma_f32_16x16x32_bf16 v[36:39], a[124:127], a[76:79], 0
    v_max_f32 v108, v108, v109
    v_mov_b32 v109, v108
    v_mfma_f32_16x16x32_bf16 v[36:39], a[120:123], a[72:75], v[36:39]
    s_nop 0
    v_permlane16_swap_b32 v108, v109
    v_mfma_f32_16x16x32_bf16 v[36:39], a[116:119], a[68:71], v[36:39]
    v_max_f32 v108, v108, v109
    v_sub_f32 v109, 0, v108
    v_mfma_f32_16x16x32_bf16 v[36:39], a[112:115], a[64:67], v[36:39]
    v_sub_f32 v110, 0, v108
    v_sub_f32 v111, 0, v108
    v_sub_f32 v108, 0, v108
    v_mov_b64_dpp v[72:73], v[116:117] row_newbcast:1 row_mask:0xf bank_mask:0xf
    v_mov_b64_dpp v[74:75], v[118:119] row_newbcast:1 row_mask:0xf bank_mask:0xf
    v_accvgpr_read_b32 v177, a193
    v_accvgpr_read_b32 v178, a194
    v_accvgpr_read_b32 v179, a195
    v_accvgpr_read_b32 v180, a196
    v_accvgpr_read_b32 v181, a197
    v_accvgpr_read_b32 v182, a198
    v_accvgpr_read_b32 v183, a199
    v_accvgpr_read_b32 v184, a200
L_pad7:
    s_cbranch_vccz L_padret1
    v_accvgpr_read_b32 v185, a201
    v_accvgpr_read_b32 v186, a202
    v_accvgpr_read_b32 v187, a203
    v_accvgpr_read_b32 v188, a204
    v_accvgpr_read_b32 v189, a205
    v_accvgpr_read_b32 v190, a206
    v_accvgpr_read_b32 v191, a207
    v_pk_mul_f32 v[176:177], v[176:177], v[72:73]
    v_pk_mul_f32 v[178:179], v[178:179], v[74:75]
    v_pk_mul_f32 v[180:181], v[180:181], v[72:73]
    v_pk_mul_f32 v[182:183], v[182:183], v[74:75]
    v_pk_mul_f32 v[184:185], v[184:185], v[72:73]
    v_pk_mul_f32 v[186:187], v[186:187], v[74:75]
    v_pk_mul_f32 v[188:189], v[188:189], v[72:73]
    v_pk_mul_f32 v[190:191], v[190:191], v[74:75]
    v_cvt_pk_bf16_f32 v76, v176, v180
    v_cvt_pk_bf16_f32 v77, v184, v188
    v_cvt_pk_bf16_f32 v78, v177, v181
    v_cvt_pk_bf16_f32 v79, v185, v189
    v_cvt_pk_bf16_f32 v80, v178, v182
    v_cvt_pk_bf16_f32 v81, v186, v190
    v_cvt_pk_bf16_f32 v82, v179, v183
    v_cvt_pk_bf16_f32 v83, v187, v191
    ds_write2st64_b64 v140, v[76:77], v[78:79] offset0:32 offset1:33
    ds_write2st64_b64 v140, v[80:81], v[82:83] offset0:34 offset1:35
    v_pk_add_f32 v[24:25], v[24:25], v[108:109]
    v_pk_add_f32 v[26:27], v[26:27], v[108:109]
    v_pk_add_f32 v[28:29], v[28:29], v[108:109]
    v_pk_add_f32 v[30:31], v[30:31], v[108:109]
    v_exp_f32 v24, v24
    v_exp_f32 v25, v25
    v_exp_f32 v26, v26
    v_cvt_pk_bf16_f32 v60, v24, v25
    v_exp_f32 v27, v27
    s_nop 0
    v_cvt_pk_bf16_f32 v61, v26, v27
    v_accvgpr_read_b32 v192, a208
    v_accvgpr_read_b32 v193, a209
    v_accvgpr_read_b32 v194, a210
    v_accvgpr_read_b32 v195, a211
    v_accvgpr_read_b32 v196, a212
    v_accvgpr_read_b32 v197, a213
    v_accvgpr_read_b32 v198, a214
    v_accvgpr_read_b32 v199, a215
    v_accvgpr_read_b32 v200, a216
    v_accvgpr_read_b32 v201, a217
    v_accvgpr_read_b32 v202, a218
    v_accvgpr_read_b32 v203, a219
    v_accvgpr_read_b32 v204, a220
    v_accvgpr_read_b32 v205, a221
    v_accvgpr_read_b32 v206, a222
    v_accvgpr_read_b32 v207, a223
    v_pk_mul_f32 v[192:193], v[192:193], v[72:73]
    v_pk_mul_f32 v[194:195], v[194:195], v[74:75]
    v_pk_mul_f32 v[196:197], v[196:197], v[72:73]
    v_pk_mul_f32 v[198:199], v[198:199], v[74:75]
    v_pk_mul_f32 v[200:201], v[200:201], v[72:73]
    v_pk_mul_f32 v[202:203], v[202:203], v[74:75]
    v_pk_mul_f32 v[204:205], v[204:205], v[72:73]
    v_pk_mul_f32 v[206:207], v[206:207], v[74:75]
    v_cvt_pk_bf16_f32 v76, v192, v196
    v_cvt_pk_bf16_f32 v77, v200, v204
    v_cvt_pk_bf16_f32 v78, v193, v197
    v_cvt_pk_bf16_f32 v79, v201, v205
    v_cvt_pk_bf16_f32 v80, v194, v198
    v_cvt_pk_bf16_f32 v81, v202, v206
    v_cvt_pk_bf16_f32 v82, v195, v199
    v_cvt_pk_bf16_f32 v83, v203, v207
    ds_write2st64_b64 v140, v[76:77], v[78:79] offset0:36 offset1:37
    ds_write2st64_b64 v140, v[80:81], v[82:83] offset0:38 offset1:39
    v_mfma_f32_16x16x32_bf16 v[84:87], a[166:169], a[84:87], 0
    v_max3_f32 v112, v32, v33, v34
    v_max3_f32 v113, v35, v36, v37
    v_mfma_f32_16x16x32_bf16 v[84:87], a[170:173], a[84:87], v[84:87]
    v_max3_f32 v112, v112, v38, v39
    v_max_f32 v112, v112, v113
    v_mfma_f32_16x16x32_bf16 v[88:91], a[164:167], a[84:87], 0
    v_mov_b32 v113, v112
    v_accvgpr_read_b32 v176, a224
    v_mfma_f32_16x16x32_bf16 v[88:91], a[168:171], a[84:87], v[88:91]
    v_permlane32_swap_b32 v112, v113
    v_mfma_f32_16x16x32_bf16 v[76:79], a[166:169], a[88:91], 0
    v_cvt_pk_bf16_f32 v92, v84, v85
    v_cvt_pk_bf16_f32 v93, v86, v87
    v_mfma_f32_16x16x32_bf16 v[76:79], a[170:173], a[88:91], v[76:79]
    v_accvgpr_write_b32 a84, v92
    v_accvgpr_write_b32 a85, v93
    v_mfma_f32_16x16x32_bf16 v[80:83], a[164:167], a[88:91], 0
    v_cvt_pk_bf16_f32 v94, v88, v89
    v_cvt_pk_bf16_f32 v95, v90, v91
    v_mfma_f32_16x16x32_bf16 v[80:83], a[168:171], a[88:91], v[80:83]
    v_accvgpr_write_b32 a86, v94
    v_accvgpr_write_b32 a87, v95
    v_mfma_f32_16x16x32_bf16 v[84:87], a[166:169], a[92:95], 0
    v_cvt_pk_bf16_f32 v92, v76, v77
    v_cvt_pk_bf16_f32 v93, v78, v79
    v_mfma_f32_16x16x32_bf16 v[84:87], a[170:173], a[92:95], v[84:87]
    v_accvgpr_write_b32 a88, v92
    v_accvgpr_write_b32 a89, v93
    v_mfma_f32_16x16x32_bf16 v[88:91], a[164:167], a[92:95], 0
    v_cvt_pk_bf16_f32 v94, v80, v81
    v_cvt_pk_bf16_f32 v95, v82, v83
    v_mfma_f32_16x16x32_bf16 v[88:91], a[168:171], a[92:95], v[88:91]
    v_accvgpr_write_b32 a90, v94
    v_accvgpr_write_b32 a91, v95
    v_mfma_f32_16x16x32_bf16 v[40:43], a[96:99], a[80:83], 0
    v_cvt_pk_bf16_f32 v92, v84, v85
    v_cvt_pk_bf16_f32 v93, v86, v87
    v_mfma_f32_16x16x32_bf16 v[40:43], a[100:103], a[84:87], v[40:43]
    v_accvgpr_write_b32 a92, v92
    v_accvgpr_write_b32 a93, v93
    v_mfma_f32_16x16x32_bf16 v[40:43], a[104:107], a[88:91], v[40:43]
    v_cvt_pk_bf16_f32 v94, v88, v89
    v_cvt_pk_bf16_f32 v95, v90, v91
    v_mfma_f32_16x16x32_bf16 v[44:47], a[112:115], a[80:83], 0
    v_accvgpr_write_b32 a94, v94
    v_accvgpr_write_b32 a95, v95
    v_mfma_f32_16x16x32_bf16 v[44:47], a[116:119], a[84:87], v[44:47]
    v_max_f32 v112, v112, v113
    v_mov_b32 v113, v112
    v_mfma_f32_16x16x32_bf16 v[44:47], a[120:123], a[88:91], v[44:47]
    s_nop 0
    v_permlane16_swap_b32 v112, v113
    v_mfma_f32_16x16x32_bf16 v[40:43], a[108:111], a[92:95], v[40:43]
    v_max_f32 v112, v112, v113
    v_sub_f32 v113, 0, v112
    v_mfma_f32_16x16x32_bf16 v[44:47], a[124:127], a[92:95], v[44:47]
    v_sub_f32 v114, 0, v112
    v_sub_f32 v115, 0, v112
    v_sub_f32 v112, 0, v112
    ds_read_b128 a[96:99], v120 offset:49152
    ds_read_b128 a[100:103], v121 offset:49152
    ds_read_b128 a[104:107], v122 offset:49152
    ds_read_b128 a[108:111], v123 offset:49152
    v_mov_b64_dpp v[72:73], v[116:117] row_newbcast:2 row_mask:0xf bank_mask:0xf
    v_mov_b64_dpp v[74:75], v[118:119] row_newbcast:2 row_mask:0xf bank_mask:0xf
    v_accvgpr_read_b32 v177, a225
    v_accvgpr_read_b32 v178, a226
    v_accvgpr_read_b32 v179, a227
    v_accvgpr_read_b32 v180, a228
    v_accvgpr_read_b32 v181, a229
    v_accvgpr_read_b32 v182, a230
    v_accvgpr_read_b32 v183, a231
    v_accvgpr_read_b32 v184, a232
    v_accvgpr_read_b32 v185, a233
    v_accvgpr_read_b32 v186, a234
    v_accvgpr_read_b32 v187, a235
    v_accvgpr_read_b32 v188, a236
    v_accvgpr_read_b32 v189, a237
    v_accvgpr_read_b32 v190, a238
    v_accvgpr_read_b32 v191, a239
    v_pk_mul_f32 v[176:177], v[176:177], v[72:73]
    v_pk_mul_f32 v[178:179], v[178:179], v[74:75]
    v_pk_mul_f32 v[180:181], v[180:181], v[72:73]
    v_pk_mul_f32 v[182:183], v[182:183], v[74:75]
    v_pk_mul_f32 v[184:185], v[184:185], v[72:73]
    v_pk_mul_f32 v[186:187], v[186:187], v[74:75]
    v_pk_mul_f32 v[188:189], v[188:189], v[72:73]
    v_pk_mul_f32 v[190:191], v[190:191], v[74:75]
    v_cvt_pk_bf16_f32 v76, v176, v180
    v_cvt_pk_bf16_f32 v77, v184, v188
    v_cvt_pk_bf16_f32 v78, v177, v181
    v_cvt_pk_bf16_f32 v79, v185, v189
    v_cvt_pk_bf16_f32 v80, v178, v182
    v_cvt_pk_bf16_f32 v81, v186, v190
    v_cvt_pk_bf16_f32 v82, v179, v183
    v_cvt_pk_bf16_f32 v83, v187, v191
    ds_write2st64_b64 v140, v[76:77], v[78:79] offset0:40 offset1:41
    ds_write2st64_b64 v140, v[80:81], v[82:83] offset0:42 offset1:43
    v_pk_add_f32 v[32:33], v[32:33], v[112:113]
    v_pk_add_f32 v[34:35], v[34:35], v[112:113]
    v_pk_add_f32 v[36:37], v[36:37], v[112:113]
    v_pk_add_f32 v[38:39], v[38:39], v[112:113]
    v_exp_f32 v32, v32
    v_exp_f32 v33, v33
    v_exp_f32 v34, v34
    v_cvt_pk_bf16_f32 v64, v32, v33
    v_exp_f32 v35, v35
    s_nop 0
    v_cvt_pk_bf16_f32 v65, v34, v35
    v_accvgpr_read_b32 v192, a240
    v_accvgpr_read_b32 v193, a241
    v_accvgpr_read_b32 v194, a242
    v_accvgpr_read_b32 v195, a243
    v_accvgpr_read_b32 v196, a244
    v_accvgpr_read_b32 v197, a245
    v_accvgpr_read_b32 v198, a246
    v_accvgpr_read_b32 v199, a247
    v_accvgpr_read_b32 v200, a248
    v_accvgpr_read_b32 v201, a249
    v_accvgpr_read_b32 v202, a250
    v_accvgpr_read_b32 v203, a251
    v_accvgpr_read_b32 v204, a252
    v_accvgpr_read_b32 v205, a253
    v_accvgpr_read_b32 v206, a254
    v_accvgpr_read_b32 v207, a255
    v_pk_mul_f32 v[192:193], v[192:193], v[72:73]
    v_pk_mul_f32 v[194:195], v[194:195], v[74:75]
    v_pk_mul_f32 v[196:197], v[196:197], v[72:73]
    v_pk_mul_f32 v[198:199], v[198:199], v[74:75]
    v_pk_mul_f32 v[200:201], v[200:201], v[72:73]
    v_pk_mul_f32 v[202:203], v[202:203], v[74:75]
    v_pk_mul_f32 v[204:205], v[204:205], v[72:73]
    v_pk_mul_f32 v[206:207], v[206:207], v[74:75]
    v_cvt_pk_bf16_f32 v76, v192, v196
    v_cvt_pk_bf16_f32 v77, v200, v204
    v_cvt_pk_bf16_f32 v78, v193, v197
    v_cvt_pk_bf16_f32 v79, v201, v205
    v_cvt_pk_bf16_f32 v80, v194, v198
    v_cvt_pk_bf16_f32 v81, v202, v206
    v_cvt_pk_bf16_f32 v82, v195, v199
    v_cvt_pk_bf16_f32 v83, v203, v207
    ds_write2st64_b64 v140, v[76:77], v[78:79] offset0:44 offset1:45
    ds_write2st64_b64 v140, v[80:81], v[82:83] offset0:46 offset1:47
    v_max3_f32 v116, v40, v41, v42
    v_max3_f32 v117, v43, v44, v45
    v_max3_f32 v116, v116, v46, v47
    v_max_f32 v116, v116, v117
    s_mov_b32 s3, 1
    s_waitcnt lgkmcnt(4)
    v_mfma_f32_16x16x32_bf16 v[0:3], a[96:99], a[0:3], v[96:99]
    v_mov_b32 v117, v116
    v_mfma_f32_16x16x32_bf16 v[0:3], a[100:103], a[4:7], v[0:3]
    ds_read_b128 a[112:115], v120 offset:57344
    s_mov_b32 s32, 4096
    v_mfma_f32_16x16x32_bf16 v[0:3], a[104:107], a[8:11], v[0:3]
    v_permlane32_swap_b32 v116, v117
    v_mfma_f32_16x16x32_bf16 v[0:3], a[108:111], a[12:15], v[0:3]
    v_max_f32 v116, v116, v117
    v_mov_b32 v117, v116
    v_mfma_f32_16x16x32_bf16 v[8:11], a[108:111], a[28:31], v[100:103]
    s_nop 0
    v_permlane16_swap_b32 v116, v117
    v_mfma_f32_16x16x32_bf16 v[8:11], a[104:107], a[24:27], v[8:11]
    v_max_f32 v116, v116, v117
    v_sub_f32 v117, 0, v116
    v_mfma_f32_16x16x32_bf16 v[8:11], a[100:103], a[20:23], v[8:11]
    ds_read_b128 a[116:119], v121 offset:57344
    v_sub_f32 v118, 0, v116
    v_mfma_f32_16x16x32_bf16 v[8:11], a[96:99], a[16:19], v[8:11]
    v_sub_f32 v119, 0, v116
    v_sub_f32 v116, 0, v116
    v_mfma_f32_16x16x32_bf16 v[16:19], a[96:99], a[32:35], v[104:107]
    v_add_f32 v40, v40, v117
    v_add_f32 v41, v41, v117
    v_mfma_f32_16x16x32_bf16 v[16:19], a[100:103], a[36:39], v[16:19]
    v_add_f32 v42, v42, v117
    v_add_f32 v43, v43, v117
    v_mfma_f32_16x16x32_bf16 v[16:19], a[104:107], a[40:43], v[16:19]
    v_add_f32 v44, v44, v117
    v_add_f32 v45, v45, v117
    v_mfma_f32_16x16x32_bf16 v[16:19], a[108:111], a[44:47], v[16:19]
    ds_read_b128 a[120:123], v122 offset:57344
    v_add_f32 v46, v46, v117
    v_mfma_f32_16x16x32_bf16 v[24:27], a[108:111], a[60:63], v[108:111]
    v_add_f32 v47, v47, v117
    v_exp_f32 v40, v40
    v_mfma_f32_16x16x32_bf16 v[24:27], a[104:107], a[56:59], v[24:27]
    ds_read_b128 a[124:127], v123 offset:57344
    v_exp_f32 v30, v30
    v_mfma_f32_16x16x32_bf16 v[24:27], a[100:103], a[52:55], v[24:27]
    v_exp_f32 v41, v41
    v_mfma_f32_16x16x32_bf16 v[24:27], a[96:99], a[48:51], v[24:27]
    v_exp_f32 v42, v42
    v_mfma_f32_16x16x32_bf16 v[32:35], a[96:99], a[64:67], v[112:115]
    v_exp_f32 v37, v37
    v_mfma_f32_16x16x32_bf16 v[32:35], a[100:103], a[68:71], v[32:35]
    v_cvt_pk_bf16_f32 v68, v40, v41
    v_exp_f32 v31, v31
    v_mfma_f32_16x16x32_bf16 v[32:35], a[104:107], a[72:75], v[32:35]
    v_exp_f32 v43, v43
    v_mfma_f32_16x16x32_bf16 v[32:35], a[108:111], a[76:79], v[32:35]
    v_cvt_pk_bf16_f32 v69, v42, v43
    v_cvt_pk_bf16_f32 v63, v30, v31
    v_mfma_f32_16x16x32_bf16 v[40:43], a[108:111], a[92:95], v[116:119]
    v_exp_f32 v29, v29
    v_mfma_f32_16x16x32_bf16 v[40:43], a[104:107], a[88:91], v[40:43]
    v_exp_f32 v36, v36
    v_mfma_f32_16x16x32_bf16 v[40:43], a[100:103], a[84:87], v[40:43]
    v_exp_f32 v28, v28
    v_mfma_f32_16x16x32_bf16 v[40:43], a[96:99], a[80:83], v[40:43]
    s_waitcnt vmcnt(12) lgkmcnt(0)
    s_barrier
    v_mfma_f32_16x16x32_bf16 v[4:7], a[112:115], a[0:3], v[96:99]
    ds_read_b64_tr_b16 a[96:97], v124
    v_exp_f32 v46, v46
    v_exp_f32 v2, v2
    v_mfma_f32_16x16x32_bf16 v[4:7], a[116:119], a[4:7], v[4:7]
    ds_read_b64_tr_b16 a[98:99], v124 offset:8192
    s_add_u32 m0, s30, 49152
    v_mfma_f32_16x16x32_bf16 v[4:7], a[120:123], a[8:11], v[4:7]
    v_cvt_pk_bf16_f32 v62, v28, v29
    v_mfma_f32_16x16x32_bf16 v[4:7], a[124:127], a[12:15], v[4:7]
    global_load_lds_dwordx4 v132, s[22:23] offset:1024 nt
    v_mfma_f32_16x16x32_bf16 v[12:15], a[124:127], a[28:31], v[100:103]
    v_exp_f32 v18, v18
    v_mfma_f32_16x16x32_bf16 v[12:15], a[120:123], a[24:27], v[12:15]
    v_exp_f32 v1, v1
    v_mfma_f32_16x16x32_bf16 v[12:15], a[116:119], a[20:23], v[12:15]
    v_exp_f32 v38, v38
    v_mfma_f32_16x16x32_bf16 v[12:15], a[112:115], a[16:19], v[12:15]
    ds_read_b64_tr_b16 a[100:101], v125
    v_mfma_f32_16x16x32_bf16 v[20:23], a[112:115], a[32:35], v[104:107]
    global_load_lds_dwordx4 v132, s[16:17] nt
    v_mfma_f32_16x16x32_bf16 v[20:23], a[116:119], a[36:39], v[20:23]
    v_exp_f32 v39, v39
    v_mfma_f32_16x16x32_bf16 v[20:23], a[120:123], a[40:43], v[20:23]
    ds_read_b64_tr_b16 a[102:103], v125 offset:8192
    v_cvt_pk_bf16_f32 v67, v38, v39
    v_mfma_f32_16x16x32_bf16 v[20:23], a[124:127], a[44:47], v[20:23]
    v_exp_f32 v44, v44
    v_mfma_f32_16x16x32_bf16 v[28:31], a[124:127], a[60:63], v[108:111]
    ds_read_b64_tr_b16 a[104:105], v126
    v_mfma_f32_16x16x32_bf16 v[28:31], a[120:123], a[56:59], v[28:31]
    global_load_lds_dwordx4 v132, s[22:23] offset:3072 nt
    v_mfma_f32_16x16x32_bf16 v[28:31], a[116:119], a[52:55], v[28:31]
    v_exp_f32 v47, v47
    v_mfma_f32_16x16x32_bf16 v[28:31], a[112:115], a[48:51], v[28:31]
    v_cvt_pk_bf16_f32 v66, v36, v37
    v_cvt_pk_bf16_f32 v71, v46, v47
    v_mfma_f32_16x16x32_bf16 v[36:39], a[112:115], a[64:67], v[112:115]
    v_exp_f32 v45, v45
    v_mfma_f32_16x16x32_bf16 v[36:39], a[116:119], a[68:71], v[36:39]
    ds_read_b64_tr_b16 a[106:107], v126 offset:8192
    v_mfma_f32_16x16x32_bf16 v[36:39], a[120:123], a[72:75], v[36:39]
    global_load_lds_dwordx4 v132, s[16:17] offset:2048 nt
    v_mfma_f32_16x16x32_bf16 v[36:39], a[124:127], a[76:79], v[36:39]
    ds_read_b64_tr_b16 a[108:109], v127
    v_cvt_pk_bf16_f32 v70, v44, v45
    v_mfma_f32_16x16x32_bf16 v[44:47], a[124:127], a[92:95], v[116:119]
    v_exp_f32 v8, v8
    v_mfma_f32_16x16x32_bf16 v[44:47], a[120:123], a[88:91], v[44:47]
    v_exp_f32 v9, v9
    v_mfma_f32_16x16x32_bf16 v[44:47], a[116:119], a[84:87], v[44:47]
    ds_read_b64_tr_b16 a[110:111], v127 offset:8192
    s_waitcnt lgkmcnt(4)
    v_mfma_f32_16x16x32_bf16 v[44:47], a[112:115], a[80:83], v[44:47]
    v_exp_f32 v11, v11
    v_mfma_f32_16x16x32_bf16 v[144:147], v[48:51], a[96:99], 0
    v_exp_f32 v17, v17
    v_mfma_f32_16x16x32_bf16 a[128:131], v[48:51], a[136:139], 0
    v_exp_f32 v16, v16
    v_mfma_f32_16x16x32_bf16 v[148:151], v[48:51], a[100:103], 0
    v_exp_f32 v25, v25
    v_mfma_f32_16x16x32_bf16 v[180:183], v[52:55], a[100:103], 0
    v_exp_f32 v3, v3
    v_mfma_f32_16x16x32_bf16 a[128:131], v[52:55], a[140:143], a[128:131]
    v_exp_f32 v19, v19
    v_mfma_f32_16x16x32_bf16 v[176:179], v[52:55], a[96:99], 0
    v_exp_f32 v10, v10
    v_mfma_f32_16x16x32_bf16 v[208:211], v[56:59], a[96:99], 0
    ds_read_b64_tr_b16 a[112:113], v128
    s_waitcnt lgkmcnt(1)
    v_mfma_f32_16x16x32_bf16 v[212:215], v[56:59], a[100:103], 0
    v_exp_f32 v0, v0
    v_mfma_f32_16x16x32_bf16 v[244:247], v[60:63], a[100:103], 0
    v_exp_f32 v24, v24
    v_mfma_f32_16x16x32_bf16 v[240:243], v[60:63], a[96:99], 0
    ds_read_b64_tr_b16 a[114:115], v128 offset:8192
    v_cvt_pk_bf16_f32 v80, v16, v17
    v_mfma_f32_16x16x32_bf16 a[192:195], v[64:67], a[96:99], 0
    v_exp_f32 v32, v32
    v_mfma_f32_16x16x32_bf16 a[196:199], v[64:67], a[100:103], 0
    ds_read_b64_tr_b16 a[116:117], v129
    v_add_u32 v132, 8192, v132
    v_mfma_f32_16x16x32_bf16 a[228:231], v[68:71], a[100:103], 0
    ds_read_b64_tr_b16 a[118:119], v129 offset:8192
    v_cvt_pk_bf16_f32 v84, v24, v25
    v_mfma_f32_16x16x32_bf16 a[224:227], v[68:71], a[96:99], 0
    v_exp_f32 v40, v40
    v_mfma_f32_16x16x32_bf16 a[232:235], v[68:71], a[104:107], 0
    ds_read_b64_tr_b16 a[120:121], v130
    v_cvt_pk_bf16_f32 v76, v8, v9
    v_mfma_f32_16x16x32_bf16 a[132:135], v[68:71], a[144:147], 0
    ds_read_b64_tr_b16 a[122:123], v130 offset:8192
    v_cvt_pk_bf16_f32 v77, v10, v11
    v_mfma_f32_16x16x32_bf16 a[236:239], v[68:71], a[108:111], 0
    ds_read_b64_tr_b16 a[124:125], v131
    v_cvt_pk_bf16_f32 v81, v18, v19
    v_mfma_f32_16x16x32_bf16 a[204:207], v[64:67], a[108:111], 0
    ds_read_b64_tr_b16 a[126:127], v131 offset:8192
    v_mfma_f32_16x16x32_bf16 a[132:135], v[64:67], a[140:143], a[132:135]
    v_exp_f32 v26, v26
    v_mfma_f32_16x16x32_bf16 a[200:203], v[64:67], a[104:107], 0
    v_exp_f32 v43, v43
    v_mfma_f32_16x16x32_bf16 v[248:251], v[60:63], a[104:107], 0
    v_exp_f32 v33, v33
    v_mfma_f32_16x16x32_bf16 v[252:255], v[60:63], a[108:111], 0
    v_exp_f32 v15, v15
    v_mfma_f32_16x16x32_bf16 v[220:223], v[56:59], a[108:111], 0
    v_exp_f32 v7, v7
    v_mfma_f32_16x16x32_bf16 v[216:219], v[56:59], a[104:107], 0
    v_exp_f32 v42, v42
    v_mfma_f32_16x16x32_bf16 v[184:187], v[52:55], a[104:107], 0
    v_exp_f32 v34, v34
    v_mfma_f32_16x16x32_bf16 v[188:191], v[52:55], a[108:111], 0
    v_exp_f32 v27, v27
    v_mfma_f32_16x16x32_bf16 v[156:159], v[48:51], a[108:111], 0
    v_exp_f32 v35, v35
    v_mfma_f32_16x16x32_bf16 v[152:155], v[48:51], a[104:107], 0
    s_waitcnt lgkmcnt(0)
    v_cvt_pk_bf16_f32 v89, v34, v35
    v_mfma_f32_16x16x32_bf16 v[160:163], v[48:51], a[112:115], 0
    v_exp_f32 v4, v4
    v_mfma_f32_16x16x32_bf16 v[164:167], v[48:51], a[116:119], 0
    v_exp_f32 v5, v5
    v_mfma_f32_16x16x32_bf16 v[196:199], v[52:55], a[116:119], 0
    v_exp_f32 v31, v31
    v_mfma_f32_16x16x32_bf16 v[192:195], v[52:55], a[112:115], 0
    v_exp_f32 v28, v28
    v_mfma_f32_16x16x32_bf16 v[224:227], v[56:59], a[112:115], 0
    v_exp_f32 v41, v41
    v_mfma_f32_16x16x32_bf16 a[128:131], v[56:59], a[144:147], a[128:131]
    v_cvt_pk_bf16_f32 v72, v0, v1
    v_cvt_pk_bf16_f32 v85, v26, v27
    v_mfma_f32_16x16x32_bf16 v[228:231], v[56:59], a[116:119], 0
    ds_read_b128 a[96:99], v120
    v_cvt_pk_bf16_f32 v88, v32, v33
    v_mfma_f32_16x16x32_bf16 a[180:183], v[60:63], a[116:119], 0
    ds_read_b128 a[100:103], v121
    v_cvt_pk_bf16_f32 v92, v40, v41
    v_mfma_f32_16x16x32_bf16 a[176:179], v[60:63], a[112:115], 0
    ds_read_b128 a[104:107], v122
    v_cvt_pk_bf16_f32 v73, v2, v3
    v_mfma_f32_16x16x32_bf16 a[208:211], v[64:67], a[112:115], 0
    v_exp_f32 v6, v6
    v_mfma_f32_16x16x32_bf16 a[212:215], v[64:67], a[116:119], 0
    v_exp_f32 v13, v13
    v_mfma_f32_16x16x32_bf16 a[244:247], v[68:71], a[116:119], 0
    v_exp_f32 v12, v12
    v_mfma_f32_16x16x32_bf16 a[240:243], v[68:71], a[112:115], 0
    ds_read_b128 a[108:111], v123
    v_cvt_pk_bf16_f32 v78, v12, v13
    v_mfma_f32_16x16x32_bf16 a[248:251], v[68:71], a[120:123], 0
    v_exp_f32 v20, v20
    v_mfma_f32_16x16x32_bf16 a[252:255], v[68:71], a[124:127], 0
    v_exp_f32 v21, v21
    v_mfma_f32_16x16x32_bf16 a[220:223], v[64:67], a[124:127], 0
    v_exp_f32 v30, v30
    v_mfma_f32_16x16x32_bf16 a[216:219], v[64:67], a[120:123], 0
    v_exp_f32 v22, v22
    v_mfma_f32_16x16x32_bf16 a[184:187], v[60:63], a[120:123], 0
    v_exp_f32 v29, v29
    v_mfma_f32_16x16x32_bf16 a[132:135], v[60:63], a[136:139], a[132:135]
    v_cvt_pk_bf16_f32 v75, v6, v7
    v_mfma_f32_16x16x32_bf16 a[188:191], v[60:63], a[124:127], 0
    v_cvt_pk_bf16_f32 v74, v4, v5
    v_cvt_pk_bf16_f32 v87, v30, v31
    v_mfma_f32_16x16x32_bf16 v[236:239], v[56:59], a[124:127], 0
    s_waitcnt lgkmcnt(0)
    v_cvt_pk_bf16_f32 v86, v28, v29
    v_mfma_f32_16x16x32_bf16 v[232:235], v[56:59], a[120:123], 0
    v_exp_f32 v23, v23
    v_mfma_f32_16x16x32_bf16 v[200:203], v[52:55], a[120:123], 0
    v_exp_f32 v14, v14
    v_mfma_f32_16x16x32_bf16 v[204:207], v[52:55], a[124:127], 0
    v_cvt_pk_bf16_f32 v79, v14, v15
    v_cvt_pk_bf16_f32 v82, v20, v21
    v_mfma_f32_16x16x32_bf16 v[172:175], v[48:51], a[124:127], 0
    v_cvt_pk_bf16_f32 v93, v42, v43
    v_cvt_pk_bf16_f32 v83, v22, v23
    v_mfma_f32_16x16x32_bf16 v[168:171], v[48:51], a[120:123], 0
.p2align 3
L_M:
    v_mfma_f32_16x16x32_bf16 v[0:3], a[96:99], a[0:3], v[96:99]
    v_exp_f32 v44, v44
    v_mfma_f32_16x16x32_bf16 v[0:3], a[100:103], a[4:7], v[0:3]
    ds_read_b128 a[112:115], v120 offset:8192
    v_mfma_f32_16x16x32_bf16 v[0:3], a[104:107], a[8:11], v[0:3]
    v_mfma_f32_16x16x32_bf16 v[0:3], a[108:111], a[12:15], v[0:3]
    v_mfma_f32_16x16x32_bf16 v[8:11], a[108:111], a[28:31], v[100:103]
    v_mfma_f32_16x16x32_bf16 v[8:11], a[104:107], a[24:27], v[8:11]
    v_exp_f32 v36, v36
    v_mfma_f32_16x16x32_bf16 v[8:11], a[100:103], a[20:23], v[8:11]
    ds_read_b128 a[116:119], v121 offset:8192
    v_mfma_f32_16x16x32_bf16 v[8:11], a[96:99], a[16:19], v[8:11]
    v_exp_f32 v46, v46
    v_mfma_f32_16x16x32_bf16 v[16:19], a[96:99], a[32:35], v[104:107]
    v_exp_f32 v38, v38
    v_mfma_f32_16x16x32_bf16 v[16:19], a[100:103], a[36:39], v[16:19]
    v_exp_f32 v39, v39
    v_mfma_f32_16x16x32_bf16 v[16:19], a[104:107], a[40:43], v[16:19]
    v_exp_f32 v3, v3
    v_mfma_f32_16x16x32_bf16 v[16:19], a[108:111], a[44:47], v[16:19]
    ds_read_b128 a[120:123], v122 offset:8192
    v_mfma_f32_16x16x32_bf16 v[24:27], a[108:111], a[60:63], v[108:111]
    v_mfma_f32_16x16x32_bf16 v[24:27], a[104:107], a[56:59], v[24:27]
    ds_read_b128 a[124:127], v123 offset:8192
    v_mfma_f32_16x16x32_bf16 v[24:27], a[100:103], a[52:55], v[24:27]
    v_exp_f32 v1, v1
    v_mfma_f32_16x16x32_bf16 v[24:27], a[96:99], a[48:51], v[24:27]
    v_mfma_f32_16x16x32_bf16 v[32:35], a[96:99], a[64:67], v[112:115]
    v_exp_f32 v37, v37
    v_mfma_f32_16x16x32_bf16 v[32:35], a[100:103], a[68:71], v[32:35]
    v_cvt_pk_bf16_f32 v90, v36, v37
    v_mfma_f32_16x16x32_bf16 v[32:35], a[104:107], a[72:75], v[32:35]
    v_cvt_pk_bf16_f32 v91, v38, v39
    v_mfma_f32_16x16x32_bf16 v[32:35], a[108:111], a[76:79], v[32:35]
    v_mfma_f32_16x16x32_bf16 v[40:43], a[108:111], a[92:95], v[116:119]
    v_exp_f32 v0, v0
    v_mfma_f32_16x16x32_bf16 v[40:43], a[104:107], a[88:91], v[40:43]
    v_exp_f32 v2, v2
    v_mfma_f32_16x16x32_bf16 v[40:43], a[100:103], a[84:87], v[40:43]
    v_exp_f32 v45, v45
    v_mfma_f32_16x16x32_bf16 v[40:43], a[96:99], a[80:83], v[40:43]
    s_waitcnt vmcnt(10) lgkmcnt(0)
    s_barrier
    v_mfma_f32_16x16x32_bf16 v[4:7], a[112:115], a[0:3], v[96:99]
    v_exp_f32 v47, v47
    v_mfma_f32_16x16x32_bf16 v[4:7], a[116:119], a[4:7], v[4:7]
    s_add_u32 m0, s30, 0
    v_cvt_pk_bf16_f32 v94, v44, v45
    v_mfma_f32_16x16x32_bf16 v[4:7], a[120:123], a[8:11], v[4:7]
    ds_read_b64_tr_b16 a[96:97], v124 offset:16384
    v_mfma_f32_16x16x32_bf16 v[4:7], a[124:127], a[12:15], v[4:7]
    global_load_lds_dwordx4 v132, s[22:23] offset:1024 nt
    v_mfma_f32_16x16x32_bf16 v[12:15], a[124:127], a[28:31], v[100:103]
    v_cvt_pk_bf16_f32 v95, v46, v47
    v_mfma_f32_16x16x32_bf16 v[12:15], a[120:123], a[24:27], v[12:15]
    v_exp_f32 v8, v8
    v_mfma_f32_16x16x32_bf16 v[12:15], a[116:119], a[20:23], v[12:15]
    v_mfma_f32_16x16x32_bf16 v[12:15], a[112:115], a[16:19], v[12:15]
    ds_read_b64_tr_b16 a[98:99], v124 offset:24576
    v_mfma_f32_16x16x32_bf16 v[20:23], a[112:115], a[32:35], v[104:107]
    global_load_lds_dwordx4 v132, s[16:17] nt
    v_mfma_f32_16x16x32_bf16 v[20:23], a[116:119], a[36:39], v[20:23]
    v_exp_f32 v11, v11
    v_mfma_f32_16x16x32_bf16 v[20:23], a[120:123], a[40:43], v[20:23]
    v_exp_f32 v9, v9
    v_mfma_f32_16x16x32_bf16 v[20:23], a[124:127], a[44:47], v[20:23]
    ds_read_b64_tr_b16 a[100:101], v125 offset:16384
    v_mfma_f32_16x16x32_bf16 v[28:31], a[124:127], a[60:63], v[108:111]
    ds_read_b64_tr_b16 a[102:103], v125 offset:24576
    v_mfma_f32_16x16x32_bf16 v[28:31], a[120:123], a[56:59], v[28:31]
    global_load_lds_dwordx4 v132, s[22:23] offset:3072 nt
    v_mfma_f32_16x16x32_bf16 v[28:31], a[116:119], a[52:55], v[28:31]
    v_exp_f32 v10, v10
    v_mfma_f32_16x16x32_bf16 v[28:31], a[112:115], a[48:51], v[28:31]
    ds_read_b64_tr_b16 a[104:105], v126 offset:16384
    v_cvt_pk_bf16_f32 v53, v10, v11
    v_mfma_f32_16x16x32_bf16 v[36:39], a[112:115], a[64:67], v[112:115]
    v_mfma_f32_16x16x32_bf16 v[36:39], a[116:119], a[68:71], v[36:39]
    ds_read_b64_tr_b16 a[106:107], v126 offset:24576
    v_mfma_f32_16x16x32_bf16 v[36:39], a[120:123], a[72:75], v[36:39]
    global_load_lds_dwordx4 v132, s[16:17] offset:2048 nt
    v_mfma_f32_16x16x32_bf16 v[36:39], a[124:127], a[76:79], v[36:39]
    ds_read_b64_tr_b16 a[108:109], v127 offset:16384
    v_mfma_f32_16x16x32_bf16 v[44:47], a[124:127], a[92:95], v[116:119]
    ds_read_b64_tr_b16 a[110:111], v127 offset:24576
    v_cvt_pk_bf16_f32 v52, v8, v9
    v_mfma_f32_16x16x32_bf16 v[44:47], a[120:123], a[88:91], v[44:47]
    s_waitcnt lgkmcnt(4)
    v_cvt_pk_bf16_f32 v48, v0, v1
    v_mfma_f32_16x16x32_bf16 v[44:47], a[116:119], a[84:87], v[44:47]
    v_exp_f32 v17, v17
    v_mfma_f32_16x16x32_bf16 v[44:47], a[112:115], a[80:83], v[44:47]
    v_exp_f32 v27, v27
    v_mfma_f32_16x16x32_bf16 v[144:147], v[72:75], a[96:99], v[144:147]
    ds_read_b64_tr_b16 a[112:113], v128 offset:16384
    v_mfma_f32_16x16x32_bf16 a[128:131], v[72:75], a[136:139], a[128:131]
    v_exp_f32 v16, v16
    v_mfma_f32_16x16x32_bf16 v[148:151], v[72:75], a[100:103], v[148:151]
    v_exp_f32 v18, v18
    v_mfma_f32_16x16x32_bf16 v[180:183], v[76:79], a[100:103], v[180:183]
    v_exp_f32 v19, v19
    v_mfma_f32_16x16x32_bf16 a[128:131], v[76:79], a[140:143], a[128:131]
    ds_read_b64_tr_b16 a[114:115], v128 offset:24576
    s_waitcnt lgkmcnt(2)
    v_mfma_f32_16x16x32_bf16 v[176:179], v[76:79], a[96:99], v[176:179]
    v_exp_f32 v24, v24
    v_mfma_f32_16x16x32_bf16 v[208:211], v[80:83], a[96:99], v[208:211]
    v_exp_f32 v26, v26
    v_mfma_f32_16x16x32_bf16 v[212:215], v[80:83], a[100:103], v[212:215]
    v_exp_f32 v33, v33
    v_mfma_f32_16x16x32_bf16 v[244:247], v[84:87], a[100:103], v[244:247]
    v_exp_f32 v41, v41
    v_mfma_f32_16x16x32_bf16 v[240:243], v[84:87], a[96:99], v[240:243]
    ds_read_b64_tr_b16 a[116:117], v129 offset:16384
    v_mfma_f32_16x16x32_bf16 a[192:195], v[88:91], a[96:99], a[192:195]
    v_exp_f32 v35, v35
    v_mfma_f32_16x16x32_bf16 a[196:199], v[88:91], a[100:103], a[196:199]
    v_exp_f32 v25, v25
L_pad8:
    s_cbranch_vccz L_padret1
    v_mfma_f32_16x16x32_bf16 a[228:231], v[92:95], a[100:103], a[228:231]
    ds_read_b64_tr_b16 a[118:119], v129 offset:24576
    v_cvt_pk_bf16_f32 v49, v2, v3
    v_mfma_f32_16x16x32_bf16 a[224:227], v[92:95], a[96:99], a[224:227]
    ds_read_b64_tr_b16 a[120:121], v130 offset:16384
    v_cvt_pk_bf16_f32 v60, v24, v25
    v_mfma_f32_16x16x32_bf16 a[232:235], v[92:95], a[104:107], a[232:235]
    ds_read_b64_tr_b16 a[122:123], v130 offset:24576
    v_add_u32 v132, 8192, v132
    v_mfma_f32_16x16x32_bf16 a[132:135], v[92:95], a[144:147], a[132:135]
    ds_read_b64_tr_b16 a[124:125], v131 offset:16384
    v_mfma_f32_16x16x32_bf16 a[236:239], v[92:95], a[108:111], a[236:239]
    v_exp_f32 v12, v12
    v_mfma_f32_16x16x32_bf16 a[204:207], v[88:91], a[108:111], a[204:207]
    v_exp_f32 v40, v40
    v_mfma_f32_16x16x32_bf16 a[132:135], v[88:91], a[140:143], a[132:135]
    v_exp_f32 v43, v43
    v_mfma_f32_16x16x32_bf16 a[200:203], v[88:91], a[104:107], a[200:203]
    ds_read_b64_tr_b16 a[126:127], v131 offset:24576
    v_mfma_f32_16x16x32_bf16 v[248:251], v[84:87], a[104:107], v[248:251]
    v_exp_f32 v6, v6
    v_mfma_f32_16x16x32_bf16 v[252:255], v[84:87], a[108:111], v[252:255]
    v_exp_f32 v34, v34
    v_mfma_f32_16x16x32_bf16 v[220:223], v[80:83], a[108:111], v[220:223]
    v_exp_f32 v20, v20
    v_mfma_f32_16x16x32_bf16 v[216:219], v[80:83], a[104:107], v[216:219]
    v_exp_f32 v32, v32
    v_mfma_f32_16x16x32_bf16 v[184:187], v[76:79], a[104:107], v[184:187]
    v_exp_f32 v42, v42
    v_mfma_f32_16x16x32_bf16 v[188:191], v[76:79], a[108:111], v[188:191]
    v_cvt_pk_bf16_f32 v68, v40, v41
    v_mfma_f32_16x16x32_bf16 v[156:159], v[72:75], a[108:111], v[156:159]
    v_cvt_pk_bf16_f32 v69, v42, v43
    v_mfma_f32_16x16x32_bf16 v[152:155], v[72:75], a[104:107], v[152:155]
    s_waitcnt lgkmcnt(0)
    v_cvt_pk_bf16_f32 v57, v18, v19
    v_mfma_f32_16x16x32_bf16 v[160:163], v[72:75], a[112:115], v[160:163]
    v_mfma_f32_16x16x32_bf16 v[164:167], v[72:75], a[116:119], v[164:167]
    v_exp_f32 v5, v5
    v_mfma_f32_16x16x32_bf16 v[196:199], v[76:79], a[116:119], v[196:199]
    v_exp_f32 v14, v14
    v_mfma_f32_16x16x32_bf16 v[192:195], v[76:79], a[112:115], v[192:195]
    ds_read_b128 a[96:99], v120 offset:16384
    v_mfma_f32_16x16x32_bf16 v[224:227], v[80:83], a[112:115], v[224:227]
    v_cvt_pk_bf16_f32 v56, v16, v17
    v_cvt_pk_bf16_f32 v64, v32, v33
    v_mfma_f32_16x16x32_bf16 a[128:131], v[80:83], a[144:147], a[128:131]
    v_exp_f32 v7, v7
    v_mfma_f32_16x16x32_bf16 v[228:231], v[80:83], a[116:119], v[228:231]
    ds_read_b128 a[100:103], v121 offset:16384
    v_mfma_f32_16x16x32_bf16 a[180:183], v[84:87], a[116:119], a[180:183]
    v_exp_f32 v21, v21
    v_mfma_f32_16x16x32_bf16 a[176:179], v[84:87], a[112:115], a[176:179]
    v_exp_f32 v31, v31
    v_mfma_f32_16x16x32_bf16 a[208:211], v[88:91], a[112:115], a[208:211]
    ds_read_b128 a[104:107], v122 offset:16384
    v_mfma_f32_16x16x32_bf16 a[212:215], v[88:91], a[116:119], a[212:215]
    v_exp_f32 v15, v15
    v_mfma_f32_16x16x32_bf16 a[244:247], v[92:95], a[116:119], a[244:247]
    v_exp_f32 v4, v4
    v_mfma_f32_16x16x32_bf16 a[240:243], v[92:95], a[112:115], a[240:243]
    v_cvt_pk_bf16_f32 v50, v4, v5
    v_mfma_f32_16x16x32_bf16 a[248:251], v[92:95], a[120:123], a[248:251]
    v_exp_f32 v13, v13
    v_mfma_f32_16x16x32_bf16 a[252:255], v[92:95], a[124:127], a[252:255]
    v_exp_f32 v29, v29
    v_mfma_f32_16x16x32_bf16 a[220:223], v[88:91], a[124:127], a[220:223]
    v_exp_f32 v30, v30
    v_mfma_f32_16x16x32_bf16 a[216:219], v[88:91], a[120:123], a[216:219]
    ds_read_b128 a[108:111], v123 offset:16384
    v_cvt_pk_bf16_f32 v51, v6, v7
    v_mfma_f32_16x16x32_bf16 a[184:187], v[84:87], a[120:123], a[184:187]
    v_cvt_pk_bf16_f32 v61, v26, v27
    v_cvt_pk_bf16_f32 v63, v30, v31
    v_mfma_f32_16x16x32_bf16 a[132:135], v[84:87], a[136:139], a[132:135]
    v_cvt_pk_bf16_f32 v54, v12, v13
    v_mfma_f32_16x16x32_bf16 a[188:191], v[84:87], a[124:127], a[188:191]
    v_exp_f32 v23, v23
    v_mfma_f32_16x16x32_bf16 v[236:239], v[80:83], a[124:127], v[236:239]
    v_exp_f32 v22, v22
    v_mfma_f32_16x16x32_bf16 v[232:235], v[80:83], a[120:123], v[232:235]
    v_exp_f32 v28, v28
    v_mfma_f32_16x16x32_bf16 v[200:203], v[76:79], a[120:123], v[200:203]
    v_cvt_pk_bf16_f32 v65, v34, v35
    v_cvt_pk_bf16_f32 v55, v14, v15
    v_mfma_f32_16x16x32_bf16 v[204:207], v[76:79], a[124:127], v[204:207]
    v_cvt_pk_bf16_f32 v59, v22, v23
    v_cvt_pk_bf16_f32 v62, v28, v29
    v_mfma_f32_16x16x32_bf16 v[172:175], v[72:75], a[124:127], v[172:175]
    s_waitcnt lgkmcnt(0)
    v_cvt_pk_bf16_f32 v58, v20, v21
    v_mfma_f32_16x16x32_bf16 v[168:171], v[72:75], a[120:123], v[168:171]
    v_mfma_f32_16x16x32_bf16 v[0:3], a[96:99], a[0:3], v[96:99]
    v_exp_f32 v44, v44
    v_mfma_f32_16x16x32_bf16 v[0:3], a[100:103], a[4:7], v[0:3]
    ds_read_b128 a[112:115], v120 offset:24576
    v_mfma_f32_16x16x32_bf16 v[0:3], a[104:107], a[8:11], v[0:3]
    v_mfma_f32_16x16x32_bf16 v[0:3], a[108:111], a[12:15], v[0:3]
    v_mfma_f32_16x16x32_bf16 v[8:11], a[108:111], a[28:31], v[100:103]
    v_mfma_f32_16x16x32_bf16 v[8:11], a[104:107], a[24:27], v[8:11]
    v_exp_f32 v36, v36
    v_mfma_f32_16x16x32_bf16 v[8:11], a[100:103], a[20:23], v[8:11]
    ds_read_b128 a[116:119], v121 offset:24576
    v_mfma_f32_16x16x32_bf16 v[8:11], a[96:99], a[16:19], v[8:11]
    v_exp_f32 v46, v46
    v_mfma_f32_16x16x32_bf16 v[16:19], a[96:99], a[32:35], v[104:107]
    v_exp_f32 v38, v38
    v_mfma_f32_16x16x32_bf16 v[16:19], a[100:103], a[36:39], v[16:19]
    v_exp_f32 v39, v39
    v_mfma_f32_16x16x32_bf16 v[16:19], a[104:107], a[40:43], v[16:19]
    v_exp_f32 v3, v3
    v_mfma_f32_16x16x32_bf16 v[16:19], a[108:111], a[44:47], v[16:19]
    ds_read_b128 a[120:123], v122 offset:24576
    v_mfma_f32_16x16x32_bf16 v[24:27], a[108:111], a[60:63], v[108:111]
    v_mfma_f32_16x16x32_bf16 v[24:27], a[104:107], a[56:59], v[24:27]
    ds_read_b128 a[124:127], v123 offset:24576
    v_mfma_f32_16x16x32_bf16 v[24:27], a[100:103], a[52:55], v[24:27]
    v_exp_f32 v1, v1
    v_mfma_f32_16x16x32_bf16 v[24:27], a[96:99], a[48:51], v[24:27]
    v_mfma_f32_16x16x32_bf16 v[32:35], a[96:99], a[64:67], v[112:115]
    v_exp_f32 v37, v37
    v_mfma_f32_16x16x32_bf16 v[32:35], a[100:103], a[68:71], v[32:35]
    v_cvt_pk_bf16_f32 v66, v36, v37
    v_mfma_f32_16x16x32_bf16 v[32:35], a[104:107], a[72:75], v[32:35]
    v_cvt_pk_bf16_f32 v67, v38, v39
    v_mfma_f32_16x16x32_bf16 v[32:35], a[108:111], a[76:79], v[32:35]
    v_mfma_f32_16x16x32_bf16 v[40:43], a[108:111], a[92:95], v[116:119]
    v_exp_f32 v0, v0
    v_mfma_f32_16x16x32_bf16 v[40:43], a[104:107], a[88:91], v[40:43]
    v_exp_f32 v2, v2
    v_mfma_f32_16x16x32_bf16 v[40:43], a[100:103], a[84:87], v[40:43]
    v_exp_f32 v45, v45
    v_mfma_f32_16x16x32_bf16 v[40:43], a[96:99], a[80:83], v[40:43]
    s_waitcnt vmcnt(10) lgkmcnt(0)
    s_barrier
    v_mfma_f32_16x16x32_bf16 v[4:7], a[112:115], a[0:3], v[96:99]
    v_exp_f32 v47, v47
    v_mfma_f32_16x16x32_bf16 v[4:7], a[116:119], a[4:7], v[4:7]
    s_add_u32 m0, s30, 16384
    v_cvt_pk_bf16_f32 v70, v44, v45
    v_mfma_f32_16x16x32_bf16 v[4:7], a[120:123], a[8:11], v[4:7]
    ds_read_b64_tr_b16 a[96:97], v124 offset:32768
    v_mfma_f32_16x16x32_bf16 v[4:7], a[124:127], a[12:15], v[4:7]
    global_load_lds_dwordx4 v132, s[22:23] offset:1024 nt
    v_mfma_f32_16x16x32_bf16 v[12:15], a[124:127], a[28:31], v[100:103]
    v_cvt_pk_bf16_f32 v71, v46, v47
    v_mfma_f32_16x16x32_bf16 v[12:15], a[120:123], a[24:27], v[12:15]
    v_exp_f32 v8, v8
    v_mfma_f32_16x16x32_bf16 v[12:15], a[116:119], a[20:23], v[12:15]
    v_mfma_f32_16x16x32_bf16 v[12:15], a[112:115], a[16:19], v[12:15]
    ds_read_b64_tr_b16 a[98:99], v124 offset:40960
    v_mfma_f32_16x16x32_bf16 v[20:23], a[112:115], a[32:35], v[104:107]
    global_load_lds_dwordx4 v132, s[16:17] nt
    v_mfma_f32_16x16x32_bf16 v[20:23], a[116:119], a[36:39], v[20:23]
    v_exp_f32 v11, v11
    v_mfma_f32_16x16x32_bf16 v[20:23], a[120:123], a[40:43], v[20:23]
    v_exp_f32 v9, v9
    v_mfma_f32_16x16x32_bf16 v[20:23], a[124:127], a[44:47], v[20:23]
    ds_read_b64_tr_b16 a[100:101], v125 offset:32768
    v_mfma_f32_16x16x32_bf16 v[28:31], a[124:127], a[60:63], v[108:111]
    ds_read_b64_tr_b16 a[102:103], v125 offset:40960
    v_mfma_f32_16x16x32_bf16 v[28:31], a[120:123], a[56:59], v[28:31]
    global_load_lds_dwordx4 v132, s[22:23] offset:3072 nt
    v_mfma_f32_16x16x32_bf16 v[28:31], a[116:119], a[52:55], v[28:31]
    v_exp_f32 v10, v10
    v_mfma_f32_16x16x32_bf16 v[28:31], a[112:115], a[48:51], v[28:31]
    ds_read_b64_tr_b16 a[104:105], v126 offset:32768
    v_cvt_pk_bf16_f32 v77, v10, v11
    v_mfma_f32_16x16x32_bf16 v[36:39], a[112:115], a[64:67], v[112:115]
    v_mfma_f32_16x16x32_bf16 v[36:39], a[116:119], a[68:71], v[36:39]
    ds_read_b64_tr_b16 a[106:107], v126 offset:40960
    v_mfma_f32_16x16x32_bf16 v[36:39], a[120:123], a[72:75], v[36:39]
    global_load_lds_dwordx4 v132, s[16:17] offset:2048 nt
    v_mfma_f32_16x16x32_bf16 v[36:39], a[124:127], a[76:79], v[36:39]
    ds_read_b64_tr_b16 a[108:109], v127 offset:32768
    v_mfma_f32_16x16x32_bf16 v[44:47], a[124:127], a[92:95], v[116:119]
    ds_read_b64_tr_b16 a[110:111], v127 offset:40960
    v_cvt_pk_bf16_f32 v76, v8, v9
    v_mfma_f32_16x16x32_bf16 v[44:47], a[120:123], a[88:91], v[44:47]
    s_waitcnt lgkmcnt(4)
    v_cvt_pk_bf16_f32 v72, v0, v1
    v_mfma_f32_16x16x32_bf16 v[44:47], a[116:119], a[84:87], v[44:47]
    v_exp_f32 v17, v17
    v_mfma_f32_16x16x32_bf16 v[44:47], a[112:115], a[80:83], v[44:47]
    v_exp_f32 v27, v27
    v_mfma_f32_16x16x32_bf16 v[144:147], v[48:51], a[96:99], v[144:147]
    ds_read_b64_tr_b16 a[112:113], v128 offset:32768
    v_mfma_f32_16x16x32_bf16 a[128:131], v[48:51], a[136:139], a[128:131]
    v_exp_f32 v16, v16
    v_mfma_f32_16x16x32_bf16 v[148:151], v[48:51], a[100:103], v[148:151]
    v_exp_f32 v18, v18
    v_mfma_f32_16x16x32_bf16 v[180:183], v[52:55], a[100:103], v[180:183]
    v_exp_f32 v19, v19
    v_mfma_f32_16x16x32_bf16 a[128:131], v[52:55], a[140:143], a[128:131]
    ds_read_b64_tr_b16 a[114:115], v128 offset:40960
    s_waitcnt lgkmcnt(2)
    v_mfma_f32_16x16x32_bf16 v[176:179], v[52:55], a[96:99], v[176:179]
    v_exp_f32 v24, v24
    v_mfma_f32_16x16x32_bf16 v[208:211], v[56:59], a[96:99], v[208:211]
    v_exp_f32 v26, v26
    v_mfma_f32_16x16x32_bf16 v[212:215], v[56:59], a[100:103], v[212:215]
    v_exp_f32 v33, v33
    v_mfma_f32_16x16x32_bf16 v[244:247], v[60:63], a[100:103], v[244:247]
    v_exp_f32 v41, v41
    v_mfma_f32_16x16x32_bf16 v[240:243], v[60:63], a[96:99], v[240:243]
    ds_read_b64_tr_b16 a[116:117], v129 offset:32768
    v_mfma_f32_16x16x32_bf16 a[192:195], v[64:67], a[96:99], a[192:195]
    v_exp_f32 v35, v35
    v_mfma_f32_16x16x32_bf16 a[196:199], v[64:67], a[100:103], a[196:199]
    v_exp_f32 v25, v25
    v_mfma_f32_16x16x32_bf16 a[228:231], v[68:71], a[100:103], a[228:231]
    ds_read_b64_tr_b16 a[118:119], v129 offset:40960
    v_cvt_pk_bf16_f32 v73, v2, v3
    v_mfma_f32_16x16x32_bf16 a[224:227], v[68:71], a[96:99], a[224:227]
    ds_read_b64_tr_b16 a[120:121], v130 offset:32768
    v_cvt_pk_bf16_f32 v84, v24, v25
    v_mfma_f32_16x16x32_bf16 a[232:235], v[68:71], a[104:107], a[232:235]
    ds_read_b64_tr_b16 a[122:123], v130 offset:40960
    v_add_u32 v132, 8192, v132
    v_mfma_f32_16x16x32_bf16 a[132:135], v[68:71], a[144:147], a[132:135]
    ds_read_b64_tr_b16 a[124:125], v131 offset:32768
    v_mfma_f32_16x16x32_bf16 a[236:239], v[68:71], a[108:111], a[236:239]
    v_exp_f32 v12, v12
    v_mfma_f32_16x16x32_bf16 a[204:207], v[64:67], a[108:111], a[204:207]
    v_exp_f32 v40, v40
    v_mfma_f32_16x16x32_bf16 a[132:135], v[64:67], a[140:143], a[132:135]
    v_exp_f32 v43, v43
    v_mfma_f32_16x16x32_bf16 a[200:203], v[64:67], a[104:107], a[200:203]
    ds_read_b64_tr_b16 a[126:127], v131 offset:40960
    v_mfma_f32_16x16x32_bf16 v[248:251], v[60:63], a[104:107], v[248:251]
    v_exp_f32 v6, v6
    v_mfma_f32_16x16x32_bf16 v[252:255], v[60:63], a[108:111], v[252:255]
    v_exp_f32 v34, v34
    v_mfma_f32_16x16x32_bf16 v[220:223], v[56:59], a[108:111], v[220:223]
    v_exp_f32 v20, v20
    v_mfma_f32_16x16x32_bf16 v[216:219], v[56:59], a[104:107], v[216:219]
    v_exp_f32 v32, v32
    v_mfma_f32_16x16x32_bf16 v[184:187], v[52:55], a[104:107], v[184:187]
    v_exp_f32 v42, v42
    v_mfma_f32_16x16x32_bf16 v[188:191], v[52:55], a[108:111], v[188:191]
    v_cvt_pk_bf16_f32 v92, v40, v41
    v_mfma_f32_16x16x32_bf16 v[156:159], v[48:51], a[108:111], v[156:159]
    v_cvt_pk_bf16_f32 v93, v42, v43
    v_mfma_f32_16x16x32_bf16 v[152:155], v[48:51], a[104:107], v[152:155]
    s_waitcnt lgkmcnt(0)
    v_cvt_pk_bf16_f32 v81, v18, v19
    v_mfma_f32_16x16x32_bf16 v[160:163], v[48:51], a[112:115], v[160:163]
    v_mfma_f32_16x16x32_bf16 v[164:167], v[48:51], a[116:119], v[164:167]
    v_exp_f32 v5, v5
    v_mfma_f32_16x16x32_bf16 v[196:199], v[52:55], a[116:119], v[196:199]
    v_exp_f32 v14, v14
    v_mfma_f32_16x16x32_bf16 v[192:195], v[52:55], a[112:115], v[192:195]
    ds_read_b128 a[96:99], v120 offset:32768
    v_mfma_f32_16x16x32_bf16 v[224:227], v[56:59], a[112:115], v[224:227]
    v_cvt_pk_bf16_f32 v80, v16, v17
    v_cvt_pk_bf16_f32 v88, v32, v33
    v_mfma_f32_16x16x32_bf16 a[128:131], v[56:59], a[144:147], a[128:131]
    v_exp_f32 v7, v7
    v_mfma_f32_16x16x32_bf16 v[228:231], v[56:59], a[116:119], v[228:231]
    ds_read_b128 a[100:103], v121 offset:32768
    v_mfma_f32_16x16x32_bf16 a[180:183], v[60:63], a[116:119], a[180:183]
    v_exp_f32 v21, v21
    v_mfma_f32_16x16x32_bf16 a[176:179], v[60:63], a[112:115], a[176:179]
    v_exp_f32 v31, v31
    v_mfma_f32_16x16x32_bf16 a[208:211], v[64:67], a[112:115], a[208:211]
    ds_read_b128 a[104:107], v122 offset:32768
    v_mfma_f32_16x16x32_bf16 a[212:215], v[64:67], a[116:119], a[212:215]
    v_exp_f32 v15, v15
    v_mfma_f32_16x16x32_bf16 a[244:247], v[68:71], a[116:119], a[244:247]
    v_exp_f32 v4, v4
    v_mfma_f32_16x16x32_bf16 a[240:243], v[68:71], a[112:115], a[240:243]
    v_cvt_pk_bf16_f32 v74, v4, v5
    v_mfma_f32_16x16x32_bf16 a[248:251], v[68:71], a[120:123], a[248:251]
    v_exp_f32 v13, v13
    v_mfma_f32_16x16x32_bf16 a[252:255], v[68:71], a[124:127], a[252:255]
    v_exp_f32 v29, v29
    v_mfma_f32_16x16x32_bf16 a[220:223], v[64:67], a[124:127], a[220:223]
    v_exp_f32 v30, v30
    v_mfma_f32_16x16x32_bf16 a[216:219], v[64:67], a[120:123], a[216:219]
    ds_read_b128 a[108:111], v123 offset:32768
    v_cvt_pk_bf16_f32 v75, v6, v7
    v_mfma_f32_16x16x32_bf16 a[184:187], v[60:63], a[120:123], a[184:187]
    v_cvt_pk_bf16_f32 v85, v26, v27
    v_cvt_pk_bf16_f32 v87, v30, v31
    v_mfma_f32_16x16x32_bf16 a[132:135], v[60:63], a[136:139], a[132:135]
    v_cvt_pk_bf16_f32 v78, v12, v13
    v_mfma_f32_16x16x32_bf16 a[188:191], v[60:63], a[124:127], a[188:191]
    v_exp_f32 v23, v23
    v_mfma_f32_16x16x32_bf16 v[236:239], v[56:59], a[124:127], v[236:239]
    v_exp_f32 v22, v22
    v_mfma_f32_16x16x32_bf16 v[232:235], v[56:59], a[120:123], v[232:235]
    v_exp_f32 v28, v28
    v_mfma_f32_16x16x32_bf16 v[200:203], v[52:55], a[120:123], v[200:203]
    v_cvt_pk_bf16_f32 v89, v34, v35
    v_cvt_pk_bf16_f32 v79, v14, v15
    v_mfma_f32_16x16x32_bf16 v[204:207], v[52:55], a[124:127], v[204:207]
    v_cvt_pk_bf16_f32 v83, v22, v23
    v_cvt_pk_bf16_f32 v86, v28, v29
    v_mfma_f32_16x16x32_bf16 v[172:175], v[48:51], a[124:127], v[172:175]
    s_waitcnt lgkmcnt(0)
    v_cvt_pk_bf16_f32 v82, v20, v21
    v_mfma_f32_16x16x32_bf16 v[168:171], v[48:51], a[120:123], v[168:171]
    v_mfma_f32_16x16x32_bf16 v[0:3], a[96:99], a[0:3], v[96:99]
    v_exp_f32 v44, v44
    v_mfma_f32_16x16x32_bf16 v[0:3], a[100:103], a[4:7], v[0:3]
    ds_read_b128 a[112:115], v120 offset:40960
    v_mfma_f32_16x16x32_bf16 v[0:3], a[104:107], a[8:11], v[0:3]
    v_mfma_f32_16x16x32_bf16 v[0:3], a[108:111], a[12:15], v[0:3]
    v_mfma_f32_16x16x32_bf16 v[8:11], a[108:111], a[28:31], v[100:103]
    v_mfma_f32_16x16x32_bf16 v[8:11], a[104:107], a[24:27], v[8:11]
    v_exp_f32 v36, v36
    v_mfma_f32_16x16x32_bf16 v[8:11], a[100:103], a[20:23], v[8:11]
    ds_read_b128 a[116:119], v121 offset:40960
    v_mfma_f32_16x16x32_bf16 v[8:11], a[96:99], a[16:19], v[8:11]
    v_exp_f32 v46, v46
    v_mfma_f32_16x16x32_bf16 v[16:19], a[96:99], a[32:35], v[104:107]
    v_exp_f32 v38, v38
    v_mfma_f32_16x16x32_bf16 v[16:19], a[100:103], a[36:39], v[16:19]
    v_exp_f32 v39, v39
    v_mfma_f32_16x16x32_bf16 v[16:19], a[104:107], a[40:43], v[16:19]
    v_exp_f32 v3, v3
    v_mfma_f32_16x16x32_bf16 v[16:19], a[108:111], a[44:47], v[16:19]
    ds_read_b128 a[120:123], v122 offset:40960
    v_mfma_f32_16x16x32_bf16 v[24:27], a[108:111], a[60:63], v[108:111]
    v_mfma_f32_16x16x32_bf16 v[24:27], a[104:107], a[56:59], v[24:27]
    ds_read_b128 a[124:127], v123 offset:40960
    v_mfma_f32_16x16x32_bf16 v[24:27], a[100:103], a[52:55], v[24:27]
    v_exp_f32 v1, v1
    v_mfma_f32_16x16x32_bf16 v[24:27], a[96:99], a[48:51], v[24:27]
    v_mfma_f32_16x16x32_bf16 v[32:35], a[96:99], a[64:67], v[112:115]
    v_exp_f32 v37, v37
    v_mfma_f32_16x16x32_bf16 v[32:35], a[100:103], a[68:71], v[32:35]
    v_cvt_pk_bf16_f32 v90, v36, v37
    v_mfma_f32_16x16x32_bf16 v[32:35], a[104:107], a[72:75], v[32:35]
    v_cvt_pk_bf16_f32 v91, v38, v39
    v_mfma_f32_16x16x32_bf16 v[32:35], a[108:111], a[76:79], v[32:35]
    v_mfma_f32_16x16x32_bf16 v[40:43], a[108:111], a[92:95], v[116:119]
    v_exp_f32 v0, v0
    v_mfma_f32_16x16x32_bf16 v[40:43], a[104:107], a[88:91], v[40:43]
    v_exp_f32 v2, v2
    v_mfma_f32_16x16x32_bf16 v[40:43], a[100:103], a[84:87], v[40:43]
    v_exp_f32 v45, v45
    v_mfma_f32_16x16x32_bf16 v[40:43], a[96:99], a[80:83], v[40:43]
    s_waitcnt vmcnt(8) lgkmcnt(0)
    s_barrier
    v_mfma_f32_16x16x32_bf16 v[4:7], a[112:115], a[0:3], v[96:99]
    v_exp_f32 v47, v47
    v_mfma_f32_16x16x32_bf16 v[4:7], a[116:119], a[4:7], v[4:7]
    s_add_u32 m0, s30, 32768
    v_cvt_pk_bf16_f32 v94, v44, v45
    v_mfma_f32_16x16x32_bf16 v[4:7], a[120:123], a[8:11], v[4:7]
    ds_read_b64_tr_b16 a[96:97], v124 offset:49152
    v_mfma_f32_16x16x32_bf16 v[4:7], a[124:127], a[12:15], v[4:7]
    global_load_lds_dwordx4 v132, s[22:23] offset:1024 nt
    v_mfma_f32_16x16x32_bf16 v[12:15], a[124:127], a[28:31], v[100:103]
    v_cvt_pk_bf16_f32 v95, v46, v47
    v_mfma_f32_16x16x32_bf16 v[12:15], a[120:123], a[24:27], v[12:15]
    v_exp_f32 v8, v8
    v_mfma_f32_16x16x32_bf16 v[12:15], a[116:119], a[20:23], v[12:15]
    v_mfma_f32_16x16x32_bf16 v[12:15], a[112:115], a[16:19], v[12:15]
    ds_read_b64_tr_b16 a[98:99], v124 offset:57344
    v_mfma_f32_16x16x32_bf16 v[20:23], a[112:115], a[32:35], v[104:107]
    global_load_lds_dwordx4 v132, s[16:17] nt
    v_mfma_f32_16x16x32_bf16 v[20:23], a[116:119], a[36:39], v[20:23]
    v_exp_f32 v11, v11
    v_mfma_f32_16x16x32_bf16 v[20:23], a[120:123], a[40:43], v[20:23]
    v_exp_f32 v9, v9
    v_mfma_f32_16x16x32_bf16 v[20:23], a[124:127], a[44:47], v[20:23]
    ds_read_b64_tr_b16 a[100:101], v125 offset:49152
    v_mfma_f32_16x16x32_bf16 v[28:31], a[124:127], a[60:63], v[108:111]
    ds_read_b64_tr_b16 a[102:103], v125 offset:57344
    v_mfma_f32_16x16x32_bf16 v[28:31], a[120:123], a[56:59], v[28:31]
    global_load_lds_dwordx4 v132, s[22:23] offset:3072 nt
    v_mfma_f32_16x16x32_bf16 v[28:31], a[116:119], a[52:55], v[28:31]
    v_exp_f32 v10, v10
    v_mfma_f32_16x16x32_bf16 v[28:31], a[112:115], a[48:51], v[28:31]
    ds_read_b64_tr_b16 a[104:105], v126 offset:49152
    v_cvt_pk_bf16_f32 v53, v10, v11
    v_mfma_f32_16x16x32_bf16 v[36:39], a[112:115], a[64:67], v[112:115]
    v_mfma_f32_16x16x32_bf16 v[36:39], a[116:119], a[68:71], v[36:39]
    ds_read_b64_tr_b16 a[106:107], v126 offset:57344
    v_mfma_f32_16x16x32_bf16 v[36:39], a[120:123], a[72:75], v[36:39]
    global_load_lds_dwordx4 v132, s[16:17] offset:2048 nt
    v_mfma_f32_16x16x32_bf16 v[36:39], a[124:127], a[76:79], v[36:39]
    ds_read_b64_tr_b16 a[108:109], v127 offset:49152
    v_mfma_f32_16x16x32_bf16 v[44:47], a[124:127], a[92:95], v[116:119]
    ds_read_b64_tr_b16 a[110:111], v127 offset:57344
    v_cvt_pk_bf16_f32 v52, v8, v9
    v_mfma_f32_16x16x32_bf16 v[44:47], a[120:123], a[88:91], v[44:47]
    s_waitcnt lgkmcnt(4)
    v_cvt_pk_bf16_f32 v48, v0, v1
    v_mfma_f32_16x16x32_bf16 v[44:47], a[116:119], a[84:87], v[44:47]
    v_exp_f32 v17, v17
    v_mfma_f32_16x16x32_bf16 v[44:47], a[112:115], a[80:83], v[44:47]
    v_exp_f32 v27, v27
    v_mfma_f32_16x16x32_bf16 v[144:147], v[72:75], a[96:99], v[144:147]
    ds_read_b64_tr_b16 a[112:113], v128 offset:49152
    v_mfma_f32_16x16x32_bf16 a[128:131], v[72:75], a[136:139], a[128:131]
    v_exp_f32 v16, v16
    v_mfma_f32_16x16x32_bf16 v[148:151], v[72:75], a[100:103], v[148:151]
    v_exp_f32 v18, v18
    v_mfma_f32_16x16x32_bf16 v[180:183], v[76:79], a[100:103], v[180:183]
    v_exp_f32 v19, v19
    v_mfma_f32_16x16x32_bf16 a[128:131], v[76:79], a[140:143], a[128:131]
    ds_read_b64_tr_b16 a[114:115], v128 offset:57344
    s_waitcnt lgkmcnt(2)
    v_mfma_f32_16x16x32_bf16 v[176:179], v[76:79], a[96:99], v[176:179]
    v_exp_f32 v24, v24
    v_mfma_f32_16x16x32_bf16 v[208:211], v[80:83], a[96:99], v[208:211]
    v_exp_f32 v26, v26
    v_mfma_f32_16x16x32_bf16 v[212:215], v[80:83], a[100:103], v[212:215]
    v_exp_f32 v33, v33
    v_mfma_f32_16x16x32_bf16 v[244:247], v[84:87], a[100:103], v[244:247]
    v_exp_f32 v41, v41
    v_mfma_f32_16x16x32_bf16 v[240:243], v[84:87], a[96:99], v[240:243]
    ds_read_b64_tr_b16 a[116:117], v129 offset:49152
    v_mfma_f32_16x16x32_bf16 a[192:195], v[88:91], a[96:99], a[192:195]
    v_exp_f32 v35, v35
    v_mfma_f32_16x16x32_bf16 a[196:199], v[88:91], a[100:103], a[196:199]
    v_exp_f32 v25, v25
    v_mfma_f32_16x16x32_bf16 a[228:231], v[92:95], a[100:103], a[228:231]
    ds_read_b64_tr_b16 a[118:119], v129 offset:57344
    v_cvt_pk_bf16_f32 v49, v2, v3
    v_mfma_f32_16x16x32_bf16 a[224:227], v[92:95], a[96:99], a[224:227]
    ds_read_b64_tr_b16 a[120:121], v130 offset:49152
    v_cvt_pk_bf16_f32 v60, v24, v25
    v_mfma_f32_16x16x32_bf16 a[232:235], v[92:95], a[104:107], a[232:235]
    ds_read_b64_tr_b16 a[122:123], v130 offset:57344
    v_add_u32 v132, 8192, v132
    v_mfma_f32_16x16x32_bf16 a[132:135], v[92:95], a[144:147], a[132:135]
    ds_read_b64_tr_b16 a[124:125], v131 offset:49152
    v_mfma_f32_16x16x32_bf16 a[236:239], v[92:95], a[108:111], a[236:239]
    v_exp_f32 v12, v12
    v_mfma_f32_16x16x32_bf16 a[204:207], v[88:91], a[108:111], a[204:207]
    v_exp_f32 v40, v40
    v_mfma_f32_16x16x32_bf16 a[132:135], v[88:91], a[140:143], a[132:135]
    v_exp_f32 v43, v43
    v_mfma_f32_16x16x32_bf16 a[200:203], v[88:91], a[104:107], a[200:203]
    ds_read_b64_tr_b16 a[126:127], v131 offset:57344
    v_mfma_f32_16x16x32_bf16 v[248:251], v[84:87], a[104:107], v[248:251]
    v_exp_f32 v6, v6
    v_mfma_f32_16x16x32_bf16 v[252:255], v[84:87], a[108:111], v[252:255]
    v_exp_f32 v34, v34
    v_mfma_f32_16x16x32_bf16 v[220:223], v[80:83], a[108:111], v[220:223]
    v_exp_f32 v20, v20
    v_mfma_f32_16x16x32_bf16 v[216:219], v[80:83], a[104:107], v[216:219]
    v_exp_f32 v32, v32
    v_mfma_f32_16x16x32_bf16 v[184:187], v[76:79], a[104:107], v[184:187]
    v_exp_f32 v42, v42
    v_mfma_f32_16x16x32_bf16 v[188:191], v[76:79], a[108:111], v[188:191]
    v_cvt_pk_bf16_f32 v68, v40, v41
    v_mfma_f32_16x16x32_bf16 v[156:159], v[72:75], a[108:111], v[156:159]
    v_cvt_pk_bf16_f32 v69, v42, v43
    v_mfma_f32_16x16x32_bf16 v[152:155], v[72:75], a[104:107], v[152:155]
    s_waitcnt lgkmcnt(0)
    v_cvt_pk_bf16_f32 v57, v18, v19
    v_mfma_f32_16x16x32_bf16 v[160:163], v[72:75], a[112:115], v[160:163]
    v_mfma_f32_16x16x32_bf16 v[164:167], v[72:75], a[116:119], v[164:167]
    v_exp_f32 v5, v5
    v_mfma_f32_16x16x32_bf16 v[196:199], v[76:79], a[116:119], v[196:199]
    v_exp_f32 v14, v14
    v_mfma_f32_16x16x32_bf16 v[192:195], v[76:79], a[112:115], v[192:195]
    ds_read_b128 a[96:99], v120 offset:49152
    v_mfma_f32_16x16x32_bf16 v[224:227], v[80:83], a[112:115], v[224:227]
    v_cvt_pk_bf16_f32 v56, v16, v17
    v_cvt_pk_bf16_f32 v64, v32, v33
    v_mfma_f32_16x16x32_bf16 a[128:131], v[80:83], a[144:147], a[128:131]
    v_exp_f32 v7, v7
    v_mfma_f32_16x16x32_bf16 v[228:231], v[80:83], a[116:119], v[228:231]
    ds_read_b128 a[100:103], v121 offset:49152
    v_mfma_f32_16x16x32_bf16 a[180:183], v[84:87], a[116:119], a[180:183]
    v_exp_f32 v21, v21
    v_mfma_f32_16x16x32_bf16 a[176:179], v[84:87], a[112:115], a[176:179]
    v_exp_f32 v31, v31
    v_mfma_f32_16x16x32_bf16 a[208:211], v[88:91], a[112:115], a[208:211]
    ds_read_b128 a[104:107], v122 offset:49152
    v_mfma_f32_16x16x32_bf16 a[212:215], v[88:91], a[116:119], a[212:215]
    v_exp_f32 v15, v15
    v_mfma_f32_16x16x32_bf16 a[244:247], v[92:95], a[116:119], a[244:247]
    v_exp_f32 v4, v4
    v_mfma_f32_16x16x32_bf16 a[240:243], v[92:95], a[112:115], a[240:243]
    v_cvt_pk_bf16_f32 v50, v4, v5
    v_mfma_f32_16x16x32_bf16 a[248:251], v[92:95], a[120:123], a[248:251]
    v_exp_f32 v13, v13
    v_mfma_f32_16x16x32_bf16 a[252:255], v[92:95], a[124:127], a[252:255]
    v_exp_f32 v29, v29
    v_mfma_f32_16x16x32_bf16 a[220:223], v[88:91], a[124:127], a[220:223]
    v_exp_f32 v30, v30
    v_mfma_f32_16x16x32_bf16 a[216:219], v[88:91], a[120:123], a[216:219]
    ds_read_b128 a[108:111], v123 offset:49152
    v_cvt_pk_bf16_f32 v51, v6, v7
    v_mfma_f32_16x16x32_bf16 a[184:187], v[84:87], a[120:123], a[184:187]
    v_cvt_pk_bf16_f32 v61, v26, v27
    v_cvt_pk_bf16_f32 v63, v30, v31
    v_mfma_f32_16x16x32_bf16 a[132:135], v[84:87], a[136:139], a[132:135]
    v_cvt_pk_bf16_f32 v54, v12, v13
    v_mfma_f32_16x16x32_bf16 a[188:191], v[84:87], a[124:127], a[188:191]
    v_exp_f32 v23, v23
    v_mfma_f32_16x16x32_bf16 v[236:239], v[80:83], a[124:127], v[236:239]
    v_exp_f32 v22, v22
    v_mfma_f32_16x16x32_bf16 v[232:235], v[80:83], a[120:123], v[232:235]
    v_exp_f32 v28, v28
    v_mfma_f32_16x16x32_bf16 v[200:203], v[76:79], a[120:123], v[200:203]
    v_cvt_pk_bf16_f32 v65, v34, v35
    v_cvt_pk_bf16_f32 v55, v14, v15
    v_mfma_f32_16x16x32_bf16 v[204:207], v[76:79], a[124:127], v[204:207]
    v_cvt_pk_bf16_f32 v59, v22, v23
    v_cvt_pk_bf16_f32 v62, v28, v29
    v_mfma_f32_16x16x32_bf16 v[172:175], v[72:75], a[124:127], v[172:175]
    s_waitcnt lgkmcnt(0)
    v_cvt_pk_bf16_f32 v58, v20, v21
    v_mfma_f32_16x16x32_bf16 v[168:171], v[72:75], a[120:123], v[168:171]
    v_mfma_f32_16x16x32_bf16 v[0:3], a[96:99], a[0:3], v[96:99]
    v_exp_f32 v37, v37
    v_mfma_f32_16x16x32_bf16 v[0:3], a[100:103], a[4:7], v[0:3]
    ds_read_b128 a[112:115], v120 offset:57344
    v_mfma_f32_16x16x32_bf16 v[0:3], a[104:107], a[8:11], v[0:3]
    v_exp_f32 v38, v38
    v_mfma_f32_16x16x32_bf16 v[0:3], a[108:111], a[12:15], v[0:3]
    v_exp_f32 v39, v39
    v_mfma_f32_16x16x32_bf16 v[8:11], a[108:111], a[28:31], v[100:103]
    v_exp_f32 v36, v36
    v_mfma_f32_16x16x32_bf16 v[8:11], a[104:107], a[24:27], v[8:11]
    v_exp_f32 v46, v46
    v_mfma_f32_16x16x32_bf16 v[8:11], a[100:103], a[20:23], v[8:11]
    ds_read_b128 a[116:119], v121 offset:57344
    v_mfma_f32_16x16x32_bf16 v[8:11], a[96:99], a[16:19], v[8:11]
    v_mfma_f32_16x16x32_bf16 v[16:19], a[96:99], a[32:35], v[104:107]
    v_exp_f32 v44, v44
    v_mfma_f32_16x16x32_bf16 v[16:19], a[100:103], a[36:39], v[16:19]
    ds_read_b64_tr_b16 a[148:149], v141 offset:4096
    v_cvt_pk_bf16_f32 v67, v38, v39
    v_mfma_f32_16x16x32_bf16 v[16:19], a[104:107], a[40:43], v[16:19]
    ds_read_b64_tr_b16 a[150:151], v141 offset:4128
    v_mfma_f32_16x16x32_bf16 v[16:19], a[108:111], a[44:47], v[16:19]
    ds_read_b128 a[120:123], v122 offset:57344
    v_cvt_pk_bf16_f32 v66, v36, v37
    v_mfma_f32_16x16x32_bf16 v[24:27], a[108:111], a[60:63], v[108:111]
    v_mfma_f32_16x16x32_bf16 v[24:27], a[104:107], a[56:59], v[24:27]
    ds_read_b128 a[124:127], v123 offset:57344
    v_mfma_f32_16x16x32_bf16 v[24:27], a[100:103], a[52:55], v[24:27]
    ds_read_b64_tr_b16 a[152:153], v141 offset:4224
    v_mfma_f32_16x16x32_bf16 v[24:27], a[96:99], a[48:51], v[24:27]
    ds_read_b64_tr_b16 a[154:155], v141 offset:4256
    v_mfma_f32_16x16x32_bf16 v[32:35], a[96:99], a[64:67], v[112:115]
    v_mfma_f32_16x16x32_bf16 v[32:35], a[100:103], a[68:71], v[32:35]
    v_exp_f32 v1, v1
    v_mfma_f32_16x16x32_bf16 v[32:35], a[104:107], a[72:75], v[32:35]
    v_exp_f32 v47, v47
    v_mfma_f32_16x16x32_bf16 v[32:35], a[108:111], a[76:79], v[32:35]
    v_exp_f32 v2, v2
    v_mfma_f32_16x16x32_bf16 v[40:43], a[108:111], a[92:95], v[116:119]
    v_mfma_f32_16x16x32_bf16 v[40:43], a[104:107], a[88:91], v[40:43]
    v_exp_f32 v45, v45
    v_mfma_f32_16x16x32_bf16 v[40:43], a[100:103], a[84:87], v[40:43]
    v_exp_f32 v0, v0
    v_mfma_f32_16x16x32_bf16 v[40:43], a[96:99], a[80:83], v[40:43]
    s_waitcnt vmcnt(8) lgkmcnt(0)
    s_barrier
    v_mfma_f32_16x16x32_bf16 v[4:7], a[112:115], a[0:3], v[96:99]
    v_exp_f32 v9, v9
    v_mfma_f32_16x16x32_bf16 v[4:7], a[116:119], a[4:7], v[4:7]
    s_add_u32 m0, s30, 49152
    v_cvt_pk_bf16_f32 v70, v44, v45
    v_mfma_f32_16x16x32_bf16 v[4:7], a[120:123], a[8:11], v[4:7]
    ds_read_b64_tr_b16 a[96:97], v124
    v_mfma_f32_16x16x32_bf16 v[4:7], a[124:127], a[12:15], v[4:7]
    global_load_lds_dwordx4 v132, s[22:23] offset:1024 nt
    v_mfma_f32_16x16x32_bf16 v[12:15], a[124:127], a[28:31], v[100:103]
    ds_read_b64_tr_b16 a[98:99], v124 offset:8192
    v_mfma_f32_16x16x32_bf16 v[12:15], a[120:123], a[24:27], v[12:15]
    ds_read_b64_tr_b16 a[100:101], v125
    v_cvt_pk_bf16_f32 v71, v46, v47
    v_mfma_f32_16x16x32_bf16 v[12:15], a[116:119], a[20:23], v[12:15]
    v_mfma_f32_16x16x32_bf16 v[12:15], a[112:115], a[16:19], v[12:15]
    ds_read_b64_tr_b16 a[102:103], v125 offset:8192
    v_mfma_f32_16x16x32_bf16 v[20:23], a[112:115], a[32:35], v[104:107]
    global_load_lds_dwordx4 v132, s[16:17] nt
    v_mfma_f32_16x16x32_bf16 v[20:23], a[116:119], a[36:39], v[20:23]
    v_exp_f32 v17, v17
    v_mfma_f32_16x16x32_bf16 v[20:23], a[120:123], a[40:43], v[20:23]
    v_exp_f32 v10, v10
    v_mfma_f32_16x16x32_bf16 v[20:23], a[124:127], a[44:47], v[20:23]
    v_exp_f32 v3, v3
    v_mfma_f32_16x16x32_bf16 v[28:31], a[124:127], a[60:63], v[108:111]
    ds_read_b64_tr_b16 a[104:105], v126
L_pad9:
    s_cbranch_vccz L_padret2
    v_mfma_f32_16x16x32_bf16 v[28:31], a[120:123], a[56:59], v[28:31]
    global_load_lds_dwordx4 v132, s[22:23] offset:3072 nt
    v_mfma_f32_16x16x32_bf16 v[28:31], a[116:119], a[52:55], v[28:31]
    v_exp_f32 v27, v27
    v_mfma_f32_16x16x32_bf16 v[28:31], a[112:115], a[48:51], v[28:31]
    v_exp_f32 v8, v8
    v_mfma_f32_16x16x32_bf16 v[36:39], a[112:115], a[64:67], v[112:115]
    v_exp_f32 v11, v11
    v_mfma_f32_16x16x32_bf16 v[36:39], a[116:119], a[68:71], v[36:39]
    ds_read_b64_tr_b16 a[106:107], v126 offset:8192
    s_waitcnt lgkmcnt(2)
    v_mfma_f32_16x16x32_bf16 v[36:39], a[120:123], a[72:75], v[36:39]
    global_load_lds_dwordx4 v132, s[16:17] offset:2048 nt
    v_mfma_f32_16x16x32_bf16 v[36:39], a[124:127], a[76:79], v[36:39]
    ds_read_b64_tr_b16 a[108:109], v127
    v_cvt_pk_bf16_f32 v73, v2, v3
    v_mfma_f32_16x16x32_bf16 v[44:47], a[124:127], a[92:95], v[116:119]
    v_exp_f32 v26, v26
    v_mfma_f32_16x16x32_bf16 v[44:47], a[120:123], a[88:91], v[44:47]
    v_exp_f32 v16, v16
    v_mfma_f32_16x16x32_bf16 v[44:47], a[116:119], a[84:87], v[44:47]
    v_exp_f32 v32, v32
    v_mfma_f32_16x16x32_bf16 v[44:47], a[112:115], a[80:83], v[44:47]
    ds_read_b64_tr_b16 a[110:111], v127 offset:8192
    v_add_u32 v132, 8192, v132
    v_mfma_f32_16x16x32_bf16 v[144:147], v[48:51], a[96:99], v[144:147]
    ds_read_b64_tr_b16 a[112:113], v128
    v_mfma_f32_16x16x32_bf16 a[128:131], v[48:51], a[136:139], a[128:131]
    ds_read_b64_tr_b16 a[114:115], v128 offset:8192
    v_mfma_f32_16x16x32_bf16 v[148:151], v[48:51], a[100:103], v[148:151]
    v_exp_f32 v18, v18
    v_mfma_f32_16x16x32_bf16 v[180:183], v[52:55], a[100:103], v[180:183]
    v_exp_f32 v34, v34
    v_mfma_f32_16x16x32_bf16 a[128:131], v[52:55], a[140:143], a[128:131]
    ds_read_b64_tr_b16 a[116:117], v129
    v_add_u32 v141, 256, v141
    v_mfma_f32_16x16x32_bf16 v[176:179], v[52:55], a[96:99], v[176:179]
    ds_read_b64_tr_b16 a[118:119], v129 offset:8192
    v_mfma_f32_16x16x32_bf16 v[208:211], v[56:59], a[96:99], v[208:211]
    ds_read_b64_tr_b16 a[120:121], v130
    v_cvt_pk_bf16_f32 v80, v16, v17
    v_mfma_f32_16x16x32_bf16 v[212:215], v[56:59], a[100:103], v[212:215]
    v_exp_f32 v33, v33
    v_mfma_f32_16x16x32_bf16 v[244:247], v[60:63], a[100:103], v[244:247]
    v_exp_f32 v35, v35
    v_mfma_f32_16x16x32_bf16 v[240:243], v[60:63], a[96:99], v[240:243]
    ds_read_b64_tr_b16 a[122:123], v130 offset:8192
    v_cvt_pk_bf16_f32 v72, v0, v1
    v_mfma_f32_16x16x32_bf16 a[192:195], v[64:67], a[96:99], a[192:195]
    v_exp_f32 v24, v24
    v_mfma_f32_16x16x32_bf16 a[196:199], v[64:67], a[100:103], a[196:199]
    ds_read_b64_tr_b16 a[124:125], v131
    s_waitcnt lgkmcnt(7)
    v_mfma_f32_16x16x32_bf16 a[228:231], v[68:71], a[100:103], a[228:231]
    buffer_store_dwordx4 a[148:151], v135, s[24:27], s32 offen sc1
    v_mfma_f32_16x16x32_bf16 a[224:227], v[68:71], a[96:99], a[224:227]
    v_exp_f32 v42, v42
    v_mfma_f32_16x16x32_bf16 a[232:235], v[68:71], a[104:107], a[232:235]
    v_cvt_pk_bf16_f32 v77, v10, v11
    v_cvt_pk_bf16_f32 v85, v26, v27
    v_mfma_f32_16x16x32_bf16 a[132:135], v[68:71], a[144:147], a[132:135]
    v_exp_f32 v43, v43
    v_mfma_f32_16x16x32_bf16 a[236:239], v[68:71], a[108:111], a[236:239]
    v_exp_f32 v40, v40
    v_mfma_f32_16x16x32_bf16 a[204:207], v[64:67], a[108:111], a[204:207]
    v_exp_f32 v19, v19
    v_mfma_f32_16x16x32_bf16 a[132:135], v[64:67], a[140:143], a[132:135]
    ds_read_b64_tr_b16 a[126:127], v131 offset:8192
    v_cvt_pk_bf16_f32 v81, v18, v19
    v_mfma_f32_16x16x32_bf16 a[200:203], v[64:67], a[104:107], a[200:203]
    v_exp_f32 v4, v4
    v_mfma_f32_16x16x32_bf16 v[248:251], v[60:63], a[104:107], v[248:251]
    v_exp_f32 v7, v7
    v_mfma_f32_16x16x32_bf16 v[252:255], v[60:63], a[108:111], v[252:255]
    v_exp_f32 v13, v13
    v_mfma_f32_16x16x32_bf16 v[220:223], v[56:59], a[108:111], v[220:223]
    v_exp_f32 v22, v22
    v_mfma_f32_16x16x32_bf16 v[216:219], v[56:59], a[104:107], v[216:219]
    v_exp_f32 v5, v5
    v_mfma_f32_16x16x32_bf16 v[184:187], v[52:55], a[104:107], v[184:187]
    v_exp_f32 v25, v25
    v_mfma_f32_16x16x32_bf16 v[188:191], v[52:55], a[108:111], v[188:191]
    v_cvt_pk_bf16_f32 v74, v4, v5
    v_mfma_f32_16x16x32_bf16 v[156:159], v[48:51], a[108:111], v[156:159]
    v_exp_f32 v6, v6
    v_mfma_f32_16x16x32_bf16 v[152:155], v[48:51], a[104:107], v[152:155]
    s_waitcnt lgkmcnt(0)
    v_mfma_f32_16x16x32_bf16 v[160:163], v[48:51], a[112:115], v[160:163]
    v_exp_f32 v41, v41
    v_mfma_f32_16x16x32_bf16 v[164:167], v[48:51], a[116:119], v[164:167]
    v_exp_f32 v29, v29
    v_mfma_f32_16x16x32_bf16 v[196:199], v[52:55], a[116:119], v[196:199]
    v_exp_f32 v23, v23
    v_mfma_f32_16x16x32_bf16 v[192:195], v[52:55], a[112:115], v[192:195]
    ds_read_b128 a[96:99], v120
    v_mfma_f32_16x16x32_bf16 v[224:227], v[56:59], a[112:115], v[224:227]
    buffer_store_dwordx4 a[152:155], v135, s[24:27], s32 offen offset:1024 sc1
    v_mfma_f32_16x16x32_bf16 a[128:131], v[56:59], a[144:147], a[128:131]
    ds_read_b128 a[100:103], v121
    v_mfma_f32_16x16x32_bf16 v[228:231], v[56:59], a[116:119], v[228:231]
    v_exp_f32 v15, v15
    v_mfma_f32_16x16x32_bf16 a[180:183], v[60:63], a[116:119], a[180:183]
    s_add_u32 s32, s32, 2048
    v_cvt_pk_bf16_f32 v83, v22, v23
    v_mfma_f32_16x16x32_bf16 a[176:179], v[60:63], a[112:115], a[176:179]
    ds_read_b128 a[104:107], v122
    v_cvt_pk_bf16_f32 v92, v40, v41
    v_mfma_f32_16x16x32_bf16 a[208:211], v[64:67], a[112:115], a[208:211]
    v_mfma_f32_16x16x32_bf16 a[212:215], v[64:67], a[116:119], a[212:215]
    v_exp_f32 v28, v28
    v_mfma_f32_16x16x32_bf16 a[244:247], v[68:71], a[116:119], a[244:247]
    v_exp_f32 v21, v21
    v_mfma_f32_16x16x32_bf16 a[240:243], v[68:71], a[112:115], a[240:243]
    ds_read_b128 a[108:111], v123
    v_cvt_pk_bf16_f32 v76, v8, v9
    v_mfma_f32_16x16x32_bf16 a[248:251], v[68:71], a[120:123], a[248:251]
    v_cvt_pk_bf16_f32 v84, v24, v25
    v_mfma_f32_16x16x32_bf16 a[252:255], v[68:71], a[124:127], a[252:255]
    v_cvt_pk_bf16_f32 v88, v32, v33
    v_cvt_pk_bf16_f32 v93, v42, v43
    v_mfma_f32_16x16x32_bf16 a[220:223], v[64:67], a[124:127], a[220:223]
    v_exp_f32 v14, v14
    v_mfma_f32_16x16x32_bf16 a[216:219], v[64:67], a[120:123], a[216:219]
    v_exp_f32 v20, v20
    v_mfma_f32_16x16x32_bf16 a[184:187], v[60:63], a[120:123], a[184:187]
    v_exp_f32 v31, v31
    v_mfma_f32_16x16x32_bf16 a[132:135], v[60:63], a[136:139], a[132:135]
    v_cvt_pk_bf16_f32 v75, v6, v7
    v_cvt_pk_bf16_f32 v79, v14, v15
    v_mfma_f32_16x16x32_bf16 a[188:191], v[60:63], a[124:127], a[188:191]
    v_exp_f32 v30, v30
    v_mfma_f32_16x16x32_bf16 v[236:239], v[56:59], a[124:127], v[236:239]
    v_exp_f32 v12, v12
    v_mfma_f32_16x16x32_bf16 v[232:235], v[56:59], a[120:123], v[232:235]
    s_waitcnt lgkmcnt(0)
    v_mfma_f32_16x16x32_bf16 v[200:203], v[52:55], a[120:123], v[200:203]
    v_cvt_pk_bf16_f32 v82, v20, v21
    v_cvt_pk_bf16_f32 v87, v30, v31
    v_mfma_f32_16x16x32_bf16 v[204:207], v[52:55], a[124:127], v[204:207]
    v_cvt_pk_bf16_f32 v89, v34, v35
    v_mfma_f32_16x16x32_bf16 v[172:175], v[48:51], a[124:127], v[172:175]
    v_cvt_pk_bf16_f32 v78, v12, v13
    v_cvt_pk_bf16_f32 v86, v28, v29
    v_mfma_f32_16x16x32_bf16 v[168:171], v[48:51], a[120:123], v[168:171]
    s_sub_u32 s3, s3, 1
    s_cbranch_scc0 L_M
    v_mfma_f32_16x16x32_bf16 v[0:3], a[96:99], a[0:3], v[96:99]
    v_subrev_u32 v141, 512, v141
    v_mfma_f32_16x16x32_bf16 v[0:3], a[100:103], a[4:7], v[0:3]
    ds_read_b128 a[112:115], v120 offset:8192
    v_mfma_f32_16x16x32_bf16 v[0:3], a[104:107], a[8:11], v[0:3]
    v_exp_f32 v47, v47
    v_mfma_f32_16x16x32_bf16 v[0:3], a[108:111], a[12:15], v[0:3]
    v_exp_f32 v37, v37
    v_mfma_f32_16x16x32_bf16 v[8:11], a[108:111], a[28:31], v[100:103]
    v_exp_f32 v46, v46
    v_mfma_f32_16x16x32_bf16 v[8:11], a[104:107], a[24:27], v[8:11]
    v_exp_f32 v44, v44
    v_mfma_f32_16x16x32_bf16 v[8:11], a[100:103], a[20:23], v[8:11]
    ds_read_b128 a[116:119], v121 offset:8192
    v_mfma_f32_16x16x32_bf16 v[8:11], a[96:99], a[16:19], v[8:11]
    v_mfma_f32_16x16x32_bf16 v[16:19], a[96:99], a[32:35], v[104:107]
    v_exp_f32 v36, v36
    v_mfma_f32_16x16x32_bf16 v[16:19], a[100:103], a[36:39], v[16:19]
    v_exp_f32 v45, v45
    v_mfma_f32_16x16x32_bf16 v[16:19], a[104:107], a[40:43], v[16:19]
    v_exp_f32 v38, v38
    v_mfma_f32_16x16x32_bf16 v[16:19], a[108:111], a[44:47], v[16:19]
    ds_read_b128 a[120:123], v122 offset:8192
    v_mfma_f32_16x16x32_bf16 v[24:27], a[108:111], a[60:63], v[108:111]
    v_exp_f32 v3, v3
    v_mfma_f32_16x16x32_bf16 v[24:27], a[104:107], a[56:59], v[24:27]
    ds_read_b128 a[124:127], v123 offset:8192
    v_mfma_f32_16x16x32_bf16 v[24:27], a[100:103], a[52:55], v[24:27]
    v_exp_f32 v0, v0
    v_mfma_f32_16x16x32_bf16 v[24:27], a[96:99], a[48:51], v[24:27]
    v_cvt_pk_bf16_f32 v95, v46, v47
    v_mfma_f32_16x16x32_bf16 v[32:35], a[96:99], a[64:67], v[112:115]
    v_cvt_pk_bf16_f32 v90, v36, v37
    v_mfma_f32_16x16x32_bf16 v[32:35], a[100:103], a[68:71], v[32:35]
    v_mfma_f32_16x16x32_bf16 v[32:35], a[104:107], a[72:75], v[32:35]
    v_exp_f32 v2, v2
    v_mfma_f32_16x16x32_bf16 v[32:35], a[108:111], a[76:79], v[32:35]
    v_exp_f32 v1, v1
    v_mfma_f32_16x16x32_bf16 v[40:43], a[108:111], a[92:95], v[116:119]
    v_mfma_f32_16x16x32_bf16 v[40:43], a[104:107], a[88:91], v[40:43]
    v_exp_f32 v39, v39
    v_mfma_f32_16x16x32_bf16 v[40:43], a[100:103], a[84:87], v[40:43]
    v_mfma_f32_16x16x32_bf16 v[40:43], a[96:99], a[80:83], v[40:43]
    s_waitcnt vmcnt(10) lgkmcnt(0)
    s_barrier
    v_mfma_f32_16x16x32_bf16 v[4:7], a[112:115], a[0:3], v[96:99]
    ds_read_b64_tr_b16 a[96:97], v124 offset:16384
    v_mfma_f32_16x16x32_bf16 v[4:7], a[116:119], a[4:7], v[4:7]
    ds_read_b64_tr_b16 a[98:99], v124 offset:24576
    s_add_u32 m0, s30, 0
    v_mfma_f32_16x16x32_bf16 v[4:7], a[120:123], a[8:11], v[4:7]
    v_mfma_f32_16x16x32_bf16 v[4:7], a[124:127], a[12:15], v[4:7]
    global_load_lds_dwordx4 v132, s[22:23] offset:1024 nt
    v_mfma_f32_16x16x32_bf16 v[12:15], a[124:127], a[28:31], v[100:103]
    v_cvt_pk_bf16_f32 v91, v38, v39
    v_cvt_pk_bf16_f32 v94, v44, v45
    v_mfma_f32_16x16x32_bf16 v[12:15], a[120:123], a[24:27], v[12:15]
    v_exp_f32 v8, v8
    v_mfma_f32_16x16x32_bf16 v[12:15], a[116:119], a[20:23], v[12:15]
    v_exp_f32 v9, v9
    v_mfma_f32_16x16x32_bf16 v[12:15], a[112:115], a[16:19], v[12:15]
    ds_read_b64_tr_b16 a[100:101], v125 offset:16384
    v_mfma_f32_16x16x32_bf16 v[20:23], a[112:115], a[32:35], v[104:107]
    global_load_lds_dwordx4 v132, s[16:17] nt
    v_mfma_f32_16x16x32_bf16 v[20:23], a[116:119], a[36:39], v[20:23]
    v_exp_f32 v10, v10
    v_mfma_f32_16x16x32_bf16 v[20:23], a[120:123], a[40:43], v[20:23]
    v_exp_f32 v11, v11
    v_mfma_f32_16x16x32_bf16 v[20:23], a[124:127], a[44:47], v[20:23]
    v_exp_f32 v25, v25
    v_mfma_f32_16x16x32_bf16 v[28:31], a[124:127], a[60:63], v[108:111]
    ds_read_b64_tr_b16 a[102:103], v125 offset:24576
    v_mfma_f32_16x16x32_bf16 v[28:31], a[120:123], a[56:59], v[28:31]
    global_load_lds_dwordx4 v132, s[22:23] offset:3072 nt
    v_mfma_f32_16x16x32_bf16 v[28:31], a[116:119], a[52:55], v[28:31]
    v_exp_f32 v16, v16
    v_mfma_f32_16x16x32_bf16 v[28:31], a[112:115], a[48:51], v[28:31]
    ds_read_b64_tr_b16 a[104:105], v126 offset:16384
    v_mfma_f32_16x16x32_bf16 v[36:39], a[112:115], a[64:67], v[112:115]
    v_cvt_pk_bf16_f32 v52, v8, v9
    v_mfma_f32_16x16x32_bf16 v[36:39], a[116:119], a[68:71], v[36:39]
    ds_read_b64_tr_b16 a[106:107], v126 offset:24576
    v_mfma_f32_16x16x32_bf16 v[36:39], a[120:123], a[72:75], v[36:39]
    global_load_lds_dwordx4 v132, s[16:17] offset:2048 nt
    v_mfma_f32_16x16x32_bf16 v[36:39], a[124:127], a[76:79], v[36:39]
    v_exp_f32 v18, v18
    v_mfma_f32_16x16x32_bf16 v[44:47], a[124:127], a[92:95], v[116:119]
    v_exp_f32 v33, v33
    v_mfma_f32_16x16x32_bf16 v[44:47], a[120:123], a[88:91], v[44:47]
    v_exp_f32 v17, v17
    v_mfma_f32_16x16x32_bf16 v[44:47], a[116:119], a[84:87], v[44:47]
    ds_read_b64_tr_b16 a[108:109], v127 offset:16384
    s_waitcnt lgkmcnt(3)
    v_mfma_f32_16x16x32_bf16 v[44:47], a[112:115], a[80:83], v[44:47]
    v_exp_f32 v27, v27
    v_mfma_f32_16x16x32_bf16 v[144:147], v[72:75], a[96:99], v[144:147]
    ds_read_b64_tr_b16 a[110:111], v127 offset:24576
    v_cvt_pk_bf16_f32 v48, v0, v1
    v_mfma_f32_16x16x32_bf16 a[128:131], v[72:75], a[136:139], a[128:131]
    v_exp_f32 v6, v6
    v_mfma_f32_16x16x32_bf16 v[148:151], v[72:75], a[100:103], v[148:151]
    ds_read_b64_tr_b16 a[112:113], v128 offset:16384
    v_mfma_f32_16x16x32_bf16 v[180:183], v[76:79], a[100:103], v[180:183]
    v_cvt_pk_bf16_f32 v49, v2, v3
    v_cvt_pk_bf16_f32 v53, v10, v11
    v_mfma_f32_16x16x32_bf16 a[128:131], v[76:79], a[140:143], a[128:131]
    v_exp_f32 v19, v19
    v_mfma_f32_16x16x32_bf16 v[176:179], v[76:79], a[96:99], v[176:179]
    v_exp_f32 v41, v41
    v_mfma_f32_16x16x32_bf16 v[208:211], v[80:83], a[96:99], v[208:211]
    ds_read_b64_tr_b16 a[114:115], v128 offset:24576
    v_cvt_pk_bf16_f32 v57, v18, v19
    v_mfma_f32_16x16x32_bf16 v[212:215], v[80:83], a[100:103], v[212:215]
    v_exp_f32 v42, v42
    v_mfma_f32_16x16x32_bf16 v[244:247], v[84:87], a[100:103], v[244:247]
    ds_read_b64_tr_b16 a[116:117], v129 offset:16384
    v_mfma_f32_16x16x32_bf16 v[240:243], v[84:87], a[96:99], v[240:243]
    ds_read_b64_tr_b16 a[118:119], v129 offset:24576
    v_mfma_f32_16x16x32_bf16 a[192:195], v[88:91], a[96:99], a[192:195]
    ds_read_b64_tr_b16 a[120:121], v130 offset:16384
    v_mfma_f32_16x16x32_bf16 a[196:199], v[88:91], a[100:103], a[196:199]
    v_add_u32 v132, 8192, v132
    v_mfma_f32_16x16x32_bf16 a[228:231], v[92:95], a[100:103], a[228:231]
    v_exp_f32 v32, v32
    v_mfma_f32_16x16x32_bf16 a[224:227], v[92:95], a[96:99], a[224:227]
    ds_read_b64_tr_b16 a[122:123], v130 offset:24576
    s_waitcnt lgkmcnt(6)
    v_mfma_f32_16x16x32_bf16 a[232:235], v[92:95], a[104:107], a[232:235]
    ds_read_b64_tr_b16 a[124:125], v131 offset:16384
    v_mfma_f32_16x16x32_bf16 a[132:135], v[92:95], a[144:147], a[132:135]
    v_exp_f32 v24, v24
    v_mfma_f32_16x16x32_bf16 a[236:239], v[92:95], a[108:111], a[236:239]
    ds_read_b64_tr_b16 a[126:127], v131 offset:24576
    v_mfma_f32_16x16x32_bf16 a[204:207], v[88:91], a[108:111], a[204:207]
    v_cvt_pk_bf16_f32 v56, v16, v17
    v_mfma_f32_16x16x32_bf16 a[132:135], v[88:91], a[140:143], a[132:135]
    v_exp_f32 v34, v34
    v_mfma_f32_16x16x32_bf16 a[200:203], v[88:91], a[104:107], a[200:203]
    v_exp_f32 v35, v35
    v_mfma_f32_16x16x32_bf16 v[248:251], v[84:87], a[104:107], v[248:251]
    v_cvt_pk_bf16_f32 v60, v24, v25
    v_mfma_f32_16x16x32_bf16 v[252:255], v[84:87], a[108:111], v[252:255]
    v_exp_f32 v12, v12
    v_mfma_f32_16x16x32_bf16 v[220:223], v[80:83], a[108:111], v[220:223]
    v_exp_f32 v20, v20
    v_mfma_f32_16x16x32_bf16 v[216:219], v[80:83], a[104:107], v[216:219]
    v_exp_f32 v43, v43
    v_mfma_f32_16x16x32_bf16 v[184:187], v[76:79], a[104:107], v[184:187]
    v_exp_f32 v5, v5
    v_mfma_f32_16x16x32_bf16 v[188:191], v[76:79], a[108:111], v[188:191]
    v_exp_f32 v26, v26
    v_mfma_f32_16x16x32_bf16 v[156:159], v[72:75], a[108:111], v[156:159]
    s_waitcnt lgkmcnt(0)
    v_cvt_pk_bf16_f32 v65, v34, v35
    v_mfma_f32_16x16x32_bf16 v[152:155], v[72:75], a[104:107], v[152:155]
    v_cvt_pk_bf16_f32 v64, v32, v33
    v_mfma_f32_16x16x32_bf16 v[160:163], v[72:75], a[112:115], v[160:163]
    v_exp_f32 v4, v4
    v_mfma_f32_16x16x32_bf16 v[164:167], v[72:75], a[116:119], v[164:167]
    v_exp_f32 v14, v14
    v_mfma_f32_16x16x32_bf16 v[196:199], v[76:79], a[116:119], v[196:199]
    ds_read_b128 a[96:99], v120 offset:16384
    v_cvt_pk_bf16_f32 v61, v26, v27
    v_mfma_f32_16x16x32_bf16 v[192:195], v[76:79], a[112:115], v[192:195]
    v_exp_f32 v28, v28
    v_mfma_f32_16x16x32_bf16 v[224:227], v[80:83], a[112:115], v[224:227]
    v_exp_f32 v15, v15
    v_mfma_f32_16x16x32_bf16 a[128:131], v[80:83], a[144:147], a[128:131]
    v_exp_f32 v13, v13
    v_mfma_f32_16x16x32_bf16 v[228:231], v[80:83], a[116:119], v[228:231]
    v_exp_f32 v7, v7
    v_mfma_f32_16x16x32_bf16 a[180:183], v[84:87], a[116:119], a[180:183]
    ds_read_b128 a[100:103], v121 offset:16384
    v_mfma_f32_16x16x32_bf16 a[176:179], v[84:87], a[112:115], a[176:179]
    v_mfma_f32_16x16x32_bf16 a[208:211], v[88:91], a[112:115], a[208:211]
    v_exp_f32 v40, v40
    v_mfma_f32_16x16x32_bf16 a[212:215], v[88:91], a[116:119], a[212:215]
    ds_read_b128 a[104:107], v122 offset:16384
    v_cvt_pk_bf16_f32 v69, v42, v43
    v_mfma_f32_16x16x32_bf16 a[244:247], v[92:95], a[116:119], a[244:247]
    v_mfma_f32_16x16x32_bf16 a[240:243], v[92:95], a[112:115], a[240:243]
    ds_read_b128 a[108:111], v123 offset:16384
    v_mfma_f32_16x16x32_bf16 a[248:251], v[92:95], a[120:123], a[248:251]
    v_exp_f32 v22, v22
    v_mfma_f32_16x16x32_bf16 a[252:255], v[92:95], a[124:127], a[252:255]
    v_exp_f32 v30, v30
    v_mfma_f32_16x16x32_bf16 a[220:223], v[88:91], a[124:127], a[220:223]
    v_exp_f32 v29, v29
    v_mfma_f32_16x16x32_bf16 a[216:219], v[88:91], a[120:123], a[216:219]
    v_cvt_pk_bf16_f32 v68, v40, v41
    v_cvt_pk_bf16_f32 v55, v14, v15
    v_mfma_f32_16x16x32_bf16 a[184:187], v[84:87], a[120:123], a[184:187]
    v_exp_f32 v31, v31
    v_mfma_f32_16x16x32_bf16 a[132:135], v[84:87], a[136:139], a[132:135]
    v_exp_f32 v21, v21
    v_mfma_f32_16x16x32_bf16 a[188:191], v[84:87], a[124:127], a[188:191]
    v_cvt_pk_bf16_f32 v51, v6, v7
    v_cvt_pk_bf16_f32 v58, v20, v21
    v_mfma_f32_16x16x32_bf16 v[236:239], v[80:83], a[124:127], v[236:239]
    v_exp_f32 v23, v23
    v_mfma_f32_16x16x32_bf16 v[232:235], v[80:83], a[120:123], v[232:235]
    v_mfma_f32_16x16x32_bf16 v[200:203], v[76:79], a[120:123], v[200:203]
    v_cvt_pk_bf16_f32 v50, v4, v5
    v_cvt_pk_bf16_f32 v59, v22, v23
    v_mfma_f32_16x16x32_bf16 v[204:207], v[76:79], a[124:127], v[204:207]
    v_cvt_pk_bf16_f32 v62, v28, v29
    v_cvt_pk_bf16_f32 v63, v30, v31
    v_mfma_f32_16x16x32_bf16 v[172:175], v[72:75], a[124:127], v[172:175]
    s_waitcnt lgkmcnt(0)
    v_cvt_pk_bf16_f32 v54, v12, v13
    v_mfma_f32_16x16x32_bf16 v[168:171], v[72:75], a[120:123], v[168:171]
    v_mfma_f32_16x16x32_bf16 v[0:3], a[96:99], a[0:3], v[96:99]
    v_exp_f32 v44, v44
    v_mfma_f32_16x16x32_bf16 v[0:3], a[100:103], a[4:7], v[0:3]
    ds_read_b128 a[112:115], v120 offset:24576
    v_mfma_f32_16x16x32_bf16 v[0:3], a[104:107], a[8:11], v[0:3]
    v_mfma_f32_16x16x32_bf16 v[0:3], a[108:111], a[12:15], v[0:3]
    v_mfma_f32_16x16x32_bf16 v[8:11], a[108:111], a[28:31], v[100:103]
    v_mfma_f32_16x16x32_bf16 v[8:11], a[104:107], a[24:27], v[8:11]
    v_exp_f32 v36, v36
    v_mfma_f32_16x16x32_bf16 v[8:11], a[100:103], a[20:23], v[8:11]
    ds_read_b128 a[116:119], v121 offset:24576
    v_mfma_f32_16x16x32_bf16 v[8:11], a[96:99], a[16:19], v[8:11]
    v_exp_f32 v46, v46
    v_mfma_f32_16x16x32_bf16 v[16:19], a[96:99], a[32:35], v[104:107]
    v_exp_f32 v38, v38
    v_mfma_f32_16x16x32_bf16 v[16:19], a[100:103], a[36:39], v[16:19]
    v_exp_f32 v39, v39
    v_mfma_f32_16x16x32_bf16 v[16:19], a[104:107], a[40:43], v[16:19]
    v_exp_f32 v3, v3
    v_mfma_f32_16x16x32_bf16 v[16:19], a[108:111], a[44:47], v[16:19]
    ds_read_b128 a[120:123], v122 offset:24576
    v_mfma_f32_16x16x32_bf16 v[24:27], a[108:111], a[60:63], v[108:111]
    v_mfma_f32_16x16x32_bf16 v[24:27], a[104:107], a[56:59], v[24:27]
    ds_read_b128 a[124:127], v123 offset:24576
    v_mfma_f32_16x16x32_bf16 v[24:27], a[100:103], a[52:55], v[24:27]
    v_exp_f32 v1, v1
    v_mfma_f32_16x16x32_bf16 v[24:27], a[96:99], a[48:51], v[24:27]
    v_mfma_f32_16x16x32_bf16 v[32:35], a[96:99], a[64:67], v[112:115]
    v_exp_f32 v37, v37
    v_mfma_f32_16x16x32_bf16 v[32:35], a[100:103], a[68:71], v[32:35]
    v_cvt_pk_bf16_f32 v66, v36, v37
    v_mfma_f32_16x16x32_bf16 v[32:35], a[104:107], a[72:75], v[32:35]
    v_cvt_pk_bf16_f32 v67, v38, v39
    v_mfma_f32_16x16x32_bf16 v[32:35], a[108:111], a[76:79], v[32:35]
    v_mfma_f32_16x16x32_bf16 v[40:43], a[108:111], a[92:95], v[116:119]
    v_exp_f32 v0, v0
    v_mfma_f32_16x16x32_bf16 v[40:43], a[104:107], a[88:91], v[40:43]
    v_exp_f32 v2, v2
    v_mfma_f32_16x16x32_bf16 v[40:43], a[100:103], a[84:87], v[40:43]
    v_exp_f32 v45, v45
    v_mfma_f32_16x16x32_bf16 v[40:43], a[96:99], a[80:83], v[40:43]
    s_waitcnt vmcnt(10) lgkmcnt(0)
    s_barrier
    v_mfma_f32_16x16x32_bf16 v[4:7], a[112:115], a[0:3], v[96:99]
    v_exp_f32 v47, v47
    v_mfma_f32_16x16x32_bf16 v[4:7], a[116:119], a[4:7], v[4:7]
    s_add_u32 m0, s30, 16384
    v_cvt_pk_bf16_f32 v70, v44, v45
    v_mfma_f32_16x16x32_bf16 v[4:7], a[120:123], a[8:11], v[4:7]
    ds_read_b64_tr_b16 a[96:97], v124 offset:32768
    v_mfma_f32_16x16x32_bf16 v[4:7], a[124:127], a[12:15], v[4:7]
    global_load_lds_dwordx4 v132, s[22:23] offset:1024 nt
    v_mfma_f32_16x16x32_bf16 v[12:15], a[124:127], a[28:31], v[100:103]
    v_cvt_pk_bf16_f32 v71, v46, v47
    v_mfma_f32_16x16x32_bf16 v[12:15], a[120:123], a[24:27], v[12:15]
    v_exp_f32 v8, v8
    v_mfma_f32_16x16x32_bf16 v[12:15], a[116:119], a[20:23], v[12:15]
    v_mfma_f32_16x16x32_bf16 v[12:15], a[112:115], a[16:19], v[12:15]
    ds_read_b64_tr_b16 a[98:99], v124 offset:40960
    v_mfma_f32_16x16x32_bf16 v[20:23], a[112:115], a[32:35], v[104:107]
    global_load_lds_dwordx4 v132, s[16:17] nt
    v_mfma_f32_16x16x32_bf16 v[20:23], a[116:119], a[36:39], v[20:23]
    v_exp_f32 v11, v11
    v_mfma_f32_16x16x32_bf16 v[20:23], a[120:123], a[40:43], v[20:23]
    v_exp_f32 v9, v9
    v_mfma_f32_16x16x32_bf16 v[20:23], a[124:127], a[44:47], v[20:23]
    ds_read_b64_tr_b16 a[100:101], v125 offset:32768
    v_mfma_f32_16x16x32_bf16 v[28:31], a[124:127], a[60:63], v[108:111]
    ds_read_b64_tr_b16 a[102:103], v125 offset:40960
    v_mfma_f32_16x16x32_bf16 v[28:31], a[120:123], a[56:59], v[28:31]
    global_load_lds_dwordx4 v132, s[22:23] offset:3072 nt
    v_mfma_f32_16x16x32_bf16 v[28:31], a[116:119], a[52:55], v[28:31]
    v_exp_f32 v10, v10
    v_mfma_f32_16x16x32_bf16 v[28:31], a[112:115], a[48:51], v[28:31]
    ds_read_b64_tr_b16 a[104:105], v126 offset:32768
    v_cvt_pk_bf16_f32 v77, v10, v11
    v_mfma_f32_16x16x32_bf16 v[36:39], a[112:115], a[64:67], v[112:115]
    v_mfma_f32_16x16x32_bf16 v[36:39], a[116:119], a[68:71], v[36:39]
    ds_read_b64_tr_b16 a[106:107], v126 offset:40960
    v_mfma_f32_16x16x32_bf16 v[36:39], a[120:123], a[72:75], v[36:39]
    global_load_lds_dwordx4 v132, s[16:17] offset:2048 nt
    v_mfma_f32_16x16x32_bf16 v[36:39], a[124:127], a[76:79], v[36:39]
    ds_read_b64_tr_b16 a[108:109], v127 offset:32768
    v_mfma_f32_16x16x32_bf16 v[44:47], a[124:127], a[92:95], v[116:119]
    ds_read_b64_tr_b16 a[110:111], v127 offset:40960
    v_cvt_pk_bf16_f32 v76, v8, v9
    v_mfma_f32_16x16x32_bf16 v[44:47], a[120:123], a[88:91], v[44:47]
    s_waitcnt lgkmcnt(4)
    v_cvt_pk_bf16_f32 v72, v0, v1
    v_mfma_f32_16x16x32_bf16 v[44:47], a[116:119], a[84:87], v[44:47]
    v_exp_f32 v17, v17
    v_mfma_f32_16x16x32_bf16 v[44:47], a[112:115], a[80:83], v[44:47]
    v_exp_f32 v27, v27
    v_mfma_f32_16x16x32_bf16 v[144:147], v[48:51], a[96:99], v[144:147]
    ds_read_b64_tr_b16 a[112:113], v128 offset:32768
    v_mfma_f32_16x16x32_bf16 a[128:131], v[48:51], a[136:139], a[128:131]
    v_exp_f32 v16, v16
    v_mfma_f32_16x16x32_bf16 v[148:151], v[48:51], a[100:103], v[148:151]
    v_exp_f32 v18, v18
    v_mfma_f32_16x16x32_bf16 v[180:183], v[52:55], a[100:103], v[180:183]
    v_exp_f32 v19, v19
    v_mfma_f32_16x16x32_bf16 a[128:131], v[52:55], a[140:143], a[128:131]
    ds_read_b64_tr_b16 a[114:115], v128 offset:40960
    s_waitcnt lgkmcnt(2)
    v_mfma_f32_16x16x32_bf16 v[176:179], v[52:55], a[96:99], v[176:179]
    v_exp_f32 v24, v24
    v_mfma_f32_16x16x32_bf16 v[208:211], v[56:59], a[96:99], v[208:211]
    v_exp_f32 v26, v26
    v_mfma_f32_16x16x32_bf16 v[212:215], v[56:59], a[100:103], v[212:215]
    v_exp_f32 v33, v33
    v_mfma_f32_16x16x32_bf16 v[244:247], v[60:63], a[100:103], v[244:247]
    v_exp_f32 v41, v41
    v_mfma_f32_16x16x32_bf16 v[240:243], v[60:63], a[96:99], v[240:243]
    ds_read_b64_tr_b16 a[116:117], v129 offset:32768
    v_mfma_f32_16x16x32_bf16 a[192:195], v[64:67], a[96:99], a[192:195]
    v_exp_f32 v35, v35
    v_mfma_f32_16x16x32_bf16 a[196:199], v[64:67], a[100:103], a[196:199]
    v_exp_f32 v25, v25
    v_mfma_f32_16x16x32_bf16 a[228:231], v[68:71], a[100:103], a[228:231]
    ds_read_b64_tr_b16 a[118:119], v129 offset:40960
    v_cvt_pk_bf16_f32 v73, v2, v3
    v_mfma_f32_16x16x32_bf16 a[224:227], v[68:71], a[96:99], a[224:227]
    ds_read_b64_tr_b16 a[120:121], v130 offset:32768
    v_cvt_pk_bf16_f32 v84, v24, v25
    v_mfma_f32_16x16x32_bf16 a[232:235], v[68:71], a[104:107], a[232:235]
    ds_read_b64_tr_b16 a[122:123], v130 offset:40960
    v_add_u32 v132, 8192, v132
    v_mfma_f32_16x16x32_bf16 a[132:135], v[68:71], a[144:147], a[132:135]
    ds_read_b64_tr_b16 a[124:125], v131 offset:32768
    v_mfma_f32_16x16x32_bf16 a[236:239], v[68:71], a[108:111], a[236:239]
    v_exp_f32 v12, v12
    v_mfma_f32_16x16x32_bf16 a[204:207], v[64:67], a[108:111], a[204:207]
    v_exp_f32 v40, v40
    v_mfma_f32_16x16x32_bf16 a[132:135], v[64:67], a[140:143], a[132:135]
    v_exp_f32 v43, v43
    v_mfma_f32_16x16x32_bf16 a[200:203], v[64:67], a[104:107], a[200:203]
    ds_read_b64_tr_b16 a[126:127], v131 offset:40960
    v_mfma_f32_16x16x32_bf16 v[248:251], v[60:63], a[104:107], v[248:251]
    v_exp_f32 v6, v6
    v_mfma_f32_16x16x32_bf16 v[252:255], v[60:63], a[108:111], v[252:255]
    v_exp_f32 v34, v34
    v_mfma_f32_16x16x32_bf16 v[220:223], v[56:59], a[108:111], v[220:223]
    v_exp_f32 v20, v20
    v_mfma_f32_16x16x32_bf16 v[216:219], v[56:59], a[104:107], v[216:219]
    v_exp_f32 v32, v32
    v_mfma_f32_16x16x32_bf16 v[184:187], v[52:55], a[104:107], v[184:187]
    v_exp_f32 v42, v42
    v_mfma_f32_16x16x32_bf16 v[188:191], v[52:55], a[108:111], v[188:191]
    v_cvt_pk_bf16_f32 v92, v40, v41
    v_mfma_f32_16x16x32_bf16 v[156:159], v[48:51], a[108:111], v[156:159]
    v_cvt_pk_bf16_f32 v93, v42, v43
    v_mfma_f32_16x16x32_bf16 v[152:155], v[48:51], a[104:107], v[152:155]
    s_waitcnt lgkmcnt(0)
    v_cvt_pk_bf16_f32 v81, v18, v19
    v_mfma_f32_16x16x32_bf16 v[160:163], v[48:51], a[112:115], v[160:163]
    v_mfma_f32_16x16x32_bf16 v[164:167], v[48:51], a[116:119], v[164:167]
    v_exp_f32 v5, v5
    v_mfma_f32_16x16x32_bf16 v[196:199], v[52:55], a[116:119], v[196:199]
    v_exp_f32 v14, v14
    v_mfma_f32_16x16x32_bf16 v[192:195], v[52:55], a[112:115], v[192:195]
    ds_read_b128 a[96:99], v120 offset:32768
    v_mfma_f32_16x16x32_bf16 v[224:227], v[56:59], a[112:115], v[224:227]
    v_cvt_pk_bf16_f32 v80, v16, v17
    v_cvt_pk_bf16_f32 v88, v32, v33
    v_mfma_f32_16x16x32_bf16 a[128:131], v[56:59], a[144:147], a[128:131]
    v_exp_f32 v7, v7
    v_mfma_f32_16x16x32_bf16 v[228:231], v[56:59], a[116:119], v[228:231]
    ds_read_b128 a[100:103], v121 offset:32768
    v_mfma_f32_16x16x32_bf16 a[180:183], v[60:63], a[116:119], a[180:183]
    v_exp_f32 v21, v21
    v_mfma_f32_16x16x32_bf16 a[176:179], v[60:63], a[112:115], a[176:179]
    v_exp_f32 v31, v31
    v_mfma_f32_16x16x32_bf16 a[208:211], v[64:67], a[112:115], a[208:211]
    ds_read_b128 a[104:107], v122 offset:32768
    v_mfma_f32_16x16x32_bf16 a[212:215], v[64:67], a[116:119], a[212:215]
    v_exp_f32 v15, v15
    v_mfma_f32_16x16x32_bf16 a[244:247], v[68:71], a[116:119], a[244:247]
    v_exp_f32 v4, v4
    v_mfma_f32_16x16x32_bf16 a[240:243], v[68:71], a[112:115], a[240:243]
    v_cvt_pk_bf16_f32 v74, v4, v5
    v_mfma_f32_16x16x32_bf16 a[248:251], v[68:71], a[120:123], a[248:251]
    v_exp_f32 v13, v13
    v_mfma_f32_16x16x32_bf16 a[252:255], v[68:71], a[124:127], a[252:255]
    v_exp_f32 v29, v29
    v_mfma_f32_16x16x32_bf16 a[220:223], v[64:67], a[124:127], a[220:223]
    v_exp_f32 v30, v30
    v_mfma_f32_16x16x32_bf16 a[216:219], v[64:67], a[120:123], a[216:219]
    ds_read_b128 a[108:111], v123 offset:32768
    v_cvt_pk_bf16_f32 v75, v6, v7
    v_mfma_f32_16x16x32_bf16 a[184:187], v[60:63], a[120:123], a[184:187]
    v_cvt_pk_bf16_f32 v85, v26, v27
    v_cvt_pk_bf16_f32 v87, v30, v31
    v_mfma_f32_16x16x32_bf16 a[132:135], v[60:63], a[136:139], a[132:135]
    v_cvt_pk_bf16_f32 v78, v12, v13
    v_mfma_f32_16x16x32_bf16 a[188:191], v[60:63], a[124:127], a[188:191]
    v_exp_f32 v23, v23
    v_mfma_f32_16x16x32_bf16 v[236:239], v[56:59], a[124:127], v[236:239]
    v_exp_f32 v22, v22
    v_mfma_f32_16x16x32_bf16 v[232:235], v[56:59], a[120:123], v[232:235]
    v_exp_f32 v28, v28
    v_mfma_f32_16x16x32_bf16 v[200:203], v[52:55], a[120:123], v[200:203]
    v_cvt_pk_bf16_f32 v89, v34, v35
    v_cvt_pk_bf16_f32 v79, v14, v15
    v_mfma_f32_16x16x32_bf16 v[204:207], v[52:55], a[124:127], v[204:207]
    v_cvt_pk_bf16_f32 v83, v22, v23
    v_cvt_pk_bf16_f32 v86, v28, v29
    v_mfma_f32_16x16x32_bf16 v[172:175], v[48:51], a[124:127], v[172:175]
    s_waitcnt lgkmcnt(0)
    v_cvt_pk_bf16_f32 v82, v20, v21
    v_mfma_f32_16x16x32_bf16 v[168:171], v[48:51], a[120:123], v[168:171]
    v_mfma_f32_16x16x32_bf16 v[0:3], a[96:99], a[0:3], v[96:99]
    ds_read_b64_tr_b16 a[148:149], v141 offset:12288
    v_mfma_f32_16x16x32_bf16 v[0:3], a[100:103], a[4:7], v[0:3]
    ds_read_b128 a[112:115], v120 offset:40960
    v_mfma_f32_16x16x32_bf16 v[0:3], a[104:107], a[8:11], v[0:3]
    v_exp_f32 v47, v47
    v_mfma_f32_16x16x32_bf16 v[0:3], a[108:111], a[12:15], v[0:3]
    ds_read_b64_tr_b16 a[150:151], v141 offset:12320
    v_mfma_f32_16x16x32_bf16 v[8:11], a[108:111], a[28:31], v[100:103]
    v_mfma_f32_16x16x32_bf16 v[8:11], a[104:107], a[24:27], v[8:11]
    v_exp_f32 v38, v38
    v_mfma_f32_16x16x32_bf16 v[8:11], a[100:103], a[20:23], v[8:11]
    ds_read_b128 a[116:119], v121 offset:40960
    v_mfma_f32_16x16x32_bf16 v[8:11], a[96:99], a[16:19], v[8:11]
    v_exp_f32 v37, v37
    v_mfma_f32_16x16x32_bf16 v[16:19], a[96:99], a[32:35], v[104:107]
    v_exp_f32 v46, v46
    v_mfma_f32_16x16x32_bf16 v[16:19], a[100:103], a[36:39], v[16:19]
    ds_read_b64_tr_b16 a[152:153], v141 offset:12416
    v_mfma_f32_16x16x32_bf16 v[16:19], a[104:107], a[40:43], v[16:19]
L_pad10:
    s_cbranch_vccz L_padret2
    ds_read_b64_tr_b16 a[154:155], v141 offset:12448
    v_mfma_f32_16x16x32_bf16 v[16:19], a[108:111], a[44:47], v[16:19]
    ds_read_b128 a[120:123], v122 offset:40960
    v_mfma_f32_16x16x32_bf16 v[24:27], a[108:111], a[60:63], v[108:111]
    v_exp_f32 v36, v36
    v_mfma_f32_16x16x32_bf16 v[24:27], a[104:107], a[56:59], v[24:27]
    ds_read_b128 a[124:127], v123 offset:40960
    v_cvt_pk_bf16_f32 v95, v46, v47
    v_mfma_f32_16x16x32_bf16 v[24:27], a[100:103], a[52:55], v[24:27]
    v_exp_f32 v0, v0
    v_mfma_f32_16x16x32_bf16 v[24:27], a[96:99], a[48:51], v[24:27]
    v_exp_f32 v2, v2
    v_mfma_f32_16x16x32_bf16 v[32:35], a[96:99], a[64:67], v[112:115]
    v_exp_f32 v44, v44
    v_mfma_f32_16x16x32_bf16 v[32:35], a[100:103], a[68:71], v[32:35]
    v_exp_f32 v39, v39
    v_mfma_f32_16x16x32_bf16 v[32:35], a[104:107], a[72:75], v[32:35]
    v_mfma_f32_16x16x32_bf16 v[32:35], a[108:111], a[76:79], v[32:35]
    v_exp_f32 v45, v45
    v_mfma_f32_16x16x32_bf16 v[40:43], a[108:111], a[92:95], v[116:119]
    v_exp_f32 v3, v3
    v_mfma_f32_16x16x32_bf16 v[40:43], a[104:107], a[88:91], v[40:43]
    v_cvt_pk_bf16_f32 v91, v38, v39
    v_cvt_pk_bf16_f32 v49, v2, v3
    v_mfma_f32_16x16x32_bf16 v[40:43], a[100:103], a[84:87], v[40:43]
    v_cvt_pk_bf16_f32 v90, v36, v37
    v_cvt_pk_bf16_f32 v94, v44, v45
    v_mfma_f32_16x16x32_bf16 v[40:43], a[96:99], a[80:83], v[40:43]
    s_waitcnt vmcnt(10) lgkmcnt(0)
    s_barrier
    v_mfma_f32_16x16x32_bf16 v[4:7], a[112:115], a[0:3], v[96:99]
    ds_read_b64_tr_b16 a[96:97], v124 offset:49152
    v_mfma_f32_16x16x32_bf16 v[4:7], a[116:119], a[4:7], v[4:7]
    ds_read_b64_tr_b16 a[98:99], v124 offset:57344
    s_add_u32 m0, s30, 32768
    v_mfma_f32_16x16x32_bf16 v[4:7], a[120:123], a[8:11], v[4:7]
    ds_read_b64_tr_b16 a[100:101], v125 offset:49152
    v_mfma_f32_16x16x32_bf16 v[4:7], a[124:127], a[12:15], v[4:7]
    global_load_lds_dwordx4 v132, s[22:23] offset:1024 nt
    v_mfma_f32_16x16x32_bf16 v[12:15], a[124:127], a[28:31], v[100:103]
    v_exp_f32 v11, v11
    v_mfma_f32_16x16x32_bf16 v[12:15], a[120:123], a[24:27], v[12:15]
    v_exp_f32 v10, v10
    v_mfma_f32_16x16x32_bf16 v[12:15], a[116:119], a[20:23], v[12:15]
    v_exp_f32 v1, v1
    v_mfma_f32_16x16x32_bf16 v[12:15], a[112:115], a[16:19], v[12:15]
    ds_read_b64_tr_b16 a[102:103], v125 offset:57344
    v_mfma_f32_16x16x32_bf16 v[20:23], a[112:115], a[32:35], v[104:107]
    global_load_lds_dwordx4 v132, s[18:19] nt
    v_mfma_f32_16x16x32_bf16 v[20:23], a[116:119], a[36:39], v[20:23]
    ds_read_b64_tr_b16 a[104:105], v126 offset:49152
    v_cvt_pk_bf16_f32 v48, v0, v1
    v_mfma_f32_16x16x32_bf16 v[20:23], a[120:123], a[40:43], v[20:23]
    ds_read_b64_tr_b16 a[106:107], v126 offset:57344
    v_mfma_f32_16x16x32_bf16 v[20:23], a[124:127], a[44:47], v[20:23]
    v_exp_f32 v17, v17
    v_mfma_f32_16x16x32_bf16 v[28:31], a[124:127], a[60:63], v[108:111]
    v_mfma_f32_16x16x32_bf16 v[28:31], a[120:123], a[56:59], v[28:31]
    global_load_lds_dwordx4 v132, s[22:23] offset:3072 nt
    v_mfma_f32_16x16x32_bf16 v[28:31], a[116:119], a[52:55], v[28:31]
    v_exp_f32 v8, v8
    v_mfma_f32_16x16x32_bf16 v[28:31], a[112:115], a[48:51], v[28:31]
    v_exp_f32 v9, v9
    v_mfma_f32_16x16x32_bf16 v[36:39], a[112:115], a[64:67], v[112:115]
    v_exp_f32 v16, v16
    v_mfma_f32_16x16x32_bf16 v[36:39], a[116:119], a[68:71], v[36:39]
    ds_read_b64_tr_b16 a[108:109], v127 offset:49152
    s_waitcnt lgkmcnt(3)
    v_mfma_f32_16x16x32_bf16 v[36:39], a[120:123], a[72:75], v[36:39]
    global_load_lds_dwordx4 v132, s[18:19] offset:2048 nt
    v_mfma_f32_16x16x32_bf16 v[36:39], a[124:127], a[76:79], v[36:39]
    v_exp_f32 v25, v25
    v_mfma_f32_16x16x32_bf16 v[44:47], a[124:127], a[92:95], v[116:119]
    v_exp_f32 v18, v18
    v_mfma_f32_16x16x32_bf16 v[44:47], a[120:123], a[88:91], v[44:47]
    v_exp_f32 v35, v35
    v_mfma_f32_16x16x32_bf16 v[44:47], a[116:119], a[84:87], v[44:47]
    v_exp_f32 v19, v19
    v_mfma_f32_16x16x32_bf16 v[44:47], a[112:115], a[80:83], v[44:47]
    ds_read_b64_tr_b16 a[110:111], v127 offset:57344
    v_add_u32 v132, 8192, v132
    v_mfma_f32_16x16x32_bf16 v[144:147], v[72:75], a[96:99], v[144:147]
    v_exp_f32 v24, v24
    v_mfma_f32_16x16x32_bf16 a[128:131], v[72:75], a[136:139], a[128:131]
    v_exp_f32 v34, v34
    v_mfma_f32_16x16x32_bf16 v[148:151], v[72:75], a[100:103], v[148:151]
    ds_read_b64_tr_b16 a[112:113], v128 offset:49152
    v_mfma_f32_16x16x32_bf16 v[180:183], v[76:79], a[100:103], v[180:183]
    v_exp_f32 v27, v27
    v_mfma_f32_16x16x32_bf16 a[128:131], v[76:79], a[140:143], a[128:131]
    v_exp_f32 v32, v32
    v_mfma_f32_16x16x32_bf16 v[176:179], v[76:79], a[96:99], v[176:179]
    v_mfma_f32_16x16x32_bf16 v[208:211], v[80:83], a[96:99], v[208:211]
    v_exp_f32 v33, v33
    v_mfma_f32_16x16x32_bf16 v[212:215], v[80:83], a[100:103], v[212:215]
    s_mov_b32 s32, 12288
    v_mfma_f32_16x16x32_bf16 v[244:247], v[84:87], a[100:103], v[244:247]
    buffer_store_dwordx4 a[148:151], v135, s[24:27], s32 offen sc1
    v_mfma_f32_16x16x32_bf16 v[240:243], v[84:87], a[96:99], v[240:243]
    ds_read_b64_tr_b16 a[114:115], v128 offset:57344
    v_mfma_f32_16x16x32_bf16 a[192:195], v[88:91], a[96:99], a[192:195]
    v_exp_f32 v5, v5
    v_mfma_f32_16x16x32_bf16 a[196:199], v[88:91], a[100:103], a[196:199]
    ds_read_b64_tr_b16 a[116:117], v129 offset:49152
    s_waitcnt lgkmcnt(3)
    v_mfma_f32_16x16x32_bf16 a[228:231], v[92:95], a[100:103], a[228:231]
    v_exp_f32 v41, v41
    v_mfma_f32_16x16x32_bf16 a[224:227], v[92:95], a[96:99], a[224:227]
    ds_read_b64_tr_b16 a[118:119], v129 offset:57344
    v_cvt_pk_bf16_f32 v57, v18, v19
    v_mfma_f32_16x16x32_bf16 a[232:235], v[92:95], a[104:107], a[232:235]
    v_exp_f32 v42, v42
    v_mfma_f32_16x16x32_bf16 a[132:135], v[92:95], a[144:147], a[132:135]
    ds_read_b64_tr_b16 a[120:121], v130 offset:49152
    v_cvt_pk_bf16_f32 v53, v10, v11
    v_mfma_f32_16x16x32_bf16 a[236:239], v[92:95], a[108:111], a[236:239]
    v_exp_f32 v6, v6
    v_mfma_f32_16x16x32_bf16 a[204:207], v[88:91], a[108:111], a[204:207]
    ds_read_b64_tr_b16 a[122:123], v130 offset:57344
    v_cvt_pk_bf16_f32 v52, v8, v9
    v_mfma_f32_16x16x32_bf16 a[132:135], v[88:91], a[140:143], a[132:135]
    ds_read_b64_tr_b16 a[124:125], v131 offset:49152
    v_cvt_pk_bf16_f32 v60, v24, v25
    v_mfma_f32_16x16x32_bf16 a[200:203], v[88:91], a[104:107], a[200:203]
    ds_read_b64_tr_b16 a[126:127], v131 offset:57344
    v_mfma_f32_16x16x32_bf16 v[248:251], v[84:87], a[104:107], v[248:251]
    v_exp_f32 v20, v20
    v_mfma_f32_16x16x32_bf16 v[252:255], v[84:87], a[108:111], v[252:255]
    v_exp_f32 v21, v21
    v_mfma_f32_16x16x32_bf16 v[220:223], v[80:83], a[108:111], v[220:223]
    v_exp_f32 v14, v14
    v_mfma_f32_16x16x32_bf16 v[216:219], v[80:83], a[104:107], v[216:219]
    v_exp_f32 v29, v29
    v_mfma_f32_16x16x32_bf16 v[184:187], v[76:79], a[104:107], v[184:187]
    v_exp_f32 v26, v26
    v_mfma_f32_16x16x32_bf16 v[188:191], v[76:79], a[108:111], v[188:191]
    v_exp_f32 v15, v15
    v_mfma_f32_16x16x32_bf16 v[156:159], v[72:75], a[108:111], v[156:159]
    v_exp_f32 v22, v22
    v_mfma_f32_16x16x32_bf16 v[152:155], v[72:75], a[104:107], v[152:155]
    s_waitcnt lgkmcnt(0)
    v_cvt_pk_bf16_f32 v64, v32, v33
    v_mfma_f32_16x16x32_bf16 v[160:163], v[72:75], a[112:115], v[160:163]
    v_cvt_pk_bf16_f32 v61, v26, v27
    v_mfma_f32_16x16x32_bf16 v[164:167], v[72:75], a[116:119], v[164:167]
    v_exp_f32 v40, v40
    v_mfma_f32_16x16x32_bf16 v[196:199], v[76:79], a[116:119], v[196:199]
    v_exp_f32 v23, v23
    v_mfma_f32_16x16x32_bf16 v[192:195], v[76:79], a[112:115], v[192:195]
    ds_read_b128 a[96:99], v120 offset:49152
    v_mfma_f32_16x16x32_bf16 v[224:227], v[80:83], a[112:115], v[224:227]
    v_exp_f32 v43, v43
    v_mfma_f32_16x16x32_bf16 a[128:131], v[80:83], a[144:147], a[128:131]
    v_exp_f32 v7, v7
    v_mfma_f32_16x16x32_bf16 v[228:231], v[80:83], a[116:119], v[228:231]
    ds_read_b128 a[100:103], v121 offset:49152
    v_cvt_pk_bf16_f32 v68, v40, v41
    v_mfma_f32_16x16x32_bf16 a[180:183], v[84:87], a[116:119], a[180:183]
    v_exp_f32 v13, v13
    v_mfma_f32_16x16x32_bf16 a[176:179], v[84:87], a[112:115], a[176:179]
    v_exp_f32 v4, v4
    v_mfma_f32_16x16x32_bf16 a[208:211], v[88:91], a[112:115], a[208:211]
    v_exp_f32 v31, v31
    v_mfma_f32_16x16x32_bf16 a[212:215], v[88:91], a[116:119], a[212:215]
    ds_read_b128 a[104:107], v122 offset:49152
    v_mfma_f32_16x16x32_bf16 a[244:247], v[92:95], a[116:119], a[244:247]
    ds_read_b128 a[108:111], v123 offset:49152
    v_cvt_pk_bf16_f32 v59, v22, v23
    v_mfma_f32_16x16x32_bf16 a[240:243], v[92:95], a[112:115], a[240:243]
    v_cvt_pk_bf16_f32 v51, v6, v7
    v_cvt_pk_bf16_f32 v58, v20, v21
    v_mfma_f32_16x16x32_bf16 a[248:251], v[92:95], a[120:123], a[248:251]
    v_exp_f32 v30, v30
    v_mfma_f32_16x16x32_bf16 a[252:255], v[92:95], a[124:127], a[252:255]
    v_cvt_pk_bf16_f32 v69, v42, v43
    v_mfma_f32_16x16x32_bf16 a[220:223], v[88:91], a[124:127], a[220:223]
    v_cvt_pk_bf16_f32 v56, v16, v17
    v_mfma_f32_16x16x32_bf16 a[216:219], v[88:91], a[120:123], a[216:219]
    v_mfma_f32_16x16x32_bf16 a[184:187], v[84:87], a[120:123], a[184:187]
    v_cvt_pk_bf16_f32 v55, v14, v15
    v_mfma_f32_16x16x32_bf16 a[132:135], v[84:87], a[136:139], a[132:135]
    v_exp_f32 v28, v28
    v_mfma_f32_16x16x32_bf16 a[188:191], v[84:87], a[124:127], a[188:191]
    v_cvt_pk_bf16_f32 v50, v4, v5
    v_mfma_f32_16x16x32_bf16 v[236:239], v[80:83], a[124:127], v[236:239]
    buffer_store_dwordx4 a[152:155], v135, s[24:27], s32 offen offset:1024 sc1
    v_mfma_f32_16x16x32_bf16 v[232:235], v[80:83], a[120:123], v[232:235]
    s_waitcnt lgkmcnt(0)
    v_mfma_f32_16x16x32_bf16 v[200:203], v[76:79], a[120:123], v[200:203]
    v_exp_f32 v12, v12
    v_mfma_f32_16x16x32_bf16 v[204:207], v[76:79], a[124:127], v[204:207]
    v_cvt_pk_bf16_f32 v62, v28, v29
    v_cvt_pk_bf16_f32 v63, v30, v31
    v_mfma_f32_16x16x32_bf16 v[172:175], v[72:75], a[124:127], v[172:175]
    v_cvt_pk_bf16_f32 v65, v34, v35
    v_cvt_pk_bf16_f32 v54, v12, v13
    v_mfma_f32_16x16x32_bf16 v[168:171], v[72:75], a[120:123], v[168:171]
    v_mfma_f32_16x16x32_bf16 v[0:3], a[96:99], a[0:3], v[96:99]
    v_exp_f32 v39, v39
    v_mfma_f32_16x16x32_bf16 v[0:3], a[100:103], a[4:7], v[0:3]
    ds_read_b128 a[112:115], v120 offset:57344
    v_mfma_f32_16x16x32_bf16 v[0:3], a[104:107], a[8:11], v[0:3]
    v_exp_f32 v46, v46
    v_mfma_f32_16x16x32_bf16 v[0:3], a[108:111], a[12:15], v[0:3]
    v_exp_f32 v44, v44
    v_mfma_f32_16x16x32_bf16 v[8:11], a[108:111], a[28:31], v[100:103]
    v_exp_f32 v37, v37
    v_mfma_f32_16x16x32_bf16 v[8:11], a[104:107], a[24:27], v[8:11]
    ds_read_b64_tr_b16 a[148:149], v141 offset:12544
    v_mfma_f32_16x16x32_bf16 v[8:11], a[100:103], a[20:23], v[8:11]
    ds_read_b128 a[116:119], v121 offset:57344
    v_mfma_f32_16x16x32_bf16 v[8:11], a[96:99], a[16:19], v[8:11]
    v_exp_f32 v36, v36
    v_mfma_f32_16x16x32_bf16 v[16:19], a[96:99], a[32:35], v[104:107]
    ds_read_b64_tr_b16 a[150:151], v141 offset:12576
    v_mfma_f32_16x16x32_bf16 v[16:19], a[100:103], a[36:39], v[16:19]
    ds_read_b64_tr_b16 a[152:153], v141 offset:12672
    v_mfma_f32_16x16x32_bf16 v[16:19], a[104:107], a[40:43], v[16:19]
    v_exp_f32 v38, v38
    v_mfma_f32_16x16x32_bf16 v[16:19], a[108:111], a[44:47], v[16:19]
    ds_read_b128 a[120:123], v122 offset:57344
    v_mfma_f32_16x16x32_bf16 v[24:27], a[108:111], a[60:63], v[108:111]
    ds_read_b64_tr_b16 a[154:155], v141 offset:12704
    v_mfma_f32_16x16x32_bf16 v[24:27], a[104:107], a[56:59], v[24:27]
    ds_read_b128 a[124:127], v123 offset:57344
    v_cvt_pk_bf16_f32 v67, v38, v39
    v_mfma_f32_16x16x32_bf16 v[24:27], a[100:103], a[52:55], v[24:27]
    ds_read_b64_tr_b16 a[156:157], v141 offset:16384
    s_waitcnt lgkmcnt(5)
    v_mfma_f32_16x16x32_bf16 v[24:27], a[96:99], a[48:51], v[24:27]
    ds_read_b64_tr_b16 a[158:159], v141 offset:16416
    s_mov_b32 s32, 14336
    v_mfma_f32_16x16x32_bf16 v[32:35], a[96:99], a[64:67], v[112:115]
    buffer_store_dwordx4 a[148:151], v135, s[24:27], s32 offen sc1
    v_mfma_f32_16x16x32_bf16 v[32:35], a[100:103], a[68:71], v[32:35]
    ds_read_b64_tr_b16 a[160:161], v141 offset:16512
    v_mfma_f32_16x16x32_bf16 v[32:35], a[104:107], a[72:75], v[32:35]
    v_exp_f32 v45, v45
    v_mfma_f32_16x16x32_bf16 v[32:35], a[108:111], a[76:79], v[32:35]
    s_waitcnt lgkmcnt(4)
    v_mfma_f32_16x16x32_bf16 v[40:43], a[108:111], a[92:95], v[116:119]
    v_exp_f32 v0, v0
    v_mfma_f32_16x16x32_bf16 v[40:43], a[104:107], a[88:91], v[40:43]
    v_exp_f32 v2, v2
    v_mfma_f32_16x16x32_bf16 v[40:43], a[100:103], a[84:87], v[40:43]
    v_exp_f32 v8, v8
    v_mfma_f32_16x16x32_bf16 v[40:43], a[96:99], a[80:83], v[40:43]
    s_waitcnt vmcnt(11) lgkmcnt(0)
    s_barrier
    v_mfma_f32_16x16x32_bf16 v[4:7], a[112:115], a[0:3], v[96:99]
    v_exp_f32 v1, v1
    v_mfma_f32_16x16x32_bf16 v[4:7], a[116:119], a[4:7], v[4:7]
    ds_read_b64_tr_b16 a[162:163], v141 offset:16544
    v_cvt_pk_bf16_f32 v70, v44, v45
    v_mfma_f32_16x16x32_bf16 v[4:7], a[120:123], a[8:11], v[4:7]
    v_exp_f32 v47, v47
    v_mfma_f32_16x16x32_bf16 v[4:7], a[124:127], a[12:15], v[4:7]
    ds_read_b64_tr_b16 a[96:97], v124
    v_cvt_pk_bf16_f32 v66, v36, v37
    v_mfma_f32_16x16x32_bf16 v[12:15], a[124:127], a[28:31], v[100:103]
    v_exp_f32 v9, v9
    v_mfma_f32_16x16x32_bf16 v[12:15], a[120:123], a[24:27], v[12:15]
    ds_read_b64_tr_b16 a[98:99], v124 offset:8192
    v_cvt_pk_bf16_f32 v71, v46, v47
    v_mfma_f32_16x16x32_bf16 v[12:15], a[116:119], a[20:23], v[12:15]
    v_exp_f32 v27, v27
    v_mfma_f32_16x16x32_bf16 v[12:15], a[112:115], a[16:19], v[12:15]
    ds_read_b64_tr_b16 a[100:101], v125
    v_mfma_f32_16x16x32_bf16 v[20:23], a[112:115], a[32:35], v[104:107]
    v_exp_f32 v16, v16
    v_mfma_f32_16x16x32_bf16 v[20:23], a[116:119], a[36:39], v[20:23]
    ds_read_b64_tr_b16 a[164:165], v141 offset:16640
    v_mfma_f32_16x16x32_bf16 v[20:23], a[120:123], a[40:43], v[20:23]
    v_exp_f32 v3, v3
    v_mfma_f32_16x16x32_bf16 v[20:23], a[124:127], a[44:47], v[20:23]
    ds_read_b64_tr_b16 a[102:103], v125 offset:8192
    v_mfma_f32_16x16x32_bf16 v[28:31], a[124:127], a[60:63], v[108:111]
    buffer_store_dwordx4 a[152:155], v135, s[24:27], s32 offen offset:1024 sc1
    v_mfma_f32_16x16x32_bf16 v[28:31], a[120:123], a[56:59], v[28:31]
    v_exp_f32 v10, v10
    v_mfma_f32_16x16x32_bf16 v[28:31], a[116:119], a[52:55], v[28:31]
    v_exp_f32 v17, v17
    v_mfma_f32_16x16x32_bf16 v[28:31], a[112:115], a[48:51], v[28:31]
    ds_read_b64_tr_b16 a[104:105], v126
    v_cvt_pk_bf16_f32 v72, v0, v1
    v_mfma_f32_16x16x32_bf16 v[36:39], a[112:115], a[64:67], v[112:115]
    v_exp_f32 v25, v25
    v_mfma_f32_16x16x32_bf16 v[36:39], a[116:119], a[68:71], v[36:39]
    v_exp_f32 v11, v11
    v_mfma_f32_16x16x32_bf16 v[36:39], a[120:123], a[72:75], v[36:39]
    v_exp_f32 v32, v32
    v_mfma_f32_16x16x32_bf16 v[36:39], a[124:127], a[76:79], v[36:39]
    v_exp_f32 v24, v24
    v_mfma_f32_16x16x32_bf16 v[44:47], a[124:127], a[92:95], v[116:119]
    ds_read_b64_tr_b16 a[106:107], v126 offset:8192
    s_waitcnt lgkmcnt(2)
    v_mfma_f32_16x16x32_bf16 v[44:47], a[120:123], a[88:91], v[44:47]
    ds_read_b64_tr_b16 a[108:109], v127
    v_mfma_f32_16x16x32_bf16 v[44:47], a[116:119], a[84:87], v[44:47]
    ds_read_b64_tr_b16 a[110:111], v127 offset:8192
    v_mfma_f32_16x16x32_bf16 v[44:47], a[112:115], a[80:83], v[44:47]
    v_exp_f32 v18, v18
    v_mfma_f32_16x16x32_bf16 v[144:147], v[48:51], a[96:99], v[144:147]
    v_exp_f32 v26, v26
    v_mfma_f32_16x16x32_bf16 a[128:131], v[48:51], a[136:139], a[128:131]
    v_exp_f32 v43, v43
    v_mfma_f32_16x16x32_bf16 v[148:151], v[48:51], a[100:103], v[148:151]
    v_exp_f32 v33, v33
    v_mfma_f32_16x16x32_bf16 v[180:183], v[52:55], a[100:103], v[180:183]
    v_exp_f32 v19, v19
    v_mfma_f32_16x16x32_bf16 a[128:131], v[52:55], a[140:143], a[128:131]
    v_cvt_pk_bf16_f32 v84, v24, v25
    v_cvt_pk_bf16_f32 v85, v26, v27
    v_mfma_f32_16x16x32_bf16 v[176:179], v[52:55], a[96:99], v[176:179]
    ds_read_b64_tr_b16 a[112:113], v128
    v_cvt_pk_bf16_f32 v73, v2, v3
    v_mfma_f32_16x16x32_bf16 v[208:211], v[56:59], a[96:99], v[208:211]
    ds_read_b64_tr_b16 a[114:115], v128 offset:8192
    v_mfma_f32_16x16x32_bf16 v[212:215], v[56:59], a[100:103], v[212:215]
    ds_read_b64_tr_b16 a[116:117], v129
    s_waitcnt lgkmcnt(3)
    v_mfma_f32_16x16x32_bf16 v[244:247], v[60:63], a[100:103], v[244:247]
    buffer_store_dwordx4 a[156:159], v135, s[24:27], s32 offen offset:2048 sc1
    v_mfma_f32_16x16x32_bf16 v[240:243], v[60:63], a[96:99], v[240:243]
    v_exp_f32 v35, v35
    v_mfma_f32_16x16x32_bf16 a[192:195], v[64:67], a[96:99], a[192:195]
    v_exp_f32 v42, v42
    v_mfma_f32_16x16x32_bf16 a[196:199], v[64:67], a[100:103], a[196:199]
    ds_read_b64_tr_b16 a[118:119], v129 offset:8192
    v_cvt_pk_bf16_f32 v77, v10, v11
    v_mfma_f32_16x16x32_bf16 a[228:231], v[68:71], a[100:103], a[228:231]
    ds_read_b64_tr_b16 a[166:167], v141 offset:16672
    v_cvt_pk_bf16_f32 v80, v16, v17
    v_mfma_f32_16x16x32_bf16 a[224:227], v[68:71], a[96:99], a[224:227]
    ds_read_b64_tr_b16 a[120:121], v130
    v_cvt_pk_bf16_f32 v76, v8, v9
    v_mfma_f32_16x16x32_bf16 a[232:235], v[68:71], a[104:107], a[232:235]
    ds_read_b64_tr_b16 a[122:123], v130 offset:8192
    v_mfma_f32_16x16x32_bf16 a[132:135], v[68:71], a[144:147], a[132:135]
    v_exp_f32 v21, v21
    v_mfma_f32_16x16x32_bf16 a[236:239], v[68:71], a[108:111], a[236:239]
    v_exp_f32 v40, v40
    v_mfma_f32_16x16x32_bf16 a[204:207], v[64:67], a[108:111], a[204:207]
    v_exp_f32 v41, v41
    v_mfma_f32_16x16x32_bf16 a[132:135], v[64:67], a[140:143], a[132:135]
    ds_read_b64_tr_b16 a[124:125], v131
    s_waitcnt lgkmcnt(3)
    v_mfma_f32_16x16x32_bf16 a[200:203], v[64:67], a[104:107], a[200:203]
    ds_read_b64_tr_b16 a[126:127], v131 offset:8192
    v_cvt_pk_bf16_f32 v81, v18, v19
    v_mfma_f32_16x16x32_bf16 v[248:251], v[60:63], a[104:107], v[248:251]
    v_exp_f32 v30, v30
    v_mfma_f32_16x16x32_bf16 v[252:255], v[60:63], a[108:111], v[252:255]
    v_exp_f32 v29, v29
    v_mfma_f32_16x16x32_bf16 v[220:223], v[56:59], a[108:111], v[220:223]
    v_exp_f32 v22, v22
    v_mfma_f32_16x16x32_bf16 v[216:219], v[56:59], a[104:107], v[216:219]
    v_exp_f32 v31, v31
    v_mfma_f32_16x16x32_bf16 v[184:187], v[52:55], a[104:107], v[184:187]
    v_exp_f32 v23, v23
    v_mfma_f32_16x16x32_bf16 v[188:191], v[52:55], a[108:111], v[188:191]
    v_exp_f32 v34, v34
    v_mfma_f32_16x16x32_bf16 v[156:159], v[48:51], a[108:111], v[156:159]
    v_exp_f32 v20, v20
    v_mfma_f32_16x16x32_bf16 v[152:155], v[48:51], a[104:107], v[152:155]
    s_waitcnt lgkmcnt(0)
    v_mfma_f32_16x16x32_bf16 v[160:163], v[48:51], a[112:115], v[160:163]
    buffer_store_dwordx4 a[160:163], v135, s[24:27], s32 offen offset:3072 sc1
    v_mfma_f32_16x16x32_bf16 v[164:167], v[48:51], a[116:119], v[164:167]
    v_exp_f32 v37, v37
    v_mfma_f32_16x16x32_bf16 v[196:199], v[52:55], a[116:119], v[196:199]
    v_exp_f32 v38, v38
    v_mfma_f32_16x16x32_bf16 v[192:195], v[52:55], a[112:115], v[192:195]
    v_exp_f32 v44, v44
    v_mfma_f32_16x16x32_bf16 v[224:227], v[56:59], a[112:115], v[224:227]
    v_exp_f32 v45, v45
    v_mfma_f32_16x16x32_bf16 a[128:131], v[56:59], a[144:147], a[128:131]
    v_exp_f32 v28, v28
    v_mfma_f32_16x16x32_bf16 v[228:231], v[56:59], a[116:119], v[228:231]
    ds_read_b128 a[96:99], v120
    v_cvt_pk_bf16_f32 v87, v30, v31
    v_mfma_f32_16x16x32_bf16 a[180:183], v[60:63], a[116:119], a[180:183]
    ds_read_b128 a[100:103], v121
    v_cvt_pk_bf16_f32 v83, v22, v23
    v_mfma_f32_16x16x32_bf16 a[176:179], v[60:63], a[112:115], a[176:179]
    v_mfma_f32_16x16x32_bf16 a[208:211], v[64:67], a[112:115], a[208:211]
    ds_read_b128 a[104:107], v122
    v_mfma_f32_16x16x32_bf16 a[212:215], v[64:67], a[116:119], a[212:215]
    v_cvt_pk_bf16_f32 v88, v32, v33
    v_cvt_pk_bf16_f32 v89, v34, v35
    v_mfma_f32_16x16x32_bf16 a[244:247], v[68:71], a[116:119], a[244:247]
    v_exp_f32 v36, v36
    v_mfma_f32_16x16x32_bf16 a[240:243], v[68:71], a[112:115], a[240:243]
    v_exp_f32 v47, v47
    v_mfma_f32_16x16x32_bf16 a[248:251], v[68:71], a[120:123], a[248:251]
    ds_read_b128 a[108:111], v123
    v_cvt_pk_bf16_f32 v92, v40, v41
    v_mfma_f32_16x16x32_bf16 a[252:255], v[68:71], a[124:127], a[252:255]
    v_mfma_f32_16x16x32_bf16 a[220:223], v[64:67], a[124:127], a[220:223]
    ds_read_b64_tr_b16 a[148:149], v141 offset:16768
    v_mfma_f32_16x16x32_bf16 a[216:219], v[64:67], a[120:123], a[216:219]
    v_exp_f32 v39, v39
    v_mfma_f32_16x16x32_bf16 a[184:187], v[60:63], a[120:123], a[184:187]
    ds_read_b64_tr_b16 a[150:151], v141 offset:16800
    v_cvt_pk_bf16_f32 v94, v44, v45
    v_mfma_f32_16x16x32_bf16 a[132:135], v[60:63], a[136:139], a[132:135]
    ds_read_b64_tr_b16 a[152:153], v141 offset:20480
    v_cvt_pk_bf16_f32 v86, v28, v29
    v_mfma_f32_16x16x32_bf16 a[188:191], v[60:63], a[124:127], a[188:191]
    ds_read_b64_tr_b16 a[154:155], v141 offset:20512
    s_mov_b32 s32, 18432
    v_mfma_f32_16x16x32_bf16 v[236:239], v[56:59], a[124:127], v[236:239]
    buffer_store_dwordx4 a[164:167], v135, s[24:27], s32 offen sc1
    v_mfma_f32_16x16x32_bf16 v[232:235], v[56:59], a[120:123], v[232:235]
    v_cvt_pk_bf16_f32 v93, v42, v43
    v_mfma_f32_16x16x32_bf16 v[200:203], v[52:55], a[120:123], v[200:203]
    v_exp_f32 v46, v46
    v_mfma_f32_16x16x32_bf16 v[204:207], v[52:55], a[124:127], v[204:207]
    v_cvt_pk_bf16_f32 v91, v38, v39
    v_cvt_pk_bf16_f32 v95, v46, v47
    v_mfma_f32_16x16x32_bf16 v[172:175], v[48:51], a[124:127], v[172:175]
    v_cvt_pk_bf16_f32 v82, v20, v21
    v_cvt_pk_bf16_f32 v90, v36, v37
    v_mfma_f32_16x16x32_bf16 v[168:171], v[48:51], a[120:123], v[168:171]
    s_waitcnt lgkmcnt(0)
    v_mfma_f32_16x16x32_bf16 v[24:27], a[96:99], a[48:51], v[108:111]
    ds_read_b128 a[112:115], v120 offset:8192
    s_mov_b32 s32, 19456
    v_mfma_f32_16x16x32_bf16 v[24:27], a[100:103], a[52:55], v[24:27]
    ds_read_b64_tr_b16 a[160:161], v141 offset:20736
    v_mfma_f32_16x16x32_bf16 v[24:27], a[104:107], a[56:59], v[24:27]
    ds_read_b128 a[116:119], v121 offset:8192
    v_mfma_f32_16x16x32_bf16 v[24:27], a[108:111], a[60:63], v[24:27]
    ds_read_b128 a[120:123], v122 offset:8192
    v_mfma_f32_16x16x32_bf16 v[32:35], a[108:111], a[76:79], v[112:115]
    ds_read_b64_tr_b16 a[156:157], v141 offset:20608
    v_mfma_f32_16x16x32_bf16 v[32:35], a[104:107], a[72:75], v[32:35]
    ds_read_b128 a[124:127], v123 offset:8192
    v_mfma_f32_16x16x32_bf16 v[32:35], a[100:103], a[68:71], v[32:35]
    buffer_store_dwordx4 a[148:151], v135, s[24:27], s32 offen sc1
    v_mfma_f32_16x16x32_bf16 v[32:35], a[96:99], a[64:67], v[32:35]
    v_exp_f32 v27, v27
    v_mfma_f32_16x16x32_bf16 v[40:43], a[96:99], a[80:83], v[116:119]
    ds_read_b64_tr_b16 a[158:159], v141 offset:20640
    v_mfma_f32_16x16x32_bf16 v[40:43], a[100:103], a[84:87], v[40:43]
    s_waitcnt vmcnt(12)
    s_barrier
    v_mfma_f32_16x16x32_bf16 v[40:43], a[104:107], a[88:91], v[40:43]
    v_exp_f32 v24, v24
    v_mfma_f32_16x16x32_bf16 v[40:43], a[108:111], a[92:95], v[40:43]
    ds_read_b64_tr_b16 a[96:97], v124 offset:16384
    s_waitcnt lgkmcnt(2)
    v_mfma_f32_16x16x32_bf16 v[28:31], a[112:115], a[48:51], v[108:111]
    ds_read_b64_tr_b16 a[98:99], v124 offset:24576
    v_exp_f32 v26, v26
    v_mfma_f32_16x16x32_bf16 v[28:31], a[116:119], a[52:55], v[28:31]
    ds_read_b64_tr_b16 a[100:101], v125 offset:16384
    v_mfma_f32_16x16x32_bf16 v[28:31], a[120:123], a[56:59], v[28:31]
    ds_read_b64_tr_b16 a[102:103], v125 offset:24576
    v_cvt_pk_bf16_f32 v61, v26, v27
    v_mfma_f32_16x16x32_bf16 v[28:31], a[124:127], a[60:63], v[28:31]
    ds_read_b64_tr_b16 a[104:105], v126 offset:16384
    v_exp_f32 v33, v33
    v_mfma_f32_16x16x32_bf16 v[36:39], a[124:127], a[76:79], v[112:115]
    ds_read_b64_tr_b16 a[162:163], v141 offset:20768
    s_waitcnt lgkmcnt(6)
    v_mfma_f32_16x16x32_bf16 v[36:39], a[120:123], a[72:75], v[36:39]
    v_exp_f32 v42, v42
    v_mfma_f32_16x16x32_bf16 v[36:39], a[116:119], a[68:71], v[36:39]
    v_exp_f32 v25, v25
    v_mfma_f32_16x16x32_bf16 v[36:39], a[112:115], a[64:67], v[36:39]
    ds_read_b64_tr_b16 a[106:107], v126 offset:24576
    v_mfma_f32_16x16x32_bf16 v[44:47], a[112:115], a[80:83], v[116:119]
    buffer_store_dwordx4 a[152:155], v135, s[24:27], s32 offen offset:1024 sc1
    v_mfma_f32_16x16x32_bf16 v[44:47], a[116:119], a[84:87], v[44:47]
    v_exp_f32 v34, v34
    v_mfma_f32_16x16x32_bf16 v[44:47], a[120:123], a[88:91], v[44:47]
    ds_read_b64_tr_b16 a[108:109], v127 offset:16384
    v_exp_f32 v30, v30
    v_mfma_f32_16x16x32_bf16 v[44:47], a[124:127], a[92:95], v[44:47]
    ds_read_b64_tr_b16 a[110:111], v127 offset:24576
    s_waitcnt lgkmcnt(5)
    v_mfma_f32_16x16x32_bf16 v[240:243], v[84:87], a[96:99], v[240:243]
    v_exp_f32 v29, v29
    v_mfma_f32_16x16x32_bf16 a[132:135], v[84:87], a[136:139], a[132:135]
    v_exp_f32 v41, v41
    v_mfma_f32_16x16x32_bf16 v[244:247], v[84:87], a[100:103], v[244:247]
    v_exp_f32 v39, v39
    v_mfma_f32_16x16x32_bf16 a[196:199], v[88:91], a[100:103], a[196:199]
    ds_read_b64_tr_b16 a[112:113], v128 offset:16384
    v_exp_f32 v31, v31
    v_mfma_f32_16x16x32_bf16 a[192:195], v[88:91], a[96:99], a[192:195]
    ds_read_b64_tr_b16 a[114:115], v128 offset:24576
    v_exp_f32 v43, v43
    v_mfma_f32_16x16x32_bf16 a[224:227], v[92:95], a[96:99], a[224:227]
    ds_read_b64_tr_b16 a[116:117], v129 offset:16384
    v_exp_f32 v28, v28
    v_mfma_f32_16x16x32_bf16 a[228:231], v[92:95], a[100:103], a[228:231]
    ds_read_b64_tr_b16 a[118:119], v129 offset:24576
    s_waitcnt lgkmcnt(4)
    v_mfma_f32_16x16x32_bf16 a[232:235], v[92:95], a[104:107], a[232:235]
    ds_read_b64_tr_b16 a[120:121], v130 offset:16384
    v_cvt_pk_bf16_f32 v60, v24, v25
    v_mfma_f32_16x16x32_bf16 a[236:239], v[92:95], a[108:111], a[236:239]
    ds_read_b64_tr_b16 a[164:165], v141 offset:20864
    v_cvt_pk_bf16_f32 v69, v42, v43
    v_mfma_f32_16x16x32_bf16 a[204:207], v[88:91], a[108:111], a[204:207]
    v_exp_f32 v35, v35
    v_mfma_f32_16x16x32_bf16 a[132:135], v[88:91], a[140:143], a[132:135]
    ds_read_b64_tr_b16 a[122:123], v130 offset:24576
    v_mfma_f32_16x16x32_bf16 a[200:203], v[88:91], a[104:107], a[200:203]
    buffer_store_dwordx4 a[156:159], v135, s[24:27], s32 offen offset:2048 sc1
    v_mfma_f32_16x16x32_bf16 v[248:251], v[84:87], a[104:107], v[248:251]
    ds_read_b64_tr_b16 a[124:125], v131 offset:16384
    s_waitcnt lgkmcnt(4)
    v_mfma_f32_16x16x32_bf16 v[252:255], v[84:87], a[108:111], v[252:255]
    ds_read_b64_tr_b16 a[126:127], v131 offset:24576
    v_exp_f32 v40, v40
    v_mfma_f32_16x16x32_bf16 a[176:179], v[84:87], a[112:115], a[176:179]
    ds_read_b128 a[96:99], v120 offset:16384
    v_cvt_pk_bf16_f32 v65, v34, v35
    v_mfma_f32_16x16x32_bf16 a[180:183], v[84:87], a[116:119], a[180:183]
    v_exp_f32 v44, v44
    v_mfma_f32_16x16x32_bf16 a[212:215], v[88:91], a[116:119], a[212:215]
    ds_read_b128 a[100:103], v121 offset:16384
    v_mfma_f32_16x16x32_bf16 a[208:211], v[88:91], a[112:115], a[208:211]
    ds_read_b128 a[104:107], v122 offset:16384
    v_mfma_f32_16x16x32_bf16 a[240:243], v[92:95], a[112:115], a[240:243]
    ds_read_b128 a[108:111], v123 offset:16384
    v_exp_f32 v32, v32
    v_mfma_f32_16x16x32_bf16 a[132:135], v[92:95], a[144:147], a[132:135]
    ds_read_b64_tr_b16 a[166:167], v141 offset:20896
    s_waitcnt lgkmcnt(5)
    v_mfma_f32_16x16x32_bf16 a[244:247], v[92:95], a[116:119], a[244:247]
    ds_read_b64_tr_b16 a[172:173], v141 offset:8320
    v_cvt_pk_bf16_f32 v63, v30, v31
    v_mfma_f32_16x16x32_bf16 a[248:251], v[92:95], a[120:123], a[248:251]
    v_exp_f32 v46, v46
    v_mfma_f32_16x16x32_bf16 a[252:255], v[92:95], a[124:127], a[252:255]
    ds_read_b64_tr_b16 a[168:169], v141 offset:8192
    v_cvt_pk_bf16_f32 v64, v32, v33
    v_mfma_f32_16x16x32_bf16 a[220:223], v[88:91], a[124:127], a[220:223]
    v_exp_f32 v38, v38
    v_mfma_f32_16x16x32_bf16 a[216:219], v[88:91], a[120:123], a[216:219]
    v_exp_f32 v37, v37
    v_mfma_f32_16x16x32_bf16 a[184:187], v[84:87], a[120:123], a[184:187]
    ds_read_b64_tr_b16 a[170:171], v141 offset:8224
    s_waitcnt lgkmcnt(4)
    v_mfma_f32_16x16x32_bf16 a[188:191], v[84:87], a[124:127], a[188:191]
    buffer_store_dwordx4 a[160:163], v135, s[24:27], s32 offen offset:3072 sc1
    v_mfma_f32_16x16x32_bf16 v[24:27], a[96:99], a[48:51], v[108:111]
    ds_read_b128 a[112:115], v120 offset:24576
    v_cvt_pk_bf16_f32 v62, v28, v29
    v_mfma_f32_16x16x32_bf16 v[24:27], a[100:103], a[52:55], v[24:27]
    ds_read_b128 a[116:119], v121 offset:24576
    s_mov_b32 s32, 23552
    v_mfma_f32_16x16x32_bf16 v[24:27], a[104:107], a[56:59], v[24:27]
    ds_read_b64_tr_b16 a[148:149], v141 offset:8448
    s_waitcnt lgkmcnt(6)
    v_mfma_f32_16x16x32_bf16 v[24:27], a[108:111], a[60:63], v[24:27]
    v_exp_f32 v36, v36
    v_mfma_f32_16x16x32_bf16 v[32:35], a[108:111], a[76:79], v[112:115]
    ds_read_b128 a[120:123], v122 offset:24576
    v_cvt_pk_bf16_f32 v66, v36, v37
    v_mfma_f32_16x16x32_bf16 v[32:35], a[104:107], a[72:75], v[32:35]
    ds_read_b128 a[124:127], v123 offset:24576
    v_cvt_pk_bf16_f32 v68, v40, v41
    v_mfma_f32_16x16x32_bf16 v[32:35], a[100:103], a[68:71], v[32:35]
    v_exp_f32 v45, v45
    v_mfma_f32_16x16x32_bf16 v[32:35], a[96:99], a[64:67], v[32:35]
    ds_read_b64_tr_b16 a[174:175], v141 offset:8352
    v_cvt_pk_bf16_f32 v67, v38, v39
    v_mfma_f32_16x16x32_bf16 v[40:43], a[96:99], a[80:83], v[116:119]
    v_exp_f32 v47, v47
    v_mfma_f32_16x16x32_bf16 v[40:43], a[100:103], a[84:87], v[40:43]
    s_waitcnt vmcnt(11)
    s_barrier
    v_mfma_f32_16x16x32_bf16 v[40:43], a[104:107], a[88:91], v[40:43]
    v_exp_f32 v27, v27
    v_mfma_f32_16x16x32_bf16 v[40:43], a[108:111], a[92:95], v[40:43]
    ds_read_b64_tr_b16 a[96:97], v124 offset:32768
    s_waitcnt lgkmcnt(2)
    v_mfma_f32_16x16x32_bf16 v[28:31], a[112:115], a[48:51], v[108:111]
    v_exp_f32 v32, v32
    v_mfma_f32_16x16x32_bf16 v[28:31], a[116:119], a[52:55], v[28:31]
L_pad11:
    s_cbranch_vccz L_padret2
    ds_read_b64_tr_b16 a[98:99], v124 offset:40960
    v_mfma_f32_16x16x32_bf16 v[28:31], a[120:123], a[56:59], v[28:31]
    buffer_store_dwordx4 a[164:167], v135, s[24:27], s32 offen sc1
    v_mfma_f32_16x16x32_bf16 v[28:31], a[124:127], a[60:63], v[28:31]
    ds_read_b64_tr_b16 a[100:101], v125 offset:32768
    v_cvt_pk_bf16_f32 v70, v44, v45
    v_mfma_f32_16x16x32_bf16 v[36:39], a[124:127], a[76:79], v[112:115]
    ds_read_b64_tr_b16 a[102:103], v125 offset:40960
    v_cvt_pk_bf16_f32 v71, v46, v47
    v_mfma_f32_16x16x32_bf16 v[36:39], a[120:123], a[72:75], v[36:39]
    ds_read_b64_tr_b16 a[104:105], v126 offset:32768
    v_mfma_f32_16x16x32_bf16 v[36:39], a[116:119], a[68:71], v[36:39]
    ds_read_b64_tr_b16 a[106:107], v126 offset:40960
    v_exp_f32 v34, v34
    v_mfma_f32_16x16x32_bf16 v[36:39], a[112:115], a[64:67], v[36:39]
    ds_read_b64_tr_b16 a[108:109], v127 offset:32768
    v_exp_f32 v40, v40
    v_mfma_f32_16x16x32_bf16 v[44:47], a[112:115], a[80:83], v[116:119]
    ds_read_b64_tr_b16 a[110:111], v127 offset:40960
    v_exp_f32 v26, v26
    v_mfma_f32_16x16x32_bf16 v[44:47], a[116:119], a[84:87], v[44:47]
    v_exp_f32 v43, v43
    v_mfma_f32_16x16x32_bf16 v[44:47], a[120:123], a[88:91], v[44:47]
    ds_read_b64_tr_b16 a[48:49], v128 offset:32768
    s_mov_b32 s32, 8192
    v_mfma_f32_16x16x32_bf16 v[44:47], a[124:127], a[92:95], v[44:47]
    ds_read_b64_tr_b16 a[50:51], v128 offset:40960
    s_waitcnt lgkmcnt(6)
    v_mfma_f32_16x16x32_bf16 v[240:243], v[60:63], a[96:99], v[240:243]
    ds_read_b64_tr_b16 a[52:53], v129 offset:32768
    v_exp_f32 v25, v25
    v_mfma_f32_16x16x32_bf16 a[132:135], v[60:63], a[136:139], a[132:135]
    v_exp_f32 v41, v41
    v_mfma_f32_16x16x32_bf16 v[244:247], v[60:63], a[100:103], v[244:247]
    v_exp_f32 v31, v31
    v_mfma_f32_16x16x32_bf16 a[196:199], v[64:67], a[100:103], a[196:199]
    ds_read_b64_tr_b16 a[54:55], v129 offset:40960
    v_mfma_f32_16x16x32_bf16 a[192:195], v[64:67], a[96:99], a[192:195]
    ds_read_b64_tr_b16 a[56:57], v130 offset:32768
    v_mfma_f32_16x16x32_bf16 a[224:227], v[68:71], a[96:99], a[224:227]
    buffer_store_dwordx4 a[168:171], v135, s[24:27], s32 offen sc1
    ds_read_b64_tr_b16 a[150:151], v141 offset:8480
    ds_read_b64_tr_b16 a[58:59], v130 offset:40960
    v_mfma_f32_16x16x32_bf16 a[228:231], v[68:71], a[100:103], a[228:231]
    ds_read_b64_tr_b16 a[60:61], v131 offset:32768
    s_waitcnt lgkmcnt(8)
    v_mfma_f32_16x16x32_bf16 a[232:235], v[68:71], a[104:107], a[232:235]
    ds_read_b64_tr_b16 a[62:63], v131 offset:40960
    v_exp_f32 v28, v28
    v_mfma_f32_16x16x32_bf16 a[236:239], v[68:71], a[108:111], a[236:239]
    v_exp_f32 v24, v24
    v_mfma_f32_16x16x32_bf16 a[204:207], v[64:67], a[108:111], a[204:207]
    ds_read_b64_tr_b16 a[64:65], v124 offset:31744
    v_exp_f32 v29, v29
    v_mfma_f32_16x16x32_bf16 a[132:135], v[64:67], a[140:143], a[132:135]
    v_exp_f32 v33, v33
    v_mfma_f32_16x16x32_bf16 a[200:203], v[64:67], a[104:107], a[200:203]
    ds_read_b64_tr_b16 a[66:67], v124 offset:39936
    v_cvt_pk_bf16_f32 v88, v32, v33
    v_mfma_f32_16x16x32_bf16 v[248:251], v[60:63], a[104:107], v[248:251]
    ds_read_b64_tr_b16 a[68:69], v125 offset:31744
    v_exp_f32 v36, v36
    v_mfma_f32_16x16x32_bf16 v[252:255], v[60:63], a[108:111], v[252:255]
    ds_read_b64_tr_b16 a[70:71], v125 offset:39936
    s_waitcnt lgkmcnt(4)
    v_mfma_f32_16x16x32_bf16 a[176:179], v[60:63], a[48:51], a[176:179]
    ds_read_b64_tr_b16 a[72:73], v126 offset:31744
    v_exp_f32 v30, v30
    v_mfma_f32_16x16x32_bf16 a[180:183], v[60:63], a[52:55], a[180:183]
    ds_read_b64_tr_b16 a[74:75], v126 offset:39936
    v_cvt_pk_bf16_f32 v87, v30, v31
    v_mfma_f32_16x16x32_bf16 a[212:215], v[64:67], a[52:55], a[212:215]
    ds_read_b64_tr_b16 a[76:77], v127 offset:31744
    v_mfma_f32_16x16x32_bf16 a[208:211], v[64:67], a[48:51], a[208:211]
    ds_read_b64_tr_b16 a[78:79], v127 offset:39936
    v_cvt_pk_bf16_f32 v84, v24, v25
    v_mfma_f32_16x16x32_bf16 a[240:243], v[68:71], a[48:51], a[240:243]
    ds_read_b64_tr_b16 a[80:81], v128 offset:31744
    v_cvt_pk_bf16_f32 v86, v28, v29
    v_mfma_f32_16x16x32_bf16 a[132:135], v[68:71], a[144:147], a[132:135]
    ds_read_b64_tr_b16 a[82:83], v128 offset:39936
    v_mfma_f32_16x16x32_bf16 a[244:247], v[68:71], a[52:55], a[244:247]
    buffer_store_dwordx4 a[172:175], v135, s[24:27], s32 offen offset:1024 sc1
    ds_read_b64_tr_b16 a[84:85], v129 offset:31744
    v_mfma_f32_16x16x32_bf16 a[248:251], v[68:71], a[56:59], a[248:251]
    ds_read_b64_tr_b16 a[86:87], v129 offset:39936
    v_cvt_pk_bf16_f32 v85, v26, v27
    v_mfma_f32_16x16x32_bf16 a[252:255], v[68:71], a[60:63], a[252:255]
    ds_read_b64_tr_b16 a[88:89], v130 offset:31744
    v_cvt_pk_bf16_f32 v92, v40, v41
    v_mfma_f32_16x16x32_bf16 a[220:223], v[64:67], a[60:63], a[220:223]
    ds_read_b64_tr_b16 a[90:91], v130 offset:39936
    v_exp_f32 v39, v39
    v_mfma_f32_16x16x32_bf16 a[216:219], v[64:67], a[56:59], a[216:219]
    ds_read_b64_tr_b16 a[92:93], v131 offset:31744
    s_waitcnt lgkmcnt(7)
    v_mfma_f32_16x16x32_bf16 a[184:187], v[60:63], a[56:59], a[184:187]
    ds_read_b64_tr_b16 a[94:95], v131 offset:39936
    v_mfma_f32_16x16x32_bf16 a[188:191], v[60:63], a[60:63], a[188:191]
    v_exp_f32 v38, v38
    v_mfma_f32_16x16x32_bf16 a[132:135], v[84:87], a[136:139], a[132:135]
    v_exp_f32 v37, v37
    v_mfma_f32_16x16x32_bf16 v[240:243], v[84:87], a[64:67], v[240:243]
    v_exp_f32 v44, v44
    v_mfma_f32_16x16x32_bf16 v[244:247], v[84:87], a[68:71], v[244:247]
    v_exp_f32 v35, v35
    v_mfma_f32_16x16x32_bf16 v[248:251], v[84:87], a[72:75], v[248:251]
    v_exp_f32 v42, v42
    v_mfma_f32_16x16x32_bf16 v[252:255], v[84:87], a[76:79], v[252:255]
    s_waitcnt lgkmcnt(0)
    v_cvt_pk_bf16_f32 v90, v36, v37
    v_mfma_f32_16x16x32_bf16 a[176:179], v[84:87], a[80:83], a[176:179]
    v_cvt_pk_bf16_f32 v91, v38, v39
    v_mfma_f32_16x16x32_bf16 a[180:183], v[84:87], a[84:87], a[180:183]
    ds_read_b64_tr_b16 a[152:153], v141 offset:8576
    v_cvt_pk_bf16_f32 v89, v34, v35
    v_mfma_f32_16x16x32_bf16 a[184:187], v[84:87], a[88:91], a[184:187]
    ds_read_b128 a[96:99], v120
    v_mfma_f32_16x16x32_bf16 a[188:191], v[84:87], a[92:95], a[188:191]
    buffer_store_dwordx4 a[148:151], v135, s[24:27], s32 offen offset:2048 sc1
    v_mfma_f32_16x16x32_bf16 a[132:135], v[88:91], a[140:143], a[132:135]
    ds_read_b64_tr_b16 a[154:155], v141 offset:8608
    v_cvt_pk_bf16_f32 v93, v42, v43
    v_mfma_f32_16x16x32_bf16 a[192:195], v[88:91], a[64:67], a[192:195]
    v_exp_f32 v6, v6
    v_mfma_f32_16x16x32_bf16 a[196:199], v[88:91], a[68:71], a[196:199]
    v_exp_f32 v45, v45
    v_mfma_f32_16x16x32_bf16 a[200:203], v[88:91], a[72:75], a[200:203]
    v_exp_f32 v46, v46
    v_mfma_f32_16x16x32_bf16 a[204:207], v[88:91], a[76:79], a[204:207]
    v_exp_f32 v4, v4
    v_mfma_f32_16x16x32_bf16 a[208:211], v[88:91], a[80:83], a[208:211]
    ds_read_b128 a[100:103], v121
    v_cvt_pk_bf16_f32 v94, v44, v45
    v_mfma_f32_16x16x32_bf16 a[212:215], v[88:91], a[84:87], a[212:215]
    v_exp_f32 v47, v47
    v_mfma_f32_16x16x32_bf16 a[216:219], v[88:91], a[88:91], a[216:219]
    ds_read_b128 a[104:107], v122
    v_cvt_pk_bf16_f32 v95, v46, v47
    v_mfma_f32_16x16x32_bf16 a[220:223], v[88:91], a[92:95], a[220:223]
    ds_read_b128 a[108:111], v123
    s_waitcnt lgkmcnt(3)
    v_mfma_f32_16x16x32_bf16 a[132:135], v[92:95], a[144:147], a[132:135]
    v_exp_f32 v5, v5
    v_mfma_f32_16x16x32_bf16 a[224:227], v[92:95], a[64:67], a[224:227]
    ds_read_b128 a[112:115], v120 offset:8192
    v_mfma_f32_16x16x32_bf16 a[228:231], v[92:95], a[68:71], a[228:231]
    v_cvt_pk_bf16_f32 v74, v4, v5
    v_mfma_f32_16x16x32_bf16 a[232:235], v[92:95], a[72:75], a[232:235]
    v_exp_f32 v7, v7
    v_mfma_f32_16x16x32_bf16 a[236:239], v[92:95], a[76:79], a[236:239]
    v_mfma_f32_16x16x32_bf16 a[240:243], v[92:95], a[80:83], a[240:243]
    buffer_store_dwordx4 a[152:155], v135, s[24:27], s32 offen offset:3072 sc1
    v_mfma_f32_16x16x32_bf16 a[244:247], v[92:95], a[84:87], a[244:247]
    ds_read_b128 a[116:119], v121 offset:8192
    v_accvgpr_read_b32 v108, a132
    v_mfma_f32_16x16x32_bf16 a[248:251], v[92:95], a[88:91], a[248:251]
    ds_read_b128 a[120:123], v122 offset:8192
    v_cvt_pk_bf16_f32 v75, v6, v7
    v_mfma_f32_16x16x32_bf16 a[252:255], v[92:95], a[92:95], a[252:255]
    ds_read_b128 a[124:127], v123 offset:8192
    v_accvgpr_read_b32 v109, a133
    v_accvgpr_read_b32 v110, a134
    v_accvgpr_read_b32 v111, a135
    v_add_f32 v116, v108, v109
    v_add_f32 v116, v116, v110
    v_add_f32 v116, v116, v111
    v_rcp_f32 v108, v108
    v_rcp_f32 v109, v109
    v_rcp_f32 v110, v110
    v_rcp_f32 v111, v111
    v_cmp_nlt_f32 s[40:41], v116, s37
    s_nop 0
    s_cmp_lg_u64 s[40:41], 0
    s_cselect_b32 s33, 2, 0
    s_or_b32 s36, s36, s33
    v_mov_b64_dpp v[112:113], v[108:109] row_newbcast:0 row_mask:0xf bank_mask:0xf
    v_mov_b64_dpp v[114:115], v[110:111] row_newbcast:0 row_mask:0xf bank_mask:0xf
    v_pk_mul_f32 v[240:241], v[240:241], v[112:113]
    v_pk_mul_f32 v[242:243], v[242:243], v[114:115]
    v_pk_mul_f32 v[244:245], v[244:245], v[112:113]
    v_pk_mul_f32 v[246:247], v[246:247], v[114:115]
    v_pk_mul_f32 v[248:249], v[248:249], v[112:113]
    v_pk_mul_f32 v[250:251], v[250:251], v[114:115]
    v_pk_mul_f32 v[252:253], v[252:253], v[112:113]
    v_pk_mul_f32 v[254:255], v[254:255], v[114:115]
    v_cvt_pk_bf16_f32 v40, v240, v244
    v_cvt_pk_bf16_f32 v41, v248, v252
    v_cvt_pk_bf16_f32 v42, v241, v245
    v_cvt_pk_bf16_f32 v43, v249, v253
    v_cvt_pk_bf16_f32 v44, v242, v246
    v_cvt_pk_bf16_f32 v45, v250, v254
    v_cvt_pk_bf16_f32 v46, v243, v247
    v_cvt_pk_bf16_f32 v47, v251, v255
    ds_write2st64_b64 v140, v[40:41], v[42:43] offset0:24 offset1:25
    ds_write2st64_b64 v140, v[44:45], v[46:47] offset0:26 offset1:27
    v_accvgpr_read_b32 v24, a176
    v_accvgpr_read_b32 v25, a177
    v_accvgpr_read_b32 v26, a178
    v_accvgpr_read_b32 v27, a179
    v_accvgpr_read_b32 v28, a180
    v_accvgpr_read_b32 v29, a181
    v_accvgpr_read_b32 v30, a182
    v_accvgpr_read_b32 v31, a183
    v_accvgpr_read_b32 v32, a184
    v_accvgpr_read_b32 v33, a185
    v_accvgpr_read_b32 v34, a186
    v_accvgpr_read_b32 v35, a187
    v_accvgpr_read_b32 v36, a188
    v_accvgpr_read_b32 v37, a189
    v_accvgpr_read_b32 v38, a190
    v_accvgpr_read_b32 v39, a191
    v_pk_mul_f32 v[24:25], v[24:25], v[112:113]
    v_pk_mul_f32 v[26:27], v[26:27], v[114:115]
    v_pk_mul_f32 v[28:29], v[28:29], v[112:113]
    v_pk_mul_f32 v[30:31], v[30:31], v[114:115]
    v_pk_mul_f32 v[32:33], v[32:33], v[112:113]
    v_pk_mul_f32 v[34:35], v[34:35], v[114:115]
    v_pk_mul_f32 v[36:37], v[36:37], v[112:113]
    v_pk_mul_f32 v[38:39], v[38:39], v[114:115]
    v_cvt_pk_bf16_f32 v40, v24, v28
    v_cvt_pk_bf16_f32 v41, v32, v36
    v_cvt_pk_bf16_f32 v42, v25, v29
    v_cvt_pk_bf16_f32 v43, v33, v37
    v_cvt_pk_bf16_f32 v44, v26, v30
    v_cvt_pk_bf16_f32 v45, v34, v38
    v_cvt_pk_bf16_f32 v46, v27, v31
    v_cvt_pk_bf16_f32 v47, v35, v39
    ds_write2st64_b64 v140, v[40:41], v[42:43] offset0:28 offset1:29
    ds_write2st64_b64 v140, v[44:45], v[46:47] offset0:30 offset1:31
    v_mov_b64_dpp v[112:113], v[108:109] row_newbcast:1 row_mask:0xf bank_mask:0xf
    v_mov_b64_dpp v[114:115], v[110:111] row_newbcast:1 row_mask:0xf bank_mask:0xf
    v_accvgpr_read_b32 v24, a192
    v_accvgpr_read_b32 v25, a193
    v_accvgpr_read_b32 v26, a194
    v_accvgpr_read_b32 v27, a195
    v_accvgpr_read_b32 v28, a196
    v_accvgpr_read_b32 v29, a197
    v_accvgpr_read_b32 v30, a198
    v_accvgpr_read_b32 v31, a199
    ds_read_b64_tr_b16 a[148:149], v141 offset:12288
    ds_read_b64_tr_b16 a[150:151], v141 offset:12320
    ds_read_b64_tr_b16 a[152:153], v141 offset:12416
    ds_read_b64_tr_b16 a[154:155], v141 offset:12448
    ds_read_b64_tr_b16 a[156:157], v141 offset:12544
    ds_read_b64_tr_b16 a[158:159], v141 offset:12576
    ds_read_b64_tr_b16 a[160:161], v141 offset:12672
    ds_read_b64_tr_b16 a[162:163], v141 offset:12704
    v_accvgpr_read_b32 v32, a200
    v_accvgpr_read_b32 v33, a201
    v_accvgpr_read_b32 v34, a202
    v_accvgpr_read_b32 v35, a203
    v_accvgpr_read_b32 v36, a204
    v_accvgpr_read_b32 v37, a205
    v_accvgpr_read_b32 v38, a206
    v_accvgpr_read_b32 v39, a207
    v_pk_mul_f32 v[24:25], v[24:25], v[112:113]
    v_pk_mul_f32 v[26:27], v[26:27], v[114:115]
    v_pk_mul_f32 v[28:29], v[28:29], v[112:113]
    v_pk_mul_f32 v[30:31], v[30:31], v[114:115]
    v_pk_mul_f32 v[32:33], v[32:33], v[112:113]
    v_pk_mul_f32 v[34:35], v[34:35], v[114:115]
    v_pk_mul_f32 v[36:37], v[36:37], v[112:113]
    v_pk_mul_f32 v[38:39], v[38:39], v[114:115]
    v_cvt_pk_bf16_f32 v40, v24, v28
    v_cvt_pk_bf16_f32 v41, v32, v36
    v_cvt_pk_bf16_f32 v42, v25, v29
    v_cvt_pk_bf16_f32 v43, v33, v37
    v_cvt_pk_bf16_f32 v44, v26, v30
    v_cvt_pk_bf16_f32 v45, v34, v38
    v_cvt_pk_bf16_f32 v46, v27, v31
    v_cvt_pk_bf16_f32 v47, v35, v39
    ds_write2st64_b64 v140, v[40:41], v[42:43] offset0:32 offset1:33
    ds_write2st64_b64 v140, v[44:45], v[46:47] offset0:34 offset1:35
    s_mov_b32 s32, 110592
    s_waitcnt lgkmcnt(2)
    buffer_store_dwordx4 a[148:151], v135, s[24:27], s32 offen sc1
    v_accvgpr_read_b32 v24, a208
    v_accvgpr_read_b32 v25, a209
    v_accvgpr_read_b32 v26, a210
    v_accvgpr_read_b32 v27, a211
    v_accvgpr_read_b32 v28, a212
    v_accvgpr_read_b32 v29, a213
    v_accvgpr_read_b32 v30, a214
    v_accvgpr_read_b32 v31, a215
    v_accvgpr_read_b32 v32, a216
    v_accvgpr_read_b32 v33, a217
    v_accvgpr_read_b32 v34, a218
    v_accvgpr_read_b32 v35, a219
    v_accvgpr_read_b32 v36, a220
    v_accvgpr_read_b32 v37, a221
    v_accvgpr_read_b32 v38, a222
    v_accvgpr_read_b32 v39, a223
    v_pk_mul_f32 v[24:25], v[24:25], v[112:113]
    v_pk_mul_f32 v[26:27], v[26:27], v[114:115]
    v_pk_mul_f32 v[28:29], v[28:29], v[112:113]
    v_pk_mul_f32 v[30:31], v[30:31], v[114:115]
    v_pk_mul_f32 v[32:33], v[32:33], v[112:113]
    v_pk_mul_f32 v[34:35], v[34:35], v[114:115]
    v_pk_mul_f32 v[36:37], v[36:37], v[112:113]
    v_pk_mul_f32 v[38:39], v[38:39], v[114:115]
    v_cvt_pk_bf16_f32 v40, v24, v28
    v_cvt_pk_bf16_f32 v41, v32, v36
    v_cvt_pk_bf16_f32 v42, v25, v29
    v_cvt_pk_bf16_f32 v43, v33, v37
    v_cvt_pk_bf16_f32 v44, v26, v30
    v_cvt_pk_bf16_f32 v45, v34, v38
    v_cvt_pk_bf16_f32 v46, v27, v31
    v_cvt_pk_bf16_f32 v47, v35, v39
    ds_write2st64_b64 v140, v[40:41], v[42:43] offset0:36 offset1:37
    ds_write2st64_b64 v140, v[44:45], v[46:47] offset0:38 offset1:39
    buffer_store_dwordx4 a[152:155], v135, s[24:27], s32 offen offset:1024 sc1
    v_mov_b64_dpp v[112:113], v[108:109] row_newbcast:2 row_mask:0xf bank_mask:0xf
    v_mov_b64_dpp v[114:115], v[110:111] row_newbcast:2 row_mask:0xf bank_mask:0xf
    v_accvgpr_read_b32 v24, a224
    v_accvgpr_read_b32 v25, a225
    v_accvgpr_read_b32 v26, a226
    v_accvgpr_read_b32 v27, a227
    v_accvgpr_read_b32 v28, a228
    v_accvgpr_read_b32 v29, a229
    v_accvgpr_read_b32 v30, a230
    v_accvgpr_read_b32 v31, a231
    v_accvgpr_read_b32 v32, a232
    v_accvgpr_read_b32 v33, a233
    v_accvgpr_read_b32 v34, a234
    v_accvgpr_read_b32 v35, a235
    v_accvgpr_read_b32 v36, a236
    v_accvgpr_read_b32 v37, a237
    v_accvgpr_read_b32 v38, a238
    v_accvgpr_read_b32 v39, a239
    v_pk_mul_f32 v[24:25], v[24:25], v[112:113]
    v_pk_mul_f32 v[26:27], v[26:27], v[114:115]
    v_pk_mul_f32 v[28:29], v[28:29], v[112:113]
    v_pk_mul_f32 v[30:31], v[30:31], v[114:115]
    v_pk_mul_f32 v[32:33], v[32:33], v[112:113]
    v_pk_mul_f32 v[34:35], v[34:35], v[114:115]
    v_pk_mul_f32 v[36:37], v[36:37], v[112:113]
    v_pk_mul_f32 v[38:39], v[38:39], v[114:115]
    v_cvt_pk_bf16_f32 v40, v24, v28
    v_cvt_pk_bf16_f32 v41, v32, v36
    v_cvt_pk_bf16_f32 v42, v25, v29
    v_cvt_pk_bf16_f32 v43, v33, v37
    v_cvt_pk_bf16_f32 v44, v26, v30
    v_cvt_pk_bf16_f32 v45, v34, v38
    v_cvt_pk_bf16_f32 v46, v27, v31
    v_cvt_pk_bf16_f32 v47, v35, v39
    ds_write2st64_b64 v140, v[40:41], v[42:43] offset0:40 offset1:41
    ds_write2st64_b64 v140, v[44:45], v[46:47] offset0:42 offset1:43
    buffer_store_dwordx4 a[156:159], v135, s[24:27], s32 offen offset:2048 sc1
    v_accvgpr_read_b32 v24, a240
    v_accvgpr_read_b32 v25, a241
    v_accvgpr_read_b32 v26, a242
    v_accvgpr_read_b32 v27, a243
    v_accvgpr_read_b32 v28, a244
    v_accvgpr_read_b32 v29, a245
    v_accvgpr_read_b32 v30, a246
    v_accvgpr_read_b32 v31, a247
    v_accvgpr_read_b32 v32, a248
    v_accvgpr_read_b32 v33, a249
    v_accvgpr_read_b32 v34, a250
    v_accvgpr_read_b32 v35, a251
    v_accvgpr_read_b32 v36, a252
    v_accvgpr_read_b32 v37, a253
    v_accvgpr_read_b32 v38, a254
    v_accvgpr_read_b32 v39, a255
    v_pk_mul_f32 v[24:25], v[24:25], v[112:113]
    v_pk_mul_f32 v[26:27], v[26:27], v[114:115]
    v_pk_mul_f32 v[28:29], v[28:29], v[112:113]
    v_pk_mul_f32 v[30:31], v[30:31], v[114:115]
    v_pk_mul_f32 v[32:33], v[32:33], v[112:113]
    v_pk_mul_f32 v[34:35], v[34:35], v[114:115]
    v_pk_mul_f32 v[36:37], v[36:37], v[112:113]
    v_pk_mul_f32 v[38:39], v[38:39], v[114:115]
    v_cvt_pk_bf16_f32 v40, v24, v28
    v_cvt_pk_bf16_f32 v41, v32, v36
    v_cvt_pk_bf16_f32 v42, v25, v29
    v_cvt_pk_bf16_f32 v43, v33, v37
    v_cvt_pk_bf16_f32 v44, v26, v30
    v_cvt_pk_bf16_f32 v45, v34, v38
    v_cvt_pk_bf16_f32 v46, v27, v31
    v_cvt_pk_bf16_f32 v47, v35, v39
    ds_write2st64_b64 v140, v[40:41], v[42:43] offset0:44 offset1:45
    ds_write2st64_b64 v140, v[44:45], v[46:47] offset0:46 offset1:47
    buffer_store_dwordx4 a[160:163], v135, s[24:27], s32 offen offset:3072 sc1
    s_waitcnt lgkmcnt(0)
    v_mfma_f32_16x16x32_bf16 v[0:3], a[96:99], a[0:3], v[96:99]
    ds_read_b64_tr_b16 a[148:149], v141 offset:16384
    v_exp_f32 v12, v12
    v_mfma_f32_16x16x32_bf16 v[0:3], a[100:103], a[4:7], v[0:3]
    v_exp_f32 v15, v15
    v_mfma_f32_16x16x32_bf16 v[0:3], a[104:107], a[8:11], v[0:3]
    ds_read_b64_tr_b16 a[150:151], v141 offset:16416
    v_mfma_f32_16x16x32_bf16 v[0:3], a[108:111], a[12:15], v[0:3]
    ds_read_b64_tr_b16 a[152:153], v141 offset:16512
    ds_read_b64_tr_b16 a[156:157], v141 offset:16640
    v_mfma_f32_16x16x32_bf16 v[8:11], a[108:111], a[28:31], v[100:103]
    ds_read_b64_tr_b16 a[176:177], v124 offset:16384
    s_mov_b32 s32, 114688
    v_mfma_f32_16x16x32_bf16 v[8:11], a[104:107], a[24:27], v[8:11]
    ds_read_b64_tr_b16 a[158:159], v141 offset:16672
    ds_read_b64_tr_b16 a[178:179], v124 offset:24576
    v_mfma_f32_16x16x32_bf16 v[8:11], a[100:103], a[20:23], v[8:11]
    ds_read_b64_tr_b16 a[180:181], v125 offset:16384
    v_mfma_f32_16x16x32_bf16 v[8:11], a[96:99], a[16:19], v[8:11]
    v_exp_f32 v2, v2
    v_mfma_f32_16x16x32_bf16 v[16:19], a[96:99], a[32:35], v[104:107]
    ds_read_b64_tr_b16 a[182:183], v125 offset:24576
    v_exp_f32 v0, v0
    v_mfma_f32_16x16x32_bf16 v[16:19], a[100:103], a[36:39], v[16:19]
    ds_read_b64_tr_b16 a[184:185], v126 offset:16384
    s_waitcnt lgkmcnt(8)
    v_mfma_f32_16x16x32_bf16 v[16:19], a[104:107], a[40:43], v[16:19]
    buffer_store_dwordx4 a[148:151], v135, s[24:27], s32 offen sc1
    ds_read_b64_tr_b16 a[186:187], v126 offset:24576
    v_mfma_f32_16x16x32_bf16 v[16:19], a[108:111], a[44:47], v[16:19]
    ds_read_b64_tr_b16 a[188:189], v127 offset:16384
    v_exp_f32 v14, v14
    v_mfma_f32_16x16x32_bf16 v[4:7], a[112:115], a[0:3], v[96:99]
    ds_read_b64_tr_b16 a[190:191], v127 offset:24576
    v_exp_f32 v3, v3
    v_mfma_f32_16x16x32_bf16 v[4:7], a[116:119], a[4:7], v[4:7]
    v_exp_f32 v13, v13
    v_mfma_f32_16x16x32_bf16 v[4:7], a[120:123], a[8:11], v[4:7]
    ds_read_b64_tr_b16 a[154:155], v141 offset:16544
    v_cvt_pk_bf16_f32 v78, v12, v13
    v_mfma_f32_16x16x32_bf16 v[4:7], a[124:127], a[12:15], v[4:7]
    ds_read_b64_tr_b16 a[192:193], v128 offset:16384
    v_cvt_pk_bf16_f32 v79, v14, v15
    v_mfma_f32_16x16x32_bf16 v[12:15], a[124:127], a[28:31], v[100:103]
    v_exp_f32 v8, v8
    v_mfma_f32_16x16x32_bf16 v[12:15], a[120:123], a[24:27], v[12:15]
    v_exp_f32 v17, v17
    v_mfma_f32_16x16x32_bf16 v[12:15], a[116:119], a[20:23], v[12:15]
    v_exp_f32 v9, v9
    v_mfma_f32_16x16x32_bf16 v[12:15], a[112:115], a[16:19], v[12:15]
    ds_read_b64_tr_b16 a[194:195], v128 offset:24576
    v_mfma_f32_16x16x32_bf16 v[20:23], a[112:115], a[32:35], v[104:107]
    ds_read_b64_tr_b16 a[160:161], v141 offset:16768
    v_mfma_f32_16x16x32_bf16 v[20:23], a[116:119], a[36:39], v[20:23]
    ds_read_b64_tr_b16 a[196:197], v129 offset:16384
    v_mfma_f32_16x16x32_bf16 v[20:23], a[120:123], a[40:43], v[20:23]
    ds_read_b64_tr_b16 a[198:199], v129 offset:24576
    s_waitcnt lgkmcnt(6)
    v_mfma_f32_16x16x32_bf16 v[20:23], a[124:127], a[44:47], v[20:23]
    ds_read_b64_tr_b16 a[200:201], v130 offset:16384
    s_waitcnt lgkmcnt(6)
    v_mfma_f32_16x16x32_bf16 v[144:147], v[72:75], a[176:179], v[144:147]
    ds_read_b64_tr_b16 a[202:203], v130 offset:24576
    v_mfma_f32_16x16x32_bf16 a[128:131], v[72:75], a[136:139], a[128:131]
    ds_read_b64_tr_b16 a[204:205], v131 offset:16384
    v_mfma_f32_16x16x32_bf16 v[148:151], v[72:75], a[180:183], v[148:151]
    buffer_store_dwordx4 a[152:155], v135, s[24:27], s32 offen offset:1024 sc1
    ds_read_b64_tr_b16 a[206:207], v131 offset:24576
    v_mfma_f32_16x16x32_bf16 v[180:183], v[76:79], a[180:183], v[180:183]
    v_exp_f32 v4, v4
    v_mfma_f32_16x16x32_bf16 v[176:179], v[76:79], a[176:179], v[176:179]
    v_exp_f32 v1, v1
    v_mfma_f32_16x16x32_bf16 v[208:211], v[80:83], a[176:179], v[208:211]
    v_exp_f32 v20, v20
    v_mfma_f32_16x16x32_bf16 v[212:215], v[80:83], a[180:183], v[212:215]
    ds_read_b128 a[208:211], v120 offset:16384
    v_mfma_f32_16x16x32_bf16 v[216:219], v[80:83], a[184:187], v[216:219]
    v_exp_f32 v19, v19
    v_mfma_f32_16x16x32_bf16 v[220:223], v[80:83], a[188:191], v[220:223]
    ds_read_b128 a[212:215], v121 offset:16384
    v_cvt_pk_bf16_f32 v52, v8, v9
    v_mfma_f32_16x16x32_bf16 v[188:191], v[76:79], a[188:191], v[188:191]
    ds_read_b128 a[216:219], v122 offset:16384
    v_cvt_pk_bf16_f32 v48, v0, v1
    v_mfma_f32_16x16x32_bf16 a[128:131], v[76:79], a[140:143], a[128:131]
    ds_read_b128 a[220:223], v123 offset:16384
    v_exp_f32 v11, v11
    v_mfma_f32_16x16x32_bf16 v[184:187], v[76:79], a[184:187], v[184:187]
    ds_read_b128 a[224:227], v120 offset:24576
    s_waitcnt lgkmcnt(5)
    v_mfma_f32_16x16x32_bf16 v[152:155], v[72:75], a[184:187], v[152:155]
    v_exp_f32 v16, v16
    v_mfma_f32_16x16x32_bf16 v[156:159], v[72:75], a[188:191], v[156:159]
    ds_read_b64_tr_b16 a[162:163], v141 offset:16800
    v_mfma_f32_16x16x32_bf16 v[160:163], v[72:75], a[192:195], v[160:163]
    v_exp_f32 v10, v10
    v_mfma_f32_16x16x32_bf16 v[164:167], v[72:75], a[196:199], v[164:167]
    v_exp_f32 v15, v15
    v_mfma_f32_16x16x32_bf16 v[196:199], v[76:79], a[196:199], v[196:199]
    v_exp_f32 v6, v6
    v_mfma_f32_16x16x32_bf16 v[192:195], v[76:79], a[192:195], v[192:195]
    ds_read_b64_tr_b16 a[168:169], v141 offset:20608
    v_cvt_pk_bf16_f32 v49, v2, v3
    v_mfma_f32_16x16x32_bf16 v[224:227], v[80:83], a[192:195], v[224:227]
    ds_read_b128 a[228:231], v121 offset:24576
    v_mfma_f32_16x16x32_bf16 a[128:131], v[80:83], a[144:147], a[128:131]
    buffer_store_dwordx4 a[156:159], v135, s[24:27], s32 offen offset:2048 sc1
    v_mfma_f32_16x16x32_bf16 v[228:231], v[80:83], a[196:199], v[228:231]
    ds_read_b128 a[232:235], v122 offset:24576
    v_cvt_pk_bf16_f32 v56, v16, v17
    v_mfma_f32_16x16x32_bf16 v[232:235], v[80:83], a[200:203], v[232:235]
    ds_read_b128 a[236:239], v123 offset:24576
    s_waitcnt lgkmcnt(6)
    v_mfma_f32_16x16x32_bf16 v[236:239], v[80:83], a[204:207], v[236:239]
    ds_read_b64_tr_b16 a[240:241], v124 offset:32768
    v_cvt_pk_bf16_f32 v53, v10, v11
    v_mfma_f32_16x16x32_bf16 v[204:207], v[76:79], a[204:207], v[204:207]
    ds_read_b64_tr_b16 a[170:171], v141 offset:20640
    s_waitcnt lgkmcnt(6)
    v_mfma_f32_16x16x32_bf16 v[200:203], v[76:79], a[200:203], v[200:203]
    v_exp_f32 v13, v13
    v_mfma_f32_16x16x32_bf16 v[168:171], v[72:75], a[200:203], v[168:171]
    v_exp_f32 v7, v7
    v_mfma_f32_16x16x32_bf16 v[172:175], v[72:75], a[204:207], v[172:175]
    v_exp_f32 v21, v21
    v_mfma_f32_16x16x32_bf16 v[0:3], a[208:211], a[0:3], v[96:99]
    v_exp_f32 v18, v18
    v_mfma_f32_16x16x32_bf16 v[0:3], a[212:215], a[4:7], v[0:3]
    v_exp_f32 v23, v23
    v_mfma_f32_16x16x32_bf16 v[0:3], a[216:219], a[8:11], v[0:3]
    v_exp_f32 v5, v5
    v_mfma_f32_16x16x32_bf16 v[0:3], a[220:223], a[12:15], v[0:3]
    ds_read_b64_tr_b16 a[242:243], v124 offset:40960
    v_cvt_pk_bf16_f32 v57, v18, v19
    v_mfma_f32_16x16x32_bf16 v[8:11], a[220:223], a[28:31], v[100:103]
    v_exp_f32 v14, v14
    v_mfma_f32_16x16x32_bf16 v[8:11], a[216:219], a[24:27], v[8:11]
    v_exp_f32 v22, v22
    v_mfma_f32_16x16x32_bf16 v[8:11], a[212:215], a[20:23], v[8:11]
    ds_read_b64_tr_b16 a[172:173], v141 offset:20736
    v_cvt_pk_bf16_f32 v50, v4, v5
    v_mfma_f32_16x16x32_bf16 v[8:11], a[208:211], a[16:19], v[8:11]
    ds_read_b64_tr_b16 a[244:245], v125 offset:32768
    v_mfma_f32_16x16x32_bf16 v[16:19], a[208:211], a[32:35], v[104:107]
    buffer_store_dwordx4 a[160:163], v135, s[24:27], s32 offen offset:3072 sc1
    v_mfma_f32_16x16x32_bf16 v[16:19], a[212:215], a[36:39], v[16:19]
    ds_read_b64_tr_b16 a[246:247], v125 offset:40960
    s_waitcnt lgkmcnt(6)
    v_mfma_f32_16x16x32_bf16 v[16:19], a[216:219], a[40:43], v[16:19]
    ds_read_b64_tr_b16 a[164:165], v141 offset:20480
    v_mfma_f32_16x16x32_bf16 v[16:19], a[220:223], a[44:47], v[16:19]
    ds_read_b64_tr_b16 a[248:249], v126 offset:32768
    v_cvt_pk_bf16_f32 v51, v6, v7
    v_mfma_f32_16x16x32_bf16 v[4:7], a[224:227], a[0:3], v[96:99]
    v_exp_f32 v12, v12
    v_mfma_f32_16x16x32_bf16 v[4:7], a[228:231], a[4:7], v[4:7]
    ds_read_b64_tr_b16 a[166:167], v141 offset:20512
    v_cvt_pk_bf16_f32 v54, v12, v13
    v_mfma_f32_16x16x32_bf16 v[4:7], a[232:235], a[8:11], v[4:7]
    v_exp_f32 v3, v3
    v_mfma_f32_16x16x32_bf16 v[4:7], a[236:239], a[12:15], v[4:7]
    ds_read_b64_tr_b16 a[250:251], v126 offset:40960
    v_cvt_pk_bf16_f32 v55, v14, v15
    v_mfma_f32_16x16x32_bf16 v[12:15], a[236:239], a[28:31], v[100:103]
    ds_read_b64_tr_b16 a[252:253], v127 offset:32768
    s_mov_b32 s32, 118784
    v_mfma_f32_16x16x32_bf16 v[12:15], a[232:235], a[24:27], v[12:15]
    ds_read_b64_tr_b16 a[254:255], v127 offset:40960
    v_cvt_pk_bf16_f32 v58, v20, v21
    v_mfma_f32_16x16x32_bf16 v[12:15], a[228:231], a[20:23], v[12:15]
L_pad12:
    s_cbranch_vccz L_padret2
    v_cvt_pk_bf16_f32 v59, v22, v23
    v_mfma_f32_16x16x32_bf16 v[12:15], a[224:227], a[16:19], v[12:15]
    v_exp_f32 v2, v2
    v_mfma_f32_16x16x32_bf16 v[20:23], a[224:227], a[32:35], v[104:107]
    v_exp_f32 v11, v11
    v_mfma_f32_16x16x32_bf16 v[20:23], a[228:231], a[36:39], v[20:23]
    v_exp_f32 v5, v5
    v_mfma_f32_16x16x32_bf16 v[20:23], a[232:235], a[40:43], v[20:23]
    v_exp_f32 v16, v16
    v_mfma_f32_16x16x32_bf16 v[20:23], a[236:239], a[44:47], v[20:23]
    s_waitcnt lgkmcnt(0)
    v_mfma_f32_16x16x32_bf16 v[144:147], v[48:51], a[240:243], v[144:147]
    v_mfma_f32_16x16x32_bf16 a[128:131], v[48:51], a[136:139], a[128:131]
    buffer_store_dwordx4 a[164:167], v135, s[24:27], s32 offen sc1
    v_mfma_f32_16x16x32_bf16 v[148:151], v[48:51], a[244:247], v[148:151]
    v_exp_f32 v12, v12
    v_mfma_f32_16x16x32_bf16 v[180:183], v[52:55], a[244:247], v[180:183]
    v_exp_f32 v13, v13
    v_mfma_f32_16x16x32_bf16 v[176:179], v[52:55], a[240:243], v[176:179]
    v_exp_f32 v15, v15
    v_mfma_f32_16x16x32_bf16 v[208:211], v[56:59], a[240:243], v[208:211]
    v_mfma_f32_16x16x32_bf16 v[212:215], v[56:59], a[244:247], v[212:215]
    v_exp_f32 v23, v23
    v_mfma_f32_16x16x32_bf16 v[216:219], v[56:59], a[248:251], v[216:219]
    v_exp_f32 v14, v14
    v_mfma_f32_16x16x32_bf16 v[220:223], v[56:59], a[252:255], v[220:223]
    v_exp_f32 v1, v1
    v_mfma_f32_16x16x32_bf16 v[188:191], v[52:55], a[252:255], v[188:191]
    v_exp_f32 v0, v0
    v_mfma_f32_16x16x32_bf16 a[128:131], v[52:55], a[140:143], a[128:131]
    ds_read_b64_tr_b16 a[174:175], v141 offset:20768
    v_mfma_f32_16x16x32_bf16 v[184:187], v[52:55], a[248:251], v[184:187]
    v_exp_f32 v7, v7
    v_mfma_f32_16x16x32_bf16 v[152:155], v[48:51], a[248:251], v[152:155]
    v_exp_f32 v9, v9
    v_mfma_f32_16x16x32_bf16 v[156:159], v[48:51], a[252:255], v[156:159]
    ds_read_b64_tr_b16 a[148:149], v141 offset:20864
    v_mfma_f32_16x16x32_bf16 v[160:163], v[48:51], a[48:51], v[160:163]
    v_cvt_pk_bf16_f32 v79, v14, v15
    v_mfma_f32_16x16x32_bf16 v[164:167], v[48:51], a[52:55], v[164:167]
    v_exp_f32 v4, v4
    v_mfma_f32_16x16x32_bf16 v[196:199], v[52:55], a[52:55], v[196:199]
    v_mfma_f32_16x16x32_bf16 v[192:195], v[52:55], a[48:51], v[192:195]
    buffer_store_dwordx4 a[168:171], v135, s[24:27], s32 offen offset:1024 sc1
    v_mfma_f32_16x16x32_bf16 v[224:227], v[56:59], a[48:51], v[224:227]
    v_exp_f32 v6, v6
    v_mfma_f32_16x16x32_bf16 a[128:131], v[56:59], a[144:147], a[128:131]
    v_exp_f32 v10, v10
    v_mfma_f32_16x16x32_bf16 v[228:231], v[56:59], a[52:55], v[228:231]
    v_cvt_pk_bf16_f32 v72, v0, v1
    v_cvt_pk_bf16_f32 v74, v4, v5
    v_mfma_f32_16x16x32_bf16 v[232:235], v[56:59], a[56:59], v[232:235]
    v_exp_f32 v22, v22
    v_mfma_f32_16x16x32_bf16 v[236:239], v[56:59], a[60:63], v[236:239]
    v_exp_f32 v21, v21
    v_mfma_f32_16x16x32_bf16 v[204:207], v[52:55], a[60:63], v[204:207]
    v_cvt_pk_bf16_f32 v73, v2, v3
    v_mfma_f32_16x16x32_bf16 v[200:203], v[52:55], a[56:59], v[200:203]
    v_cvt_pk_bf16_f32 v77, v10, v11
    v_cvt_pk_bf16_f32 v75, v6, v7
    v_mfma_f32_16x16x32_bf16 v[168:171], v[48:51], a[56:59], v[168:171]
    v_exp_f32 v18, v18
    v_mfma_f32_16x16x32_bf16 v[172:175], v[48:51], a[60:63], v[172:175]
    v_exp_f32 v17, v17
    v_mfma_f32_16x16x32_bf16 a[128:131], v[72:75], a[136:139], a[128:131]
    ds_read_b64_tr_b16 a[150:151], v141 offset:20896
    v_mfma_f32_16x16x32_bf16 v[144:147], v[72:75], a[64:67], v[144:147]
    s_waitcnt lgkmcnt(2)
    v_mfma_f32_16x16x32_bf16 v[148:151], v[72:75], a[68:71], v[148:151]
    v_exp_f32 v20, v20
    v_mfma_f32_16x16x32_bf16 v[152:155], v[72:75], a[72:75], v[152:155]
    v_cvt_pk_bf16_f32 v78, v12, v13
    v_mfma_f32_16x16x32_bf16 v[156:159], v[72:75], a[76:79], v[156:159]
    v_exp_f32 v8, v8
    v_mfma_f32_16x16x32_bf16 v[160:163], v[72:75], a[80:83], v[160:163]
    v_exp_f32 v19, v19
    v_mfma_f32_16x16x32_bf16 v[164:167], v[72:75], a[84:87], v[164:167]
    v_cvt_pk_bf16_f32 v76, v8, v9
    v_mfma_f32_16x16x32_bf16 v[168:171], v[72:75], a[88:91], v[168:171]
    buffer_store_dwordx4 a[172:175], v135, s[24:27], s32 offen offset:2048 sc1
    v_mfma_f32_16x16x32_bf16 v[172:175], v[72:75], a[92:95], v[172:175]
    v_mfma_f32_16x16x32_bf16 a[128:131], v[76:79], a[140:143], a[128:131]
    v_cvt_pk_bf16_f32 v83, v22, v23
    v_mfma_f32_16x16x32_bf16 v[176:179], v[76:79], a[64:67], v[176:179]
    v_cvt_pk_bf16_f32 v81, v18, v19
    v_mfma_f32_16x16x32_bf16 v[180:183], v[76:79], a[68:71], v[180:183]
    v_cvt_pk_bf16_f32 v80, v16, v17
    v_mfma_f32_16x16x32_bf16 v[184:187], v[76:79], a[72:75], v[184:187]
    v_mfma_f32_16x16x32_bf16 v[188:191], v[76:79], a[76:79], v[188:191]
    v_mfma_f32_16x16x32_bf16 v[192:195], v[76:79], a[80:83], v[192:195]
    v_cvt_pk_bf16_f32 v82, v20, v21
    v_mfma_f32_16x16x32_bf16 v[196:199], v[76:79], a[84:87], v[196:199]
    s_waitcnt lgkmcnt(0)
    v_mfma_f32_16x16x32_bf16 v[200:203], v[76:79], a[88:91], v[200:203]
    v_mfma_f32_16x16x32_bf16 v[204:207], v[76:79], a[92:95], v[204:207]
    v_mfma_f32_16x16x32_bf16 a[128:131], v[80:83], a[144:147], a[128:131]
    v_mfma_f32_16x16x32_bf16 v[208:211], v[80:83], a[64:67], v[208:211]
    v_mfma_f32_16x16x32_bf16 v[212:215], v[80:83], a[68:71], v[212:215]
    v_mfma_f32_16x16x32_bf16 v[216:219], v[80:83], a[72:75], v[216:219]
    v_mfma_f32_16x16x32_bf16 v[220:223], v[80:83], a[76:79], v[220:223]
    s_nop 3
    v_accvgpr_read_b32 v96, a128
    s_nop 2
    v_accvgpr_read_b32 v97, a129
    v_mfma_f32_16x16x32_bf16 v[224:227], v[80:83], a[80:83], v[224:227]
    v_mfma_f32_16x16x32_bf16 v[228:231], v[80:83], a[84:87], v[228:231]
    buffer_store_dwordx4 a[148:151], v135, s[24:27], s32 offen offset:3072 sc1
    v_mfma_f32_16x16x32_bf16 v[232:235], v[80:83], a[88:91], v[232:235]
    v_accvgpr_read_b32 v98, a130
    v_accvgpr_read_b32 v99, a131
    v_mfma_f32_16x16x32_bf16 v[236:239], v[80:83], a[92:95], v[236:239]
    v_add_f32 v104, v96, v97
    v_add_f32 v104, v104, v98
    v_add_f32 v104, v104, v99
    v_rcp_f32 v96, v96
    v_rcp_f32 v97, v97
    v_rcp_f32 v98, v98
    v_rcp_f32 v99, v99
    v_cmp_nlt_f32 s[40:41], v104, s37
    s_nop 0
    s_cmp_lg_u64 s[40:41], 0
    s_cselect_b32 s33, 2, 0
    s_or_b32 s36, s36, s33
    v_mov_b64_dpp v[100:101], v[96:97] row_newbcast:0 row_mask:0xf bank_mask:0xf
    v_mov_b64_dpp v[102:103], v[98:99] row_newbcast:0 row_mask:0xf bank_mask:0xf
    v_pk_mul_f32 v[144:145], v[144:145], v[100:101]
    v_pk_mul_f32 v[146:147], v[146:147], v[102:103]
    v_pk_mul_f32 v[148:149], v[148:149], v[100:101]
    v_pk_mul_f32 v[150:151], v[150:151], v[102:103]
    v_pk_mul_f32 v[152:153], v[152:153], v[100:101]
    v_pk_mul_f32 v[154:155], v[154:155], v[102:103]
    v_pk_mul_f32 v[156:157], v[156:157], v[100:101]
    v_pk_mul_f32 v[158:159], v[158:159], v[102:103]
    v_cvt_pk_bf16_f32 v40, v144, v148
    v_cvt_pk_bf16_f32 v41, v152, v156
    v_cvt_pk_bf16_f32 v42, v145, v149
    v_cvt_pk_bf16_f32 v43, v153, v157
    v_cvt_pk_bf16_f32 v44, v146, v150
    v_cvt_pk_bf16_f32 v45, v154, v158
    v_cvt_pk_bf16_f32 v46, v147, v151
    v_cvt_pk_bf16_f32 v47, v155, v159
    ds_write2st64_b64 v140, v[40:41], v[42:43] offset0:0 offset1:1
    ds_write2st64_b64 v140, v[44:45], v[46:47] offset0:2 offset1:3
    v_pk_mul_f32 v[160:161], v[160:161], v[100:101]
    v_pk_mul_f32 v[162:163], v[162:163], v[102:103]
    v_pk_mul_f32 v[164:165], v[164:165], v[100:101]
    v_pk_mul_f32 v[166:167], v[166:167], v[102:103]
    v_pk_mul_f32 v[168:169], v[168:169], v[100:101]
    v_pk_mul_f32 v[170:171], v[170:171], v[102:103]
    v_pk_mul_f32 v[172:173], v[172:173], v[100:101]
    v_pk_mul_f32 v[174:175], v[174:175], v[102:103]
    v_cvt_pk_bf16_f32 v40, v160, v164
    v_cvt_pk_bf16_f32 v41, v168, v172
    v_cvt_pk_bf16_f32 v42, v161, v165
    v_cvt_pk_bf16_f32 v43, v169, v173
    v_cvt_pk_bf16_f32 v44, v162, v166
    v_cvt_pk_bf16_f32 v45, v170, v174
    v_cvt_pk_bf16_f32 v46, v163, v167
    v_cvt_pk_bf16_f32 v47, v171, v175
    ds_write2st64_b64 v140, v[40:41], v[42:43] offset0:4 offset1:5
    ds_write2st64_b64 v140, v[44:45], v[46:47] offset0:6 offset1:7
    ds_read_b64_tr_b16 a[148:149], v141
    ds_read_b64_tr_b16 a[150:151], v141 offset:32
    ds_read_b64_tr_b16 a[152:153], v141 offset:128
    ds_read_b64_tr_b16 a[154:155], v141 offset:160
    ds_read_b64_tr_b16 a[156:157], v141 offset:256
    ds_read_b64_tr_b16 a[158:159], v141 offset:288
    ds_read_b64_tr_b16 a[160:161], v141 offset:384
    ds_read_b64_tr_b16 a[162:163], v141 offset:416
    v_mov_b64_dpp v[100:101], v[96:97] row_newbcast:1 row_mask:0xf bank_mask:0xf
    v_mov_b64_dpp v[102:103], v[98:99] row_newbcast:1 row_mask:0xf bank_mask:0xf
    v_pk_mul_f32 v[176:177], v[176:177], v[100:101]
    v_pk_mul_f32 v[178:179], v[178:179], v[102:103]
    v_pk_mul_f32 v[180:181], v[180:181], v[100:101]
    v_pk_mul_f32 v[182:183], v[182:183], v[102:103]
    v_pk_mul_f32 v[184:185], v[184:185], v[100:101]
    v_pk_mul_f32 v[186:187], v[186:187], v[102:103]
    v_pk_mul_f32 v[188:189], v[188:189], v[100:101]
    v_pk_mul_f32 v[190:191], v[190:191], v[102:103]
    v_cvt_pk_bf16_f32 v40, v176, v180
    v_cvt_pk_bf16_f32 v41, v184, v188
    v_cvt_pk_bf16_f32 v42, v177, v181
    v_cvt_pk_bf16_f32 v43, v185, v189
    v_cvt_pk_bf16_f32 v44, v178, v182
    v_cvt_pk_bf16_f32 v45, v186, v190
    v_cvt_pk_bf16_f32 v46, v179, v183
    v_cvt_pk_bf16_f32 v47, v187, v191
    ds_write2st64_b64 v140, v[40:41], v[42:43] offset0:8 offset1:9
    ds_write2st64_b64 v140, v[44:45], v[46:47] offset0:10 offset1:11
    s_mov_b32 s32, 98304
    s_waitcnt lgkmcnt(2)
    buffer_store_dwordx4 a[148:151], v135, s[24:27], s32 offen sc1
    buffer_store_dwordx4 a[152:155], v135, s[24:27], s32 offen offset:1024 sc1
    v_pk_mul_f32 v[192:193], v[192:193], v[100:101]
    v_pk_mul_f32 v[194:195], v[194:195], v[102:103]
    v_pk_mul_f32 v[196:197], v[196:197], v[100:101]
    v_pk_mul_f32 v[198:199], v[198:199], v[102:103]
    v_pk_mul_f32 v[200:201], v[200:201], v[100:101]
    v_pk_mul_f32 v[202:203], v[202:203], v[102:103]
    v_pk_mul_f32 v[204:205], v[204:205], v[100:101]
    v_pk_mul_f32 v[206:207], v[206:207], v[102:103]
    v_cvt_pk_bf16_f32 v40, v192, v196
    v_cvt_pk_bf16_f32 v41, v200, v204
    v_cvt_pk_bf16_f32 v42, v193, v197
    v_cvt_pk_bf16_f32 v43, v201, v205
    v_cvt_pk_bf16_f32 v44, v194, v198
    v_cvt_pk_bf16_f32 v45, v202, v206
    v_cvt_pk_bf16_f32 v46, v195, v199
    v_cvt_pk_bf16_f32 v47, v203, v207
    ds_write2st64_b64 v140, v[40:41], v[42:43] offset0:12 offset1:13
    ds_write2st64_b64 v140, v[44:45], v[46:47] offset0:14 offset1:15
    buffer_store_dwordx4 a[156:159], v135, s[24:27], s32 offen offset:2048 sc1
    buffer_store_dwordx4 a[160:163], v135, s[24:27], s32 offen offset:3072 sc1
    ds_read_b64_tr_b16 a[112:113], v141 offset:4096
    ds_read_b64_tr_b16 a[114:115], v141 offset:4128
    ds_read_b64_tr_b16 a[116:117], v141 offset:4224
    ds_read_b64_tr_b16 a[118:119], v141 offset:4256
    ds_read_b64_tr_b16 a[120:121], v141 offset:4352
    ds_read_b64_tr_b16 a[122:123], v141 offset:4384
    ds_read_b64_tr_b16 a[124:125], v141 offset:4480
    ds_read_b64_tr_b16 a[126:127], v141 offset:4512
    v_mov_b64_dpp v[100:101], v[96:97] row_newbcast:2 row_mask:0xf bank_mask:0xf
    v_mov_b64_dpp v[102:103], v[98:99] row_newbcast:2 row_mask:0xf bank_mask:0xf
    v_pk_mul_f32 v[208:209], v[208:209], v[100:101]
    v_pk_mul_f32 v[210:211], v[210:211], v[102:103]
    v_pk_mul_f32 v[212:213], v[212:213], v[100:101]
    v_pk_mul_f32 v[214:215], v[214:215], v[102:103]
    v_pk_mul_f32 v[216:217], v[216:217], v[100:101]
    v_pk_mul_f32 v[218:219], v[218:219], v[102:103]
    v_pk_mul_f32 v[220:221], v[220:221], v[100:101]
    v_pk_mul_f32 v[222:223], v[222:223], v[102:103]
    v_cvt_pk_bf16_f32 v40, v208, v212
    v_cvt_pk_bf16_f32 v41, v216, v220
    v_cvt_pk_bf16_f32 v42, v209, v213
    v_cvt_pk_bf16_f32 v43, v217, v221
    v_cvt_pk_bf16_f32 v44, v210, v214
    v_cvt_pk_bf16_f32 v45, v218, v222
    v_cvt_pk_bf16_f32 v46, v211, v215
    v_cvt_pk_bf16_f32 v47, v219, v223
    ds_write2st64_b64 v140, v[40:41], v[42:43] offset0:16 offset1:17
    ds_write2st64_b64 v140, v[44:45], v[46:47] offset0:18 offset1:19
    s_mov_b32 s32, 102400
    s_waitcnt lgkmcnt(2)
    buffer_store_dwordx4 a[112:115], v135, s[24:27], s32 offen sc1
    buffer_store_dwordx4 a[116:119], v135, s[24:27], s32 offen offset:1024 sc1
    v_pk_mul_f32 v[224:225], v[224:225], v[100:101]
    v_pk_mul_f32 v[226:227], v[226:227], v[102:103]
    v_pk_mul_f32 v[228:229], v[228:229], v[100:101]
    v_pk_mul_f32 v[230:231], v[230:231], v[102:103]
    v_pk_mul_f32 v[232:233], v[232:233], v[100:101]
    v_pk_mul_f32 v[234:235], v[234:235], v[102:103]
    v_pk_mul_f32 v[236:237], v[236:237], v[100:101]
    v_pk_mul_f32 v[238:239], v[238:239], v[102:103]
    v_cvt_pk_bf16_f32 v40, v224, v228
    v_cvt_pk_bf16_f32 v41, v232, v236
    v_cvt_pk_bf16_f32 v42, v225, v229
    v_cvt_pk_bf16_f32 v43, v233, v237
    v_cvt_pk_bf16_f32 v44, v226, v230
    v_cvt_pk_bf16_f32 v45, v234, v238
    v_cvt_pk_bf16_f32 v46, v227, v231
    v_cvt_pk_bf16_f32 v47, v235, v239
    ds_write2st64_b64 v140, v[40:41], v[42:43] offset0:20 offset1:21
    ds_write2st64_b64 v140, v[44:45], v[46:47] offset0:22 offset1:23
    buffer_store_dwordx4 a[120:123], v135, s[24:27], s32 offen offset:2048 sc1
    buffer_store_dwordx4 a[124:127], v135, s[24:27], s32 offen offset:3072 sc1
    ds_read_b64_tr_b16 a[148:149], v141 offset:8192
    ds_read_b64_tr_b16 a[150:151], v141 offset:8224
    ds_read_b64_tr_b16 a[152:153], v141 offset:8320
    ds_read_b64_tr_b16 a[154:155], v141 offset:8352
    ds_read_b64_tr_b16 a[156:157], v141 offset:8448
    ds_read_b64_tr_b16 a[158:159], v141 offset:8480
    ds_read_b64_tr_b16 a[160:161], v141 offset:8576
    ds_read_b64_tr_b16 a[162:163], v141 offset:8608
    s_mov_b32 s32, 106496
    s_waitcnt lgkmcnt(0)
    buffer_store_dwordx4 a[148:151], v135, s[24:27], s32 offen sc1
    buffer_store_dwordx4 a[152:155], v135, s[24:27], s32 offen offset:1024 sc1
    buffer_store_dwordx4 a[156:159], v135, s[24:27], s32 offen offset:2048 sc1
    buffer_store_dwordx4 a[160:163], v135, s[24:27], s32 offen offset:3072 sc1
    s_waitcnt lgkmcnt(0)
    s_cmp_eq_u32 s36, 0
    s_cbranch_scc1 L_end
L_fast_end:
L_slow:
    s_waitcnt vmcnt(0) lgkmcnt(0)
    v_mbcnt_lo_u32_b32 v117, -1, 0
    v_mbcnt_hi_u32_b32 v117, -1, v117
    v_lshlrev_b32 v135, 4, v117
    v_mov_b32 v120, 0x3f803f80
    v_mov_b32 v121, 0x3f803f80
    v_mov_b32 v122, 0x3f803f80
    v_mov_b32 v123, 0x3f803f80
    v_bfe_u32 v117, v135, 4, 4
    v_lshrrev_b32 v118, 8, v135
    v_lshlrev_b32 v112, 8, v117
    v_lshl_add_u32 v116, v118, 3, v112
    v_lshl_add_u32 v112, v118, 4, v112
    v_lshrrev_b32 v115, 2, v117
    v_lshl_add_u32 v115, v118, 2, v115
    v_lshlrev_b32 v115, 8, v115
    v_and_b32 v117, 3, v117
    v_lshl_add_u32 v115, v117, 3, v115
    v_add_u32 v115, s31, v115
    s_mov_b32 s4, 0
L_sl_head:
    s_lshr_b32 s33, s36, s4
    s_and_b32 s33, s33, 1
    s_cbranch_scc0 L_sl_next
    s_lshl_b32 s7, s4, 17
    s_mul_i32 s8, s4, 98304
    s_mov_b32 s5, 0
L_sl_blk:
    buffer_load_dwordx4 v[16:19], v112, s[12:15], s8 offen
    buffer_load_dwordx4 v[20:23], v112, s[12:15], s8 offen offset:64
    buffer_load_dwordx4 v[24:27], v112, s[12:15], s8 offen offset:128
    buffer_load_dwordx4 v[28:31], v112, s[12:15], s8 offen offset:192
    s_waitcnt vmcnt(0)
    v_lshlrev_b32 v104, 16, v16
    v_and_b32 v105, 0xffff0000, v16
    v_lshlrev_b32 v106, 16, v17
    v_and_b32 v107, 0xffff0000, v17
    v_lshlrev_b32 v108, 16, v18
    v_and_b32 v109, 0xffff0000, v18
    v_lshlrev_b32 v110, 16, v19
    v_and_b32 v111, 0xffff0000, v19
    v_pk_mul_f32 v[104:105], v[104:105], s[38:39]
    v_pk_mul_f32 v[106:107], v[106:107], s[38:39]
    v_pk_mul_f32 v[108:109], v[108:109], s[38:39]
    v_pk_mul_f32 v[110:111], v[110:111], s[38:39]
    v_cvt_pk_bf16_f32 v0, v104, v105
    v_cvt_pk_bf16_f32 v1, v106, v107
    v_cvt_pk_bf16_f32 v2, v108, v109
    v_cvt_pk_bf16_f32 v3, v110, v111
    v_lshlrev_b32 v104, 16, v20
    v_and_b32 v105, 0xffff0000, v20
    v_lshlrev_b32 v106, 16, v21
    v_and_b32 v107, 0xffff0000, v21
    v_lshlrev_b32 v108, 16, v22
    v_and_b32 v109, 0xffff0000, v22
    v_lshlrev_b32 v110, 16, v23
    v_and_b32 v111, 0xffff0000, v23
    v_pk_mul_f32 v[104:105], v[104:105], s[38:39]
    v_pk_mul_f32 v[106:107], v[106:107], s[38:39]
    v_pk_mul_f32 v[108:109], v[108:109], s[38:39]
    v_pk_mul_f32 v[110:111], v[110:111], s[38:39]
    v_cvt_pk_bf16_f32 v4, v104, v105
    v_cvt_pk_bf16_f32 v5, v106, v107
    v_cvt_pk_bf16_f32 v6, v108, v109
    v_cvt_pk_bf16_f32 v7, v110, v111
    v_lshlrev_b32 v104, 16, v24
    v_and_b32 v105, 0xffff0000, v24
    v_lshlrev_b32 v106, 16, v25
    v_and_b32 v107, 0xffff0000, v25
    v_lshlrev_b32 v108, 16, v26
    v_and_b32 v109, 0xffff0000, v26
    v_lshlrev_b32 v110, 16, v27
    v_and_b32 v111, 0xffff0000, v27
    v_pk_mul_f32 v[104:105], v[104:105], s[38:39]
    v_pk_mul_f32 v[106:107], v[106:107], s[38:39]
    v_pk_mul_f32 v[108:109], v[108:109], s[38:39]
    v_pk_mul_f32 v[110:111], v[110:111], s[38:39]
    v_cvt_pk_bf16_f32 v8, v104, v105
    v_cvt_pk_bf16_f32 v9, v106, v107
    v_cvt_pk_bf16_f32 v10, v108, v109
    v_cvt_pk_bf16_f32 v11, v110, v111
    v_lshlrev_b32 v104, 16, v28
    v_and_b32 v105, 0xffff0000, v28
    v_lshlrev_b32 v106, 16, v29
    v_and_b32 v107, 0xffff0000, v29
    v_lshlrev_b32 v108, 16, v30
    v_and_b32 v109, 0xffff0000, v30
    v_lshlrev_b32 v110, 16, v31
    v_and_b32 v111, 0xffff0000, v31
    v_pk_mul_f32 v[104:105], v[104:105], s[38:39]
    v_pk_mul_f32 v[106:107], v[106:107], s[38:39]
    v_pk_mul_f32 v[108:109], v[108:109], s[38:39]
    v_pk_mul_f32 v[110:111], v[110:111], s[38:39]
    v_cvt_pk_bf16_f32 v12, v104, v105
    v_cvt_pk_bf16_f32 v13, v106, v107
    v_cvt_pk_bf16_f32 v14, v108, v109
    v_cvt_pk_bf16_f32 v15, v110, v111
    v_mov_b32 v60, 0xff800000
    v_add_u32 v113, s7, v112
    s_mov_b32 s6, 32
L_sl_p1:
    global_load_dwordx4 v[16:19], v113, s[16:17]
    global_load_dwordx4 v[20:23], v113, s[16:17] offset:64
    global_load_dwordx4 v[24:27], v113, s[16:17] offset:128
    global_load_dwordx4 v[28:31], v113, s[16:17] offset:192
    v_add_u32 v113, 4096, v113
    s_waitcnt vmcnt(0)
    v_mfma_f32_16x16x32_bf16 v[48:51], v[16:19], v[0:3], 0
    v_mfma_f32_16x16x32_bf16 v[48:51], v[20:23], v[4:7], v[48:51]
    v_mfma_f32_16x16x32_bf16 v[48:51], v[24:27], v[8:11], v[48:51]
    v_mfma_f32_16x16x32_bf16 v[48:51], v[28:31], v[12:15], v[48:51]
    s_sub_u32 s6, s6, 1
    s_cmp_lg_u32 s6, 0
    s_nop 7
    v_max3_f32 v60, v60, v48, v49
    v_max3_f32 v60, v60, v50, v51
    s_cbranch_scc1 L_sl_p1
    v_mov_b32 v61, v60
    s_nop 1
    v_permlane32_swap_b32 v60, v61
    v_max_f32 v60, v60, v61
    v_mov_b32 v61, v60
    s_nop 1
    v_permlane16_swap_b32 v60, v61
    v_max_f32 v60, v60, v61
    v_sub_f32 v61, 0, v60
    v_sub_f32 v62, 0, v60
    v_sub_f32 v63, 0, v60
    v_sub_f32 v60, 0, v60
    v_mov_b32 v68, 0
    v_mov_b32 v69, 0
    v_mov_b32 v70, 0
    v_mov_b32 v71, 0
    v_mov_b32 v72, 0
    v_mov_b32 v73, 0
    v_mov_b32 v74, 0
    v_mov_b32 v75, 0
    v_mov_b32 v76, 0
    v_mov_b32 v77, 0
    v_mov_b32 v78, 0
    v_mov_b32 v79, 0
    v_mov_b32 v80, 0
    v_mov_b32 v81, 0
    v_mov_b32 v82, 0
    v_mov_b32 v83, 0
    v_mov_b32 v84, 0
    v_mov_b32 v85, 0
    v_mov_b32 v86, 0
    v_mov_b32 v87, 0
    v_mov_b32 v88, 0
    v_mov_b32 v89, 0
    v_mov_b32 v90, 0
    v_mov_b32 v91, 0
    v_mov_b32 v92, 0
    v_mov_b32 v93, 0
    v_mov_b32 v94, 0
    v_mov_b32 v95, 0
    v_mov_b32 v96, 0
    v_mov_b32 v97, 0
    v_mov_b32 v98, 0
    v_mov_b32 v99, 0
    v_mov_b32 v100, 0
    v_mov_b32 v101, 0
    v_mov_b32 v102, 0
    v_mov_b32 v103, 0
    v_add_u32 v113, s7, v112
    v_add_u32 v114, s7, v135
    v_add_u32 v114, 17408, v114
    s_mov_b32 s6, 16
L_sl_p2:
    s_add_u32 m0, s31, 0
    global_load_dwordx4 v[16:19], v113, s[16:17]
    global_load_dwordx4 v[20:23], v113, s[16:17] offset:64
    global_load_dwordx4 v[24:27], v113, s[16:17] offset:128
    global_load_dwordx4 v[28:31], v113, s[16:17] offset:192
    global_load_lds_dwordx4 v114, s[22:23]
    global_load_lds_dwordx4 v114, s[22:23] offset:1024
    global_load_lds_dwordx4 v114, s[22:23] offset:2048
    global_load_lds_dwordx4 v114, s[22:23] offset:3072
    v_add_u32 v113, 4096, v113
    v_add_u32 v114, 4096, v114
    s_add_u32 m0, s31, 4096
    global_load_dwordx4 v[32:35], v113, s[16:17]
    global_load_dwordx4 v[36:39], v113, s[16:17] offset:64
    global_load_dwordx4 v[40:43], v113, s[16:17] offset:128
    global_load_dwordx4 v[44:47], v113, s[16:17] offset:192
    global_load_lds_dwordx4 v114, s[22:23]
    global_load_lds_dwordx4 v114, s[22:23] offset:1024
    global_load_lds_dwordx4 v114, s[22:23] offset:2048
    global_load_lds_dwordx4 v114, s[22:23] offset:3072
    v_add_u32 v113, 4096, v113
    v_add_u32 v114, 4096, v114
    s_waitcnt vmcnt(0)
    v_mfma_f32_16x16x32_bf16 v[48:51], v[16:19], v[0:3], v[60:63]
    v_mfma_f32_16x16x32_bf16 v[48:51], v[20:23], v[4:7], v[48:51]
    v_mfma_f32_16x16x32_bf16 v[48:51], v[24:27], v[8:11], v[48:51]
    v_mfma_f32_16x16x32_bf16 v[48:51], v[28:31], v[12:15], v[48:51]
    v_mfma_f32_16x16x32_bf16 v[52:55], v[32:35], v[0:3], v[60:63]
    v_mfma_f32_16x16x32_bf16 v[52:55], v[36:39], v[4:7], v[52:55]
    v_mfma_f32_16x16x32_bf16 v[52:55], v[40:43], v[8:11], v[52:55]
    v_mfma_f32_16x16x32_bf16 v[52:55], v[44:47], v[12:15], v[52:55]
    s_nop 7
    v_exp_f32 v48, v48
    v_exp_f32 v49, v49
    v_exp_f32 v50, v50
    v_exp_f32 v51, v51
    v_exp_f32 v52, v52
    v_exp_f32 v53, v53
    v_exp_f32 v54, v54
    v_exp_f32 v55, v55
    v_cvt_pk_bf16_f32 v56, v48, v49
    v_cvt_pk_bf16_f32 v57, v50, v51
    v_cvt_pk_bf16_f32 v58, v52, v53
    v_cvt_pk_bf16_f32 v59, v54, v55
    s_nop 1
    v_mfma_f32_16x16x32_bf16 v[100:103], v[120:123], v[56:59], v[100:103]
    ds_read_b64_tr_b16 v[64:65], v115
    ds_read_b64_tr_b16 v[66:67], v115 offset:4096
    s_waitcnt lgkmcnt(0)
    v_mfma_f32_16x16x32_bf16 v[68:71], v[64:67], v[56:59], v[68:71]
    s_nop 1
    ds_read_b64_tr_b16 v[64:65], v115 offset:32
    ds_read_b64_tr_b16 v[66:67], v115 offset:4128
    s_waitcnt lgkmcnt(0)
    v_mfma_f32_16x16x32_bf16 v[72:75], v[64:67], v[56:59], v[72:75]
    s_nop 1
    ds_read_b64_tr_b16 v[64:65], v115 offset:64
    ds_read_b64_tr_b16 v[66:67], v115 offset:4160
    s_waitcnt lgkmcnt(0)
    v_mfma_f32_16x16x32_bf16 v[76:79], v[64:67], v[56:59], v[76:79]
    s_nop 1
    ds_read_b64_tr_b16 v[64:65], v115 offset:96
    ds_read_b64_tr_b16 v[66:67], v115 offset:4192
    s_waitcnt lgkmcnt(0)
    v_mfma_f32_16x16x32_bf16 v[80:83], v[64:67], v[56:59], v[80:83]
    s_nop 1
    ds_read_b64_tr_b16 v[64:65], v115 offset:128
    ds_read_b64_tr_b16 v[66:67], v115 offset:4224
    s_waitcnt lgkmcnt(0)
    v_mfma_f32_16x16x32_bf16 v[84:87], v[64:67], v[56:59], v[84:87]
    s_nop 1
    ds_read_b64_tr_b16 v[64:65], v115 offset:160
    ds_read_b64_tr_b16 v[66:67], v115 offset:4256
    s_waitcnt lgkmcnt(0)
    v_mfma_f32_16x16x32_bf16 v[88:91], v[64:67], v[56:59], v[88:91]
    s_nop 1
    ds_read_b64_tr_b16 v[64:65], v115 offset:192
    ds_read_b64_tr_b16 v[66:67], v115 offset:4288
    s_waitcnt lgkmcnt(0)
    v_mfma_f32_16x16x32_bf16 v[92:95], v[64:67], v[56:59], v[92:95]
    s_nop 1
    ds_read_b64_tr_b16 v[64:65], v115 offset:224
    ds_read_b64_tr_b16 v[66:67], v115 offset:4320
    s_waitcnt lgkmcnt(0)
    v_mfma_f32_16x16x32_bf16 v[96:99], v[64:67], v[56:59], v[96:99]
    s_nop 1
    s_sub_u32 s6, s6, 1
    s_cmp_lg_u32 s6, 0
    s_cbranch_scc1 L_sl_p2
    s_nop 7
    v_rcp_f32 v117, v100
    s_nop 0
    v_mul_f32 v68, v117, v68
    v_mul_f32 v69, v117, v69
    v_mul_f32 v70, v117, v70
    v_mul_f32 v71, v117, v71
    v_cvt_pk_bf16_f32 v68, v68, v69
    v_cvt_pk_bf16_f32 v69, v70, v71
    buffer_store_dwordx2 v[68:69], v116, s[24:27], s8 offen
    v_mul_f32 v72, v117, v72
    v_mul_f32 v73, v117, v73
    v_mul_f32 v74, v117, v74
    v_mul_f32 v75, v117, v75
    v_cvt_pk_bf16_f32 v72, v72, v73
    v_cvt_pk_bf16_f32 v73, v74, v75
    buffer_store_dwordx2 v[72:73], v116, s[24:27], s8 offen offset:32
    v_mul_f32 v76, v117, v76
    v_mul_f32 v77, v117, v77
    v_mul_f32 v78, v117, v78
    v_mul_f32 v79, v117, v79
    v_cvt_pk_bf16_f32 v76, v76, v77
    v_cvt_pk_bf16_f32 v77, v78, v79
    buffer_store_dwordx2 v[76:77], v116, s[24:27], s8 offen offset:64
    v_mul_f32 v80, v117, v80
    v_mul_f32 v81, v117, v81
    v_mul_f32 v82, v117, v82
    v_mul_f32 v83, v117, v83
    v_cvt_pk_bf16_f32 v80, v80, v81
    v_cvt_pk_bf16_f32 v81, v82, v83
    buffer_store_dwordx2 v[80:81], v116, s[24:27], s8 offen offset:96
    v_mul_f32 v84, v117, v84
    v_mul_f32 v85, v117, v85
    v_mul_f32 v86, v117, v86
    v_mul_f32 v87, v117, v87
    v_cvt_pk_bf16_f32 v84, v84, v85
    v_cvt_pk_bf16_f32 v85, v86, v87
    buffer_store_dwordx2 v[84:85], v116, s[24:27], s8 offen offset:128
    v_mul_f32 v88, v117, v88
    v_mul_f32 v89, v117, v89
    v_mul_f32 v90, v117, v90
    v_mul_f32 v91, v117, v91
    v_cvt_pk_bf16_f32 v88, v88, v89
    v_cvt_pk_bf16_f32 v89, v90, v91
    buffer_store_dwordx2 v[88:89], v116, s[24:27], s8 offen offset:160
    v_mul_f32 v92, v117, v92
    v_mul_f32 v93, v117, v93
    v_mul_f32 v94, v117, v94
    v_mul_f32 v95, v117, v95
    v_cvt_pk_bf16_f32 v92, v92, v93
    v_cvt_pk_bf16_f32 v93, v94, v95
    buffer_store_dwordx2 v[92:93], v116, s[24:27], s8 offen offset:192
    v_mul_f32 v96, v117, v96
    v_mul_f32 v97, v117, v97
    v_mul_f32 v98, v117, v98
    v_mul_f32 v99, v117, v99
    v_cvt_pk_bf16_f32 v96, v96, v97
    v_cvt_pk_bf16_f32 v97, v98, v99
    buffer_store_dwordx2 v[96:97], v116, s[24:27], s8 offen offset:224
    s_add_u32 s8, s8, 4096
    s_add_u32 s5, s5, 1
    s_cmp_lt_u32 s5, 6
    s_cbranch_scc1 L_sl_blk
L_sl_next:
    s_add_u32 s4, s4, 1
    s_cmp_lt_u32 s4, 2
    s_cbranch_scc1 L_sl_head
L_end:
    s_endpgm
.section .rodata,"a"
.p2align 6
.amdhsa_kernel standalone__mha_softmax__near_ridge_kernel
  .amdhsa_next_free_vgpr 512
  .amdhsa_next_free_sgpr 102
  .amdhsa_accum_offset 256
  .amdhsa_group_segment_fixed_size 0
  .amdhsa_kernarg_size 48
  .amdhsa_user_sgpr_count 2
  .amdhsa_user_sgpr_kernarg_segment_ptr 1
  .amdhsa_system_sgpr_workgroup_id_x 1
.end_amdhsa_kernel
```
